```python
import torch

def _softmax(x, axis=-1):
    return torch.softmax(x, dim=axis)
def _gelu(x):
    return torch.nn.functional.gelu(x, approximate="tanh")
def _silu(x):
    return torch.nn.functional.silu(x)
def _sigmoid(x):
    return torch.sigmoid(x)
def _layernorm(x, axis=-1, eps=1e-5):
    m = x.mean(dim=axis, keepdim=True)
    v = x.var(dim=axis, keepdim=True, unbiased=False)
    return (x - m) / torch.sqrt(v + eps)
def _scatter_add(tgt, idx, src, axis=0):
    return tgt.clone().index_add_(axis, idx, src)
def _segment_sum(src, seg, n):
    out = torch.zeros((n,) + src.shape[1:], dtype=src.dtype)
    return out.index_add_(0, seg, src)
def _pad(x, pw):
    flat = tuple(v for pair in reversed(pw) for v in pair)
    return torch.nn.functional.pad(x, flat)

kernel_name = 'gated_mix__mha_block__ssm_conv_s4d__prompt'

def setup_inputs():

    _w = (lambda a: (lambda t: t.to(torch.bfloat16) if t.is_floating_point() else t)(torch.as_tensor(a)))
    def _A_setup():
        B, S, D, H = 1, 2048, 576, 32
        return {
            "x": _w((lambda *s: torch.randn(*s, dtype=torch.bfloat16) * 0.05)(B, S, D)),
            "wqkv": _w((lambda *s: torch.randn(*s, dtype=torch.bfloat16) * 0.8)(D, 3 * D)),
            "wo": _w((lambda *s: torch.randn(*s, dtype=torch.bfloat16) * 0.05)(D, D)),
        }
    _A_in = _A_setup()

    def _B_setup():
        Bsz, L, D, N = 1, 2048, 576, 128
        return {
            "u": _w((lambda *s: torch.randn(*s, dtype=torch.bfloat16) * 0.05)(Bsz, L, D)),
            "log_A_real": _w((lambda *s: torch.randn(*s, dtype=torch.bfloat16) * 6.4)(D, N) * 0.5),
            "A_imag": _w((lambda *s: torch.randn(*s, dtype=torch.bfloat16) * 0.1)(D, N) * 3.14),
            "C_real": _w((lambda *s: torch.randn(*s, dtype=torch.bfloat16) * 0.4)(D, N) / N ** 0.5),
            "C_imag": _w((lambda *s: torch.randn(*s, dtype=torch.bfloat16) * 0.4)(D, N) / N ** 0.5),
            "log_dt": _w((lambda *s: torch.randn(*s, dtype=torch.bfloat16) * 0.1)(D) * 0.5 - 4.0),
            "D_skip": _w((lambda *s: torch.randn(*s, dtype=torch.bfloat16) * 0.1)(D)),
        }
    _B_in = _B_setup()

    return {
        "A_x": _A_in["x"],
        "A_wqkv": _A_in["wqkv"],
        "A_wo": _A_in["wo"],
        "B_u": _B_in["u"],
        "B_log_A_real": _B_in["log_A_real"],
        "B_A_imag": _B_in["A_imag"],
        "B_C_real": _B_in["C_real"],
        "B_C_imag": _B_in["C_imag"],
        "B_log_dt": _B_in["log_dt"],
        "B_D_skip": _B_in["D_skip"],
        "gate_w": _w((lambda *s: torch.randn(*s, dtype=torch.bfloat16) * 0.05)(576) * 16.0),
    }

def reference(A_x, A_wqkv, A_wo, B_u, B_log_A_real, B_A_imag, B_C_real, B_C_imag, B_log_dt, B_D_skip, gate_w):
    def _A_ref(x, wqkv, wo):
        B, S, D = x.shape
        H = 32
        Dh = D // H
        qkv = (lambda x, *d: x.permute(*d))((x @ wqkv).reshape(B, S, 3, H, Dh), 2, 0, 3, 1, 4)
        q, k, v = qkv[0], qkv[1], qkv[2]
        scores = torch.einsum("bhqd,bhkd->bhqk", q, k) * (Dh ** -0.5)
        p = _softmax(scores, axis=-1)
        o = torch.einsum("bhqk,bhkd->bhqd", p, v)
        return (lambda x, *d: x.permute(*d))(o, 0, 2, 1, 3).reshape(B, S, D) @ wo

    def _B_ref(u, log_A_real, A_imag, C_real, C_imag, log_dt, D_skip):
        L = u.shape[1]
        dt = torch.exp(log_dt)
        A = -torch.exp(log_A_real) + 1j * A_imag
        C = (C_real + 1j * C_imag) * dt[:, None]
        pos = (lambda x, dt: x.to(dt))(torch.arange(L), log_dt.dtype)
        P = torch.exp((A * dt[:, None])[:, :, None] * pos[None, None, :])
        K = 2.0 * torch.einsum("dn,dnl->dl", C, P).real
        L2 = 2 * L
        u_t = (lambda x, *d: x.permute(*d))(u, 0, 2, 1)
        Kf = (lambda x, *a, **k: torch.fft.rfft(x.float(), *a, **k))(K, L2)
        Uf = (lambda x, *a, **k: torch.fft.rfft(x.float(), *a, **k))(u_t, L2)
        y = (lambda x, *a, **k: torch.fft.irfft(x, *a, **k).to(torch.bfloat16))(Uf * Kf[None, :, :], L2)[:, :, :L]
        y = (lambda x, *d: x.permute(*d))(y, 0, 2, 1)
        return y + u * D_skip[None, None, :]

    x = A_x
    g = _sigmoid((x * gate_w).sum(-1, keepdims=True))
    a = _A_ref(x, A_wqkv, A_wo)
    b = _B_ref(x, B_log_A_real, B_A_imag, B_C_real, B_C_imag, B_log_dt, B_D_skip)
    return g * a + (1 - g) * b
```

```asm
; @launch kernel=k1_kernel grid=(1120,1,1) block=(256,1,1) lds=52224
; @launch kernel=k2_kernel grid=(400,1,1) block=(512,1,1) lds=78336
; @launch kernel=k3_kernel grid=(192,1,1) block=(128,1,1) lds=73728
.amdgcn_target "amdgcn-amd-amdhsa--gfx950"
.text
.globl k1_kernel
.p2align 8
.type k1_kernel,@function
k1_kernel:
    s_load_dwordx2 s[4:5], s[0:1], 0
    s_load_dwordx2 s[6:7], s[0:1], 8
    s_load_dwordx2 s[8:9], s[0:1], 104
    s_waitcnt lgkmcnt(0)
    s_mov_b32 s12, s4
    s_mov_b32 s13, s5
    s_mov_b32 s14, 2359296
    s_mov_b32 s15, 0x00020000
    s_mov_b32 s20, s8
    s_mov_b32 s21, s9
    s_mov_b32 s22, 21784576
    s_mov_b32 s23, 0x00020000
    s_cmp_ge_u32 s2, 1120
    s_cbranch_scc1 k1_kernel_exit_4
    s_cmp_ge_u32 s2, 1056
    s_cbranch_scc1 k1_kernel_gate_3
    s_cmp_ge_u32 s2, 768
    s_cbranch_scc1 k1_kernel_xt_2
    s_cmp_ge_u32 s2, 192
    s_cbranch_scc1 k1_kernel_kgen_1
    s_mov_b32 s16, s6
    s_mov_b32 s17, s7
    s_mov_b32 s18, 1990656
    s_mov_b32 s19, 0x00020000
    s_and_b32 s29, s2, 15
    s_lshr_b32 s30, s2, 4
    v_and_b32 v1, 63, v0
    v_and_b32 v2, 15, v0
    v_lshrrev_b32 v3, 4, v1
    v_lshrrev_b32 v4, 6, v0
    s_nop 0
    v_readfirstlane_b32 s24, v4
    s_lshl_b32 s31, s29, 7
    s_mov_b32 s39, s31
    s_lshl_b32 s32, s24, 5
    s_add_u32 s31, s31, s32
    s_mul_i32 s25, s31, 1152
    s_mul_i32 s26, s30, 288
    s_lshl_b32 s27, s24, 11
    s_lshl_b32 s28, s24, 10
    s_add_u32 s28, s28, 8192
    v_lshrrev_b32 v4, 2, v1
    s_mov_b32 s33, 1152
    v_mul_lo_u32 v4, v4, s33
    v_and_b32 v5, 3, v1
    v_xor_b32 v5, v5, v3
    v_lshl_add_u32 v8, v5, 4, v4
    v_add_u32 v9, 18432, v8
    s_mov_b32 s34, 3456
    s_movk_i32 s33, 3641
    v_add_u32 v4, 0, v0
    v_mul_lo_u32 v5, v4, s33
    v_lshrrev_b32 v5, 16, v5
    v_mul_u32_u24 v6, 18, v5
    v_sub_u32 v6, v4, v6
    v_mul_lo_u32 v5, v5, s34
    v_lshl_add_u32 v10, v6, 4, v5
    v_add_u32 v4, 256, v0
    v_mul_lo_u32 v5, v4, s33
    v_lshrrev_b32 v5, 16, v5
    v_mul_u32_u24 v6, 18, v5
    v_sub_u32 v6, v4, v6
    v_mul_lo_u32 v5, v5, s34
    v_lshl_add_u32 v11, v6, 4, v5
    v_add_u32 v4, 512, v0
    v_mul_lo_u32 v5, v4, s33
    v_lshrrev_b32 v5, 16, v5
    v_mul_u32_u24 v6, 18, v5
    v_sub_u32 v6, v4, v6
    v_mul_lo_u32 v5, v5, s34
    v_lshl_add_u32 v12, v6, 4, v5
    v_lshlrev_b32 v4, 5, s24
    v_add_u32 v4, v4, v2
    v_lshlrev_b32 v4, 6, v4
    v_and_b32 v5, 1, v3
    v_lshl_add_u32 v4, v5, 3, v4
    v_lshrrev_b32 v5, 2, v2
    v_lshrrev_b32 v6, 1, v3
    v_xor_b32 v5, v5, v6
    v_lshl_add_u32 v14, v5, 4, v4
    v_xor_b32 v15, 32, v14
    v_lshrrev_b32 v4, 2, v2
    v_lshl_add_u32 v4, v3, 2, v4
    v_mul_u32_u24 v4, 288, v4
    v_and_b32 v5, 3, v2
    v_lshl_add_u32 v4, v5, 3, v4
    v_add_u32 v16, 8192, v4
    s_cmp_ge_u32 s30, 8
    s_cbranch_scc1 k1_kernel_vpath_5
    v_mov_b32 v20, 0
    v_mov_b32 v21, 0
    v_mov_b32 v22, 0
    v_mov_b32 v23, 0
    v_mov_b32 v24, 0
    v_mov_b32 v25, 0
    v_mov_b32 v26, 0
    v_mov_b32 v27, 0
    v_mov_b32 v28, 0
    v_mov_b32 v29, 0
    v_mov_b32 v30, 0
    v_mov_b32 v31, 0
    v_mov_b32 v32, 0
    v_mov_b32 v33, 0
    v_mov_b32 v34, 0
    v_mov_b32 v35, 0
    v_mov_b32 v36, 0
    v_mov_b32 v37, 0
    v_mov_b32 v38, 0
    v_mov_b32 v39, 0
    v_mov_b32 v40, 0
    v_mov_b32 v41, 0
    v_mov_b32 v42, 0
    v_mov_b32 v43, 0
    v_mov_b32 v44, 0
    v_mov_b32 v45, 0
    v_mov_b32 v46, 0
    v_mov_b32 v47, 0
    v_mov_b32 v48, 0
    v_mov_b32 v49, 0
    v_mov_b32 v50, 0
    v_mov_b32 v51, 0
    v_mov_b32 v52, 0
    v_mov_b32 v53, 0
    v_mov_b32 v54, 0
    v_mov_b32 v55, 0
    v_mov_b32 v56, 0
    v_mov_b32 v57, 0
    v_mov_b32 v58, 0
    v_mov_b32 v59, 0
    v_mov_b32 v60, 0
    v_mov_b32 v61, 0
    v_mov_b32 v62, 0
    v_mov_b32 v63, 0
    v_mov_b32 v64, 0
    v_mov_b32 v65, 0
    v_mov_b32 v66, 0
    v_mov_b32 v67, 0
    v_mov_b32 v68, 0
    v_mov_b32 v69, 0
    v_mov_b32 v70, 0
    v_mov_b32 v71, 0
    v_mov_b32 v72, 0
    v_mov_b32 v73, 0
    v_mov_b32 v74, 0
    v_mov_b32 v75, 0
    v_mov_b32 v76, 0
    v_mov_b32 v77, 0
    v_mov_b32 v78, 0
    v_mov_b32 v79, 0
    v_mov_b32 v80, 0
    v_mov_b32 v81, 0
    v_mov_b32 v82, 0
    v_mov_b32 v83, 0
    v_mov_b32 v84, 0
    v_mov_b32 v85, 0
    v_mov_b32 v86, 0
    v_mov_b32 v87, 0
    v_mov_b32 v88, 0
    v_mov_b32 v89, 0
    v_mov_b32 v90, 0
    v_mov_b32 v91, 0
    s_add_u32 m0, s27, 0
    s_nop 0
    buffer_load_dwordx4 v8, s[12:15], s25 offen lds
    s_add_u32 m0, s27, 1024
    s_nop 0
    buffer_load_dwordx4 v9, s[12:15], s25 offen lds
    s_add_u32 m0, s28, 0
    s_nop 0
    buffer_load_dwordx4 v10, s[16:19], s26 offen lds
    s_add_u32 m0, s28, 4096
    s_nop 0
    buffer_load_dwordx4 v11, s[16:19], s26 offen lds
    s_cmp_ge_u32 s24, 1
    s_cbranch_scc1 k1_kernel_skipw_7
    s_add_u32 m0, s28, 8192
    s_nop 0
    buffer_load_dwordx4 v12, s[16:19], s26 offen lds
k1_kernel_skipw_7:
    s_add_u32 s25, s25, 64
    s_add_u32 s26, s26, 110592
    s_add_u32 m0, s27, 17408
    s_nop 0
    buffer_load_dwordx4 v8, s[12:15], s25 offen lds
    s_add_u32 m0, s27, 18432
    s_nop 0
    buffer_load_dwordx4 v9, s[12:15], s25 offen lds
    s_add_u32 m0, s28, 17408
    s_nop 0
    buffer_load_dwordx4 v10, s[16:19], s26 offen lds
    s_add_u32 m0, s28, 21504
    s_nop 0
    buffer_load_dwordx4 v11, s[16:19], s26 offen lds
    s_cmp_ge_u32 s24, 1
    s_cbranch_scc1 k1_kernel_skipw_8
    s_add_u32 m0, s28, 25600
    s_nop 0
    buffer_load_dwordx4 v12, s[16:19], s26 offen lds
k1_kernel_skipw_8:
    s_add_u32 s25, s25, 64
    s_add_u32 s26, s26, 110592
    s_mov_b32 s42, 0
k1_kernel_gloop_9:
    s_waitcnt vmcnt(4)
    s_barrier
    ds_read_b64 v[92:93], v14 offset:0
    ds_read_b64 v[94:95], v15 offset:0
    ds_read_b64 v[96:97], v14 offset:1024
    ds_read_b64 v[98:99], v15 offset:1024
    ds_read_b64_tr_b16 v[100:101], v16 offset:0
    ds_read_b64_tr_b16 v[102:103], v16 offset:4608
    ds_read_b64_tr_b16 v[104:105], v16 offset:32
    ds_read_b64_tr_b16 v[106:107], v16 offset:4640
    ds_read_b64_tr_b16 v[108:109], v16 offset:64
    ds_read_b64_tr_b16 v[110:111], v16 offset:4672
    ds_read_b64_tr_b16 v[112:113], v16 offset:96
    ds_read_b64_tr_b16 v[114:115], v16 offset:4704
    ds_read_b64_tr_b16 v[116:117], v16 offset:128
    ds_read_b64_tr_b16 v[118:119], v16 offset:4736
    ds_read_b64_tr_b16 v[120:121], v16 offset:160
    ds_read_b64_tr_b16 v[122:123], v16 offset:4768
    ds_read_b64_tr_b16 v[124:125], v16 offset:192
    ds_read_b64_tr_b16 v[126:127], v16 offset:4800
    ds_read_b64_tr_b16 v[128:129], v16 offset:224
    ds_read_b64_tr_b16 v[130:131], v16 offset:4832
    ds_read_b64_tr_b16 v[132:133], v16 offset:256
    ds_read_b64_tr_b16 v[134:135], v16 offset:4864
    s_add_u32 m0, s27, 34816
    s_nop 0
    buffer_load_dwordx4 v8, s[12:15], s25 offen lds
    s_add_u32 m0, s27, 35840
    s_nop 0
    buffer_load_dwordx4 v9, s[12:15], s25 offen lds
    s_add_u32 m0, s28, 34816
    s_nop 0
    buffer_load_dwordx4 v10, s[16:19], s26 offen lds
    s_add_u32 m0, s28, 38912
    s_nop 0
    buffer_load_dwordx4 v11, s[16:19], s26 offen lds
    s_cmp_ge_u32 s24, 1
    s_cbranch_scc1 k1_kernel_skipw_10
    s_add_u32 m0, s28, 43008
    s_nop 0
    buffer_load_dwordx4 v12, s[16:19], s26 offen lds
k1_kernel_skipw_10:
    s_add_u32 s25, s25, 64
    s_add_u32 s26, s26, 110592
    s_waitcnt lgkmcnt(15)
    v_mfma_f32_16x16x32_bf16 v[20:23], v[100:103], v[92:95], v[20:23]
    v_mfma_f32_16x16x32_bf16 v[56:59], v[100:103], v[96:99], v[56:59]
    s_waitcnt lgkmcnt(14)
    v_mfma_f32_16x16x32_bf16 v[24:27], v[104:107], v[92:95], v[24:27]
    v_mfma_f32_16x16x32_bf16 v[60:63], v[104:107], v[96:99], v[60:63]
    s_waitcnt lgkmcnt(12)
    v_mfma_f32_16x16x32_bf16 v[28:31], v[108:111], v[92:95], v[28:31]
    v_mfma_f32_16x16x32_bf16 v[64:67], v[108:111], v[96:99], v[64:67]
    s_waitcnt lgkmcnt(10)
    v_mfma_f32_16x16x32_bf16 v[32:35], v[112:115], v[92:95], v[32:35]
    v_mfma_f32_16x16x32_bf16 v[68:71], v[112:115], v[96:99], v[68:71]
    s_waitcnt lgkmcnt(8)
    v_mfma_f32_16x16x32_bf16 v[36:39], v[116:119], v[92:95], v[36:39]
    v_mfma_f32_16x16x32_bf16 v[72:75], v[116:119], v[96:99], v[72:75]
    s_waitcnt lgkmcnt(6)
    v_mfma_f32_16x16x32_bf16 v[40:43], v[120:123], v[92:95], v[40:43]
    v_mfma_f32_16x16x32_bf16 v[76:79], v[120:123], v[96:99], v[76:79]
    s_waitcnt lgkmcnt(4)
    v_mfma_f32_16x16x32_bf16 v[44:47], v[124:127], v[92:95], v[44:47]
    v_mfma_f32_16x16x32_bf16 v[80:83], v[124:127], v[96:99], v[80:83]
    s_waitcnt lgkmcnt(2)
    v_mfma_f32_16x16x32_bf16 v[48:51], v[128:131], v[92:95], v[48:51]
    v_mfma_f32_16x16x32_bf16 v[84:87], v[128:131], v[96:99], v[84:87]
    s_waitcnt lgkmcnt(0)
    v_mfma_f32_16x16x32_bf16 v[52:55], v[132:135], v[92:95], v[52:55]
    v_mfma_f32_16x16x32_bf16 v[88:91], v[132:135], v[96:99], v[88:91]
    s_waitcnt vmcnt(4)
    s_barrier
    ds_read_b64 v[92:93], v14 offset:17408
    ds_read_b64 v[94:95], v15 offset:17408
    ds_read_b64 v[96:97], v14 offset:18432
    ds_read_b64 v[98:99], v15 offset:18432
    ds_read_b64_tr_b16 v[100:101], v16 offset:17408
    ds_read_b64_tr_b16 v[102:103], v16 offset:22016
    ds_read_b64_tr_b16 v[104:105], v16 offset:17440
    ds_read_b64_tr_b16 v[106:107], v16 offset:22048
    ds_read_b64_tr_b16 v[108:109], v16 offset:17472
    ds_read_b64_tr_b16 v[110:111], v16 offset:22080
    ds_read_b64_tr_b16 v[112:113], v16 offset:17504
    ds_read_b64_tr_b16 v[114:115], v16 offset:22112
    ds_read_b64_tr_b16 v[116:117], v16 offset:17536
    ds_read_b64_tr_b16 v[118:119], v16 offset:22144
    ds_read_b64_tr_b16 v[120:121], v16 offset:17568
    ds_read_b64_tr_b16 v[122:123], v16 offset:22176
    ds_read_b64_tr_b16 v[124:125], v16 offset:17600
    ds_read_b64_tr_b16 v[126:127], v16 offset:22208
    ds_read_b64_tr_b16 v[128:129], v16 offset:17632
    ds_read_b64_tr_b16 v[130:131], v16 offset:22240
    ds_read_b64_tr_b16 v[132:133], v16 offset:17664
    ds_read_b64_tr_b16 v[134:135], v16 offset:22272
    s_cmp_ge_u32 s42, 5
    s_cbranch_scc1 k1_kernel_gd_11
    s_add_u32 m0, s27, 0
    s_nop 0
    buffer_load_dwordx4 v8, s[12:15], s25 offen lds
    s_add_u32 m0, s27, 1024
    s_nop 0
    buffer_load_dwordx4 v9, s[12:15], s25 offen lds
    s_add_u32 m0, s28, 0
    s_nop 0
    buffer_load_dwordx4 v10, s[16:19], s26 offen lds
    s_add_u32 m0, s28, 4096
    s_nop 0
    buffer_load_dwordx4 v11, s[16:19], s26 offen lds
    s_cmp_ge_u32 s24, 1
    s_cbranch_scc1 k1_kernel_skipw_12
    s_add_u32 m0, s28, 8192
    s_nop 0
    buffer_load_dwordx4 v12, s[16:19], s26 offen lds
k1_kernel_skipw_12:
    s_add_u32 s25, s25, 64
    s_add_u32 s26, s26, 110592
k1_kernel_gd_11:
    s_waitcnt lgkmcnt(15)
    v_mfma_f32_16x16x32_bf16 v[20:23], v[100:103], v[92:95], v[20:23]
    v_mfma_f32_16x16x32_bf16 v[56:59], v[100:103], v[96:99], v[56:59]
    s_waitcnt lgkmcnt(14)
    v_mfma_f32_16x16x32_bf16 v[24:27], v[104:107], v[92:95], v[24:27]
    v_mfma_f32_16x16x32_bf16 v[60:63], v[104:107], v[96:99], v[60:63]
    s_waitcnt lgkmcnt(12)
    v_mfma_f32_16x16x32_bf16 v[28:31], v[108:111], v[92:95], v[28:31]
    v_mfma_f32_16x16x32_bf16 v[64:67], v[108:111], v[96:99], v[64:67]
    s_waitcnt lgkmcnt(10)
    v_mfma_f32_16x16x32_bf16 v[32:35], v[112:115], v[92:95], v[32:35]
    v_mfma_f32_16x16x32_bf16 v[68:71], v[112:115], v[96:99], v[68:71]
    s_waitcnt lgkmcnt(8)
    v_mfma_f32_16x16x32_bf16 v[36:39], v[116:119], v[92:95], v[36:39]
    v_mfma_f32_16x16x32_bf16 v[72:75], v[116:119], v[96:99], v[72:75]
    s_waitcnt lgkmcnt(6)
    v_mfma_f32_16x16x32_bf16 v[40:43], v[120:123], v[92:95], v[40:43]
    v_mfma_f32_16x16x32_bf16 v[76:79], v[120:123], v[96:99], v[76:79]
    s_waitcnt lgkmcnt(4)
    v_mfma_f32_16x16x32_bf16 v[44:47], v[124:127], v[92:95], v[44:47]
    v_mfma_f32_16x16x32_bf16 v[80:83], v[124:127], v[96:99], v[80:83]
    s_waitcnt lgkmcnt(2)
    v_mfma_f32_16x16x32_bf16 v[48:51], v[128:131], v[92:95], v[48:51]
    v_mfma_f32_16x16x32_bf16 v[84:87], v[128:131], v[96:99], v[84:87]
    s_waitcnt lgkmcnt(0)
    v_mfma_f32_16x16x32_bf16 v[52:55], v[132:135], v[92:95], v[52:55]
    v_mfma_f32_16x16x32_bf16 v[88:91], v[132:135], v[96:99], v[88:91]
    s_cmp_lt_u32 s42, 5
    s_cbranch_scc1 k1_kernel_gw_13
    s_waitcnt vmcnt(0)
k1_kernel_gw_13:
    s_waitcnt vmcnt(4)
    s_barrier
    ds_read_b64 v[92:93], v14 offset:34816
    ds_read_b64 v[94:95], v15 offset:34816
    ds_read_b64 v[96:97], v14 offset:35840
    ds_read_b64 v[98:99], v15 offset:35840
    ds_read_b64_tr_b16 v[100:101], v16 offset:34816
    ds_read_b64_tr_b16 v[102:103], v16 offset:39424
    ds_read_b64_tr_b16 v[104:105], v16 offset:34848
    ds_read_b64_tr_b16 v[106:107], v16 offset:39456
    ds_read_b64_tr_b16 v[108:109], v16 offset:34880
    ds_read_b64_tr_b16 v[110:111], v16 offset:39488
    ds_read_b64_tr_b16 v[112:113], v16 offset:34912
    ds_read_b64_tr_b16 v[114:115], v16 offset:39520
    ds_read_b64_tr_b16 v[116:117], v16 offset:34944
    ds_read_b64_tr_b16 v[118:119], v16 offset:39552
    ds_read_b64_tr_b16 v[120:121], v16 offset:34976
    ds_read_b64_tr_b16 v[122:123], v16 offset:39584
    ds_read_b64_tr_b16 v[124:125], v16 offset:35008
    ds_read_b64_tr_b16 v[126:127], v16 offset:39616
    ds_read_b64_tr_b16 v[128:129], v16 offset:35040
    ds_read_b64_tr_b16 v[130:131], v16 offset:39648
    ds_read_b64_tr_b16 v[132:133], v16 offset:35072
    ds_read_b64_tr_b16 v[134:135], v16 offset:39680
    s_cmp_ge_u32 s42, 5
    s_cbranch_scc1 k1_kernel_gd_14
    s_add_u32 m0, s27, 17408
    s_nop 0
    buffer_load_dwordx4 v8, s[12:15], s25 offen lds
    s_add_u32 m0, s27, 18432
    s_nop 0
    buffer_load_dwordx4 v9, s[12:15], s25 offen lds
    s_add_u32 m0, s28, 17408
    s_nop 0
    buffer_load_dwordx4 v10, s[16:19], s26 offen lds
    s_add_u32 m0, s28, 21504
    s_nop 0
    buffer_load_dwordx4 v11, s[16:19], s26 offen lds
    s_cmp_ge_u32 s24, 1
    s_cbranch_scc1 k1_kernel_skipw_15
    s_add_u32 m0, s28, 25600
    s_nop 0
    buffer_load_dwordx4 v12, s[16:19], s26 offen lds
k1_kernel_skipw_15:
    s_add_u32 s25, s25, 64
    s_add_u32 s26, s26, 110592
k1_kernel_gd_14:
    s_waitcnt lgkmcnt(15)
    v_mfma_f32_16x16x32_bf16 v[20:23], v[100:103], v[92:95], v[20:23]
    v_mfma_f32_16x16x32_bf16 v[56:59], v[100:103], v[96:99], v[56:59]
    s_waitcnt lgkmcnt(14)
    v_mfma_f32_16x16x32_bf16 v[24:27], v[104:107], v[92:95], v[24:27]
    v_mfma_f32_16x16x32_bf16 v[60:63], v[104:107], v[96:99], v[60:63]
    s_waitcnt lgkmcnt(12)
    v_mfma_f32_16x16x32_bf16 v[28:31], v[108:111], v[92:95], v[28:31]
    v_mfma_f32_16x16x32_bf16 v[64:67], v[108:111], v[96:99], v[64:67]
    s_waitcnt lgkmcnt(10)
    v_mfma_f32_16x16x32_bf16 v[32:35], v[112:115], v[92:95], v[32:35]
    v_mfma_f32_16x16x32_bf16 v[68:71], v[112:115], v[96:99], v[68:71]
    s_waitcnt lgkmcnt(8)
    v_mfma_f32_16x16x32_bf16 v[36:39], v[116:119], v[92:95], v[36:39]
    v_mfma_f32_16x16x32_bf16 v[72:75], v[116:119], v[96:99], v[72:75]
    s_waitcnt lgkmcnt(6)
    v_mfma_f32_16x16x32_bf16 v[40:43], v[120:123], v[92:95], v[40:43]
    v_mfma_f32_16x16x32_bf16 v[76:79], v[120:123], v[96:99], v[76:79]
    s_waitcnt lgkmcnt(4)
    v_mfma_f32_16x16x32_bf16 v[44:47], v[124:127], v[92:95], v[44:47]
    v_mfma_f32_16x16x32_bf16 v[80:83], v[124:127], v[96:99], v[80:83]
    s_waitcnt lgkmcnt(2)
    v_mfma_f32_16x16x32_bf16 v[48:51], v[128:131], v[92:95], v[48:51]
    v_mfma_f32_16x16x32_bf16 v[84:87], v[128:131], v[96:99], v[84:87]
    s_waitcnt lgkmcnt(0)
    v_mfma_f32_16x16x32_bf16 v[52:55], v[132:135], v[92:95], v[52:55]
    v_mfma_f32_16x16x32_bf16 v[88:91], v[132:135], v[96:99], v[88:91]
    s_add_u32 s42, s42, 1
    s_cmp_lt_u32 s42, 6
    s_cbranch_scc1 k1_kernel_gloop_9
    s_barrier
    s_cmp_lt_u32 s30, 4
    s_cselect_b32 s40, 1051597459, 1065353216
    s_cselect_b32 s41, 0, 0x3F803F80
    v_lshlrev_b32 v4, 5, s24
    v_add_u32 v4, v4, v2
    v_mul_u32_u24 v4, 400, v4
    v_lshlrev_b32 v5, 2, v3
    v_add_u32 v5, 0, v5
    v_mul_u32_u24 v6, 57, v5
    v_lshrrev_b32 v6, 10, v6
    v_mul_u32_u24 v6, 12, v6
    v_lshl_add_u32 v6, v5, 1, v6
    v_add_u32 v6, v6, v4
    v_mul_f32 v20, s40, v20
    v_mul_f32 v21, s40, v21
    v_cvt_pk_bf16_f32 v100, v20, v21
    ds_write_b32 v6, v100 offset:0
    v_mul_f32 v56, s40, v56
    v_mul_f32 v57, s40, v57
    v_cvt_pk_bf16_f32 v101, v56, v57
    ds_write_b32 v6, v101 offset:6400
    v_lshlrev_b32 v5, 2, v3
    v_add_u32 v5, 2, v5
    v_mul_u32_u24 v6, 57, v5
    v_lshrrev_b32 v6, 10, v6
    v_mul_u32_u24 v6, 12, v6
    v_lshl_add_u32 v6, v5, 1, v6
    v_add_u32 v6, v6, v4
    v_mul_f32 v22, s40, v22
    v_mul_f32 v23, s40, v23
    v_cvt_pk_bf16_f32 v102, v22, v23
    ds_write_b32 v6, v102 offset:0
    v_mul_f32 v58, s40, v58
    v_mul_f32 v59, s40, v59
    v_cvt_pk_bf16_f32 v103, v58, v59
    ds_write_b32 v6, v103 offset:6400
    v_lshlrev_b32 v5, 2, v3
    v_add_u32 v5, 16, v5
    v_mul_u32_u24 v6, 57, v5
    v_lshrrev_b32 v6, 10, v6
    v_mul_u32_u24 v6, 12, v6
    v_lshl_add_u32 v6, v5, 1, v6
    v_add_u32 v6, v6, v4
    v_mul_f32 v24, s40, v24
    v_mul_f32 v25, s40, v25
    v_cvt_pk_bf16_f32 v104, v24, v25
    ds_write_b32 v6, v104 offset:0
    v_mul_f32 v60, s40, v60
    v_mul_f32 v61, s40, v61
    v_cvt_pk_bf16_f32 v105, v60, v61
    ds_write_b32 v6, v105 offset:6400
    v_lshlrev_b32 v5, 2, v3
    v_add_u32 v5, 18, v5
    v_mul_u32_u24 v6, 57, v5
    v_lshrrev_b32 v6, 10, v6
    v_mul_u32_u24 v6, 12, v6
    v_lshl_add_u32 v6, v5, 1, v6
    v_add_u32 v6, v6, v4
    v_mul_f32 v26, s40, v26
    v_mul_f32 v27, s40, v27
    v_cvt_pk_bf16_f32 v106, v26, v27
    ds_write_b32 v6, v106 offset:0
    v_mul_f32 v62, s40, v62
    v_mul_f32 v63, s40, v63
    v_cvt_pk_bf16_f32 v107, v62, v63
    ds_write_b32 v6, v107 offset:6400
    v_lshlrev_b32 v5, 2, v3
    v_add_u32 v5, 32, v5
    v_mul_u32_u24 v6, 57, v5
    v_lshrrev_b32 v6, 10, v6
    v_mul_u32_u24 v6, 12, v6
    v_lshl_add_u32 v6, v5, 1, v6
    v_add_u32 v6, v6, v4
    v_mul_f32 v28, s40, v28
    v_mul_f32 v29, s40, v29
    v_cvt_pk_bf16_f32 v108, v28, v29
    ds_write_b32 v6, v108 offset:0
    v_mul_f32 v64, s40, v64
    v_mul_f32 v65, s40, v65
    v_cvt_pk_bf16_f32 v109, v64, v65
    ds_write_b32 v6, v109 offset:6400
    v_lshlrev_b32 v5, 2, v3
    v_add_u32 v5, 34, v5
    v_mul_u32_u24 v6, 57, v5
    v_lshrrev_b32 v6, 10, v6
    v_mul_u32_u24 v6, 12, v6
    v_lshl_add_u32 v6, v5, 1, v6
    v_add_u32 v6, v6, v4
    v_mul_f32 v30, s40, v30
    v_mul_f32 v31, s40, v31
    v_cvt_pk_bf16_f32 v110, v30, v31
    ds_write_b32 v6, v110 offset:0
    v_mul_f32 v66, s40, v66
    v_mul_f32 v67, s40, v67
    v_cvt_pk_bf16_f32 v111, v66, v67
    ds_write_b32 v6, v111 offset:6400
    v_lshlrev_b32 v5, 2, v3
    v_add_u32 v5, 48, v5
    v_mul_u32_u24 v6, 57, v5
    v_lshrrev_b32 v6, 10, v6
    v_mul_u32_u24 v6, 12, v6
    v_lshl_add_u32 v6, v5, 1, v6
    v_add_u32 v6, v6, v4
    v_mul_f32 v32, s40, v32
    v_mul_f32 v33, s40, v33
    v_cvt_pk_bf16_f32 v112, v32, v33
    ds_write_b32 v6, v112 offset:0
    v_mul_f32 v68, s40, v68
    v_mul_f32 v69, s40, v69
    v_cvt_pk_bf16_f32 v113, v68, v69
    ds_write_b32 v6, v113 offset:6400
    v_lshlrev_b32 v5, 2, v3
    v_add_u32 v5, 50, v5
    v_mul_u32_u24 v6, 57, v5
    v_lshrrev_b32 v6, 10, v6
    v_mul_u32_u24 v6, 12, v6
    v_lshl_add_u32 v6, v5, 1, v6
    v_add_u32 v6, v6, v4
    v_mul_f32 v34, s40, v34
    v_mul_f32 v35, s40, v35
    v_cvt_pk_bf16_f32 v114, v34, v35
    ds_write_b32 v6, v114 offset:0
    v_mul_f32 v70, s40, v70
    v_mul_f32 v71, s40, v71
    v_cvt_pk_bf16_f32 v115, v70, v71
    ds_write_b32 v6, v115 offset:6400
    v_lshlrev_b32 v5, 2, v3
    v_add_u32 v5, 64, v5
    v_mul_u32_u24 v6, 57, v5
    v_lshrrev_b32 v6, 10, v6
    v_mul_u32_u24 v6, 12, v6
    v_lshl_add_u32 v6, v5, 1, v6
    v_add_u32 v6, v6, v4
    v_mul_f32 v36, s40, v36
    v_mul_f32 v37, s40, v37
    v_cvt_pk_bf16_f32 v116, v36, v37
    ds_write_b32 v6, v116 offset:0
    v_mul_f32 v72, s40, v72
    v_mul_f32 v73, s40, v73
    v_cvt_pk_bf16_f32 v117, v72, v73
    ds_write_b32 v6, v117 offset:6400
    v_lshlrev_b32 v5, 2, v3
    v_add_u32 v5, 66, v5
    v_mul_u32_u24 v6, 57, v5
    v_lshrrev_b32 v6, 10, v6
    v_mul_u32_u24 v6, 12, v6
    v_lshl_add_u32 v6, v5, 1, v6
    v_add_u32 v6, v6, v4
    v_mul_f32 v38, s40, v38
    v_mul_f32 v39, s40, v39
    v_cvt_pk_bf16_f32 v118, v38, v39
    ds_write_b32 v6, v118 offset:0
    v_mul_f32 v74, s40, v74
    v_mul_f32 v75, s40, v75
    v_cvt_pk_bf16_f32 v119, v74, v75
    ds_write_b32 v6, v119 offset:6400
    v_lshlrev_b32 v5, 2, v3
    v_add_u32 v5, 80, v5
    v_mul_u32_u24 v6, 57, v5
    v_lshrrev_b32 v6, 10, v6
    v_mul_u32_u24 v6, 12, v6
    v_lshl_add_u32 v6, v5, 1, v6
    v_add_u32 v6, v6, v4
    v_mul_f32 v40, s40, v40
    v_mul_f32 v41, s40, v41
    v_cvt_pk_bf16_f32 v120, v40, v41
    ds_write_b32 v6, v120 offset:0
    v_mul_f32 v76, s40, v76
    v_mul_f32 v77, s40, v77
    v_cvt_pk_bf16_f32 v121, v76, v77
    ds_write_b32 v6, v121 offset:6400
    v_lshlrev_b32 v5, 2, v3
    v_add_u32 v5, 82, v5
    v_mul_u32_u24 v6, 57, v5
    v_lshrrev_b32 v6, 10, v6
    v_mul_u32_u24 v6, 12, v6
    v_lshl_add_u32 v6, v5, 1, v6
    v_add_u32 v6, v6, v4
    v_mul_f32 v42, s40, v42
    v_mul_f32 v43, s40, v43
    v_cvt_pk_bf16_f32 v122, v42, v43
    ds_write_b32 v6, v122 offset:0
    v_mul_f32 v78, s40, v78
    v_mul_f32 v79, s40, v79
    v_cvt_pk_bf16_f32 v123, v78, v79
    ds_write_b32 v6, v123 offset:6400
    v_lshlrev_b32 v5, 2, v3
    v_add_u32 v5, 96, v5
    v_mul_u32_u24 v6, 57, v5
    v_lshrrev_b32 v6, 10, v6
    v_mul_u32_u24 v6, 12, v6
    v_lshl_add_u32 v6, v5, 1, v6
    v_add_u32 v6, v6, v4
    v_mul_f32 v44, s40, v44
    v_mul_f32 v45, s40, v45
    v_cvt_pk_bf16_f32 v124, v44, v45
    ds_write_b32 v6, v124 offset:0
    v_mul_f32 v80, s40, v80
    v_mul_f32 v81, s40, v81
    v_cvt_pk_bf16_f32 v125, v80, v81
    ds_write_b32 v6, v125 offset:6400
    v_lshlrev_b32 v5, 2, v3
    v_add_u32 v5, 98, v5
    v_mul_u32_u24 v6, 57, v5
    v_lshrrev_b32 v6, 10, v6
    v_mul_u32_u24 v6, 12, v6
    v_lshl_add_u32 v6, v5, 1, v6
    v_add_u32 v6, v6, v4
    v_mul_f32 v46, s40, v46
    v_mul_f32 v47, s40, v47
    v_cvt_pk_bf16_f32 v126, v46, v47
    ds_write_b32 v6, v126 offset:0
    v_mul_f32 v82, s40, v82
    v_mul_f32 v83, s40, v83
    v_cvt_pk_bf16_f32 v127, v82, v83
    ds_write_b32 v6, v127 offset:6400
    v_lshlrev_b32 v5, 2, v3
    v_add_u32 v5, 112, v5
    v_mul_u32_u24 v6, 57, v5
    v_lshrrev_b32 v6, 10, v6
    v_mul_u32_u24 v6, 12, v6
    v_lshl_add_u32 v6, v5, 1, v6
    v_add_u32 v6, v6, v4
    v_mul_f32 v48, s40, v48
    v_mul_f32 v49, s40, v49
    v_cvt_pk_bf16_f32 v128, v48, v49
    ds_write_b32 v6, v128 offset:0
    v_mul_f32 v84, s40, v84
    v_mul_f32 v85, s40, v85
    v_cvt_pk_bf16_f32 v129, v84, v85
    ds_write_b32 v6, v129 offset:6400
    v_lshlrev_b32 v5, 2, v3
    v_add_u32 v5, 114, v5
    v_mul_u32_u24 v6, 57, v5
    v_lshrrev_b32 v6, 10, v6
    v_mul_u32_u24 v6, 12, v6
    v_lshl_add_u32 v6, v5, 1, v6
    v_add_u32 v6, v6, v4
    v_mul_f32 v50, s40, v50
    v_mul_f32 v51, s40, v51
    v_cvt_pk_bf16_f32 v130, v50, v51
    ds_write_b32 v6, v130 offset:0
    v_mul_f32 v86, s40, v86
    v_mul_f32 v87, s40, v87
    v_cvt_pk_bf16_f32 v131, v86, v87
    ds_write_b32 v6, v131 offset:6400
    v_lshlrev_b32 v5, 2, v3
    v_add_u32 v5, 128, v5
    v_mul_u32_u24 v6, 57, v5
    v_lshrrev_b32 v6, 10, v6
    v_mul_u32_u24 v6, 12, v6
    v_lshl_add_u32 v6, v5, 1, v6
    v_add_u32 v6, v6, v4
    v_mul_f32 v52, s40, v52
    v_mul_f32 v53, s40, v53
    v_cvt_pk_bf16_f32 v100, v52, v53
    ds_write_b32 v6, v100 offset:0
    v_mul_f32 v88, s40, v88
    v_mul_f32 v89, s40, v89
    v_cvt_pk_bf16_f32 v101, v88, v89
    ds_write_b32 v6, v101 offset:6400
    v_lshlrev_b32 v5, 2, v3
    v_add_u32 v5, 130, v5
    v_mul_u32_u24 v6, 57, v5
    v_lshrrev_b32 v6, 10, v6
    v_mul_u32_u24 v6, 12, v6
    v_lshl_add_u32 v6, v5, 1, v6
    v_add_u32 v6, v6, v4
    v_mul_f32 v54, s40, v54
    v_mul_f32 v55, s40, v55
    v_cvt_pk_bf16_f32 v102, v54, v55
    ds_write_b32 v6, v102 offset:0
    v_mul_f32 v90, s40, v90
    v_mul_f32 v91, s40, v91
    v_cvt_pk_bf16_f32 v103, v90, v91
    ds_write_b32 v6, v103 offset:6400
    v_and_b32 v5, 127, v0
    v_mul_u32_u24 v5, 400, v5
    v_lshrrev_b32 v6, 7, v0
    v_mul_u32_u24 v6, 48, v6
    v_add_u32 v5, v5, v6
    v_mov_b32 v100, s41
    v_mov_b32 v101, 0
    ds_write_b32 v5, v100 offset:36
    ds_write_b32 v5, v101 offset:40
    ds_write_b32 v5, v101 offset:44
    ds_write_b32 v5, v100 offset:132
    ds_write_b32 v5, v101 offset:136
    ds_write_b32 v5, v101 offset:140
    ds_write_b32 v5, v100 offset:228
    ds_write_b32 v5, v101 offset:232
    ds_write_b32 v5, v101 offset:236
    ds_write_b32 v5, v100 offset:324
    ds_write_b32 v5, v101 offset:328
    ds_write_b32 v5, v101 offset:332
    s_waitcnt lgkmcnt(0)
    s_barrier
    s_and_b32 s38, s30, 3
    s_lshl_b32 s38, s38, 3
    s_cmp_ge_u32 s30, 4
    s_cbranch_scc1 k1_kernel_kpath_16
    v_lshrrev_b32 v4, 2, v0
    v_and_b32 v5, 3, v0
    v_mul_u32_u24 v6, 400, v4
    v_lshl_add_u32 v6, v5, 4, v6
    v_lshlrev_b32 v4, 6, v4
    v_lshl_add_u32 v4, v5, 4, v4
    v_cmp_eq_u32 vcc, 3, v5
    s_lshl_b32 s31, s38, 11
    s_add_u32 s31, s31, s39
    s_lshl_b32 s31, s31, 6
    s_add_u32 s31, s31, 0
    ds_read_b128 v[100:103], v6 offset:0
    s_waitcnt lgkmcnt(0)
    v_cndmask_b32 v100, v100, 0, vcc
    v_cndmask_b32 v101, v101, 0, vcc
    v_cndmask_b32 v102, v102, 0, vcc
    v_cndmask_b32 v103, v103, 0, vcc
    s_add_u32 s32, s31, 0
    buffer_store_dwordx4 v[100:103], v4, s[20:23], s32 offen
    ds_read_b128 v[104:107], v6 offset:25600
    s_waitcnt lgkmcnt(0)
    v_cndmask_b32 v104, v104, 0, vcc
    v_cndmask_b32 v105, v105, 0, vcc
    v_cndmask_b32 v106, v106, 0, vcc
    v_cndmask_b32 v107, v107, 0, vcc
    s_add_u32 s32, s31, 4096
    buffer_store_dwordx4 v[104:107], v4, s[20:23], s32 offen
    ds_read_b128 v[108:111], v6 offset:48
    s_waitcnt lgkmcnt(0)
    v_cndmask_b32 v108, v108, 0, vcc
    v_cndmask_b32 v109, v109, 0, vcc
    v_cndmask_b32 v110, v110, 0, vcc
    v_cndmask_b32 v111, v111, 0, vcc
    s_add_u32 s32, s31, 131072
    buffer_store_dwordx4 v[108:111], v4, s[20:23], s32 offen
    ds_read_b128 v[112:115], v6 offset:25648
    s_waitcnt lgkmcnt(0)
    v_cndmask_b32 v112, v112, 0, vcc
    v_cndmask_b32 v113, v113, 0, vcc
    v_cndmask_b32 v114, v114, 0, vcc
    v_cndmask_b32 v115, v115, 0, vcc
    s_add_u32 s32, s31, 135168
    buffer_store_dwordx4 v[112:115], v4, s[20:23], s32 offen
    ds_read_b128 v[100:103], v6 offset:96
    s_waitcnt lgkmcnt(0)
    v_cndmask_b32 v100, v100, 0, vcc
    v_cndmask_b32 v101, v101, 0, vcc
    v_cndmask_b32 v102, v102, 0, vcc
    v_cndmask_b32 v103, v103, 0, vcc
    s_add_u32 s32, s31, 262144
    buffer_store_dwordx4 v[100:103], v4, s[20:23], s32 offen
    ds_read_b128 v[104:107], v6 offset:25696
    s_waitcnt lgkmcnt(0)
    v_cndmask_b32 v104, v104, 0, vcc
    v_cndmask_b32 v105, v105, 0, vcc
    v_cndmask_b32 v106, v106, 0, vcc
    v_cndmask_b32 v107, v107, 0, vcc
    s_add_u32 s32, s31, 266240
    buffer_store_dwordx4 v[104:107], v4, s[20:23], s32 offen
    ds_read_b128 v[108:111], v6 offset:144
    s_waitcnt lgkmcnt(0)
    v_cndmask_b32 v108, v108, 0, vcc
    v_cndmask_b32 v109, v109, 0, vcc
    v_cndmask_b32 v110, v110, 0, vcc
    v_cndmask_b32 v111, v111, 0, vcc
    s_add_u32 s32, s31, 393216
    buffer_store_dwordx4 v[108:111], v4, s[20:23], s32 offen
    ds_read_b128 v[112:115], v6 offset:25744
    s_waitcnt lgkmcnt(0)
    v_cndmask_b32 v112, v112, 0, vcc
    v_cndmask_b32 v113, v113, 0, vcc
    v_cndmask_b32 v114, v114, 0, vcc
    v_cndmask_b32 v115, v115, 0, vcc
    s_add_u32 s32, s31, 397312
    buffer_store_dwordx4 v[112:115], v4, s[20:23], s32 offen
    ds_read_b128 v[100:103], v6 offset:192
    s_waitcnt lgkmcnt(0)
    v_cndmask_b32 v100, v100, 0, vcc
    v_cndmask_b32 v101, v101, 0, vcc
    v_cndmask_b32 v102, v102, 0, vcc
    v_cndmask_b32 v103, v103, 0, vcc
    s_add_u32 s32, s31, 524288
    buffer_store_dwordx4 v[100:103], v4, s[20:23], s32 offen
    ds_read_b128 v[104:107], v6 offset:25792
    s_waitcnt lgkmcnt(0)
    v_cndmask_b32 v104, v104, 0, vcc
    v_cndmask_b32 v105, v105, 0, vcc
    v_cndmask_b32 v106, v106, 0, vcc
    v_cndmask_b32 v107, v107, 0, vcc
    s_add_u32 s32, s31, 528384
    buffer_store_dwordx4 v[104:107], v4, s[20:23], s32 offen
    ds_read_b128 v[108:111], v6 offset:240
    s_waitcnt lgkmcnt(0)
    v_cndmask_b32 v108, v108, 0, vcc
    v_cndmask_b32 v109, v109, 0, vcc
    v_cndmask_b32 v110, v110, 0, vcc
    v_cndmask_b32 v111, v111, 0, vcc
    s_add_u32 s32, s31, 655360
    buffer_store_dwordx4 v[108:111], v4, s[20:23], s32 offen
    ds_read_b128 v[112:115], v6 offset:25840
    s_waitcnt lgkmcnt(0)
    v_cndmask_b32 v112, v112, 0, vcc
    v_cndmask_b32 v113, v113, 0, vcc
    v_cndmask_b32 v114, v114, 0, vcc
    v_cndmask_b32 v115, v115, 0, vcc
    s_add_u32 s32, s31, 659456
    buffer_store_dwordx4 v[112:115], v4, s[20:23], s32 offen
    ds_read_b128 v[100:103], v6 offset:288
    s_waitcnt lgkmcnt(0)
    v_cndmask_b32 v100, v100, 0, vcc
    v_cndmask_b32 v101, v101, 0, vcc
    v_cndmask_b32 v102, v102, 0, vcc
    v_cndmask_b32 v103, v103, 0, vcc
    s_add_u32 s32, s31, 786432
    buffer_store_dwordx4 v[100:103], v4, s[20:23], s32 offen
    ds_read_b128 v[104:107], v6 offset:25888
    s_waitcnt lgkmcnt(0)
    v_cndmask_b32 v104, v104, 0, vcc
    v_cndmask_b32 v105, v105, 0, vcc
    v_cndmask_b32 v106, v106, 0, vcc
    v_cndmask_b32 v107, v107, 0, vcc
    s_add_u32 s32, s31, 790528
    buffer_store_dwordx4 v[104:107], v4, s[20:23], s32 offen
    ds_read_b128 v[108:111], v6 offset:336
    s_waitcnt lgkmcnt(0)
    v_cndmask_b32 v108, v108, 0, vcc
    v_cndmask_b32 v109, v109, 0, vcc
    v_cndmask_b32 v110, v110, 0, vcc
    v_cndmask_b32 v111, v111, 0, vcc
    s_add_u32 s32, s31, 917504
    buffer_store_dwordx4 v[108:111], v4, s[20:23], s32 offen
    ds_read_b128 v[112:115], v6 offset:25936
    s_waitcnt lgkmcnt(0)
    v_cndmask_b32 v112, v112, 0, vcc
    v_cndmask_b32 v113, v113, 0, vcc
    v_cndmask_b32 v114, v114, 0, vcc
    v_cndmask_b32 v115, v115, 0, vcc
    s_add_u32 s32, s31, 921600
    buffer_store_dwordx4 v[112:115], v4, s[20:23], s32 offen
    s_branch k1_kernel_gend_6
k1_kernel_kpath_16:
    s_lshr_b32 s31, s39, 8
    s_lshl_b32 s32, s38, 3
    s_add_u32 s31, s31, s32
    s_mul_i32 s31, s31, 22528
    s_and_b32 s32, s39, 255
    s_mul_i32 s32, s32, 48
    s_add_u32 s31, s31, s32
    s_add_u32 s31, s31, 4194304
    v_add_u32 v4, 0, v0
    v_cmp_le_u32 vcc, 384, v4
    s_nop 1
    v_cndmask_b32 v5, 0, 1, vcc
    v_mul_u32_u24 v6, 384, v5
    v_sub_u32 v4, v4, v6
    v_mul_u32_u24 v6, 171, v4
    v_lshrrev_b32 v6, 9, v6
    v_mul_u32_u24 v136, 400, v6
    v_mul_u32_u24 v6, 3, v6
    v_sub_u32 v6, v4, v6
    v_lshl_add_u32 v136, v6, 4, v136
    v_mul_u32_u24 v6, 48, v5
    v_add_u32 v136, v136, v6
    s_mov_b32 s32, 180224
    v_mul_lo_u32 v139, v5, s32
    v_lshl_add_u32 v139, v4, 4, v139
    v_add_u32 v4, 256, v0
    v_cmp_le_u32 vcc, 384, v4
    s_nop 1
    v_cndmask_b32 v5, 0, 1, vcc
    v_mul_u32_u24 v6, 384, v5
    v_sub_u32 v4, v4, v6
    v_mul_u32_u24 v6, 171, v4
    v_lshrrev_b32 v6, 9, v6
    v_mul_u32_u24 v137, 400, v6
    v_mul_u32_u24 v6, 3, v6
    v_sub_u32 v6, v4, v6
    v_lshl_add_u32 v137, v6, 4, v137
    v_mul_u32_u24 v6, 48, v5
    v_add_u32 v137, v137, v6
    s_mov_b32 s32, 180224
    v_mul_lo_u32 v140, v5, s32
    v_lshl_add_u32 v140, v4, 4, v140
    v_add_u32 v4, 512, v0
    v_cmp_le_u32 vcc, 384, v4
    s_nop 1
    v_cndmask_b32 v5, 0, 1, vcc
    v_mul_u32_u24 v6, 384, v5
    v_sub_u32 v4, v4, v6
    v_mul_u32_u24 v6, 171, v4
    v_lshrrev_b32 v6, 9, v6
    v_mul_u32_u24 v138, 400, v6
    v_mul_u32_u24 v6, 3, v6
    v_sub_u32 v6, v4, v6
    v_lshl_add_u32 v138, v6, 4, v138
    v_mul_u32_u24 v6, 48, v5
    v_add_u32 v138, v138, v6
    s_mov_b32 s32, 180224
    v_mul_lo_u32 v141, v5, s32
    v_lshl_add_u32 v141, v4, 4, v141
    ds_read_b128 v[100:103], v136 offset:0
    s_add_u32 s32, s31, 0
    s_waitcnt lgkmcnt(0)
    buffer_store_dwordx4 v[100:103], v139, s[20:23], s32 offen
    ds_read_b128 v[104:107], v137 offset:0
    s_add_u32 s32, s31, 0
    s_waitcnt lgkmcnt(0)
    buffer_store_dwordx4 v[104:107], v140, s[20:23], s32 offen
    ds_read_b128 v[108:111], v138 offset:0
    s_add_u32 s32, s31, 0
    s_waitcnt lgkmcnt(0)
    buffer_store_dwordx4 v[108:111], v141, s[20:23], s32 offen
    ds_read_b128 v[112:115], v136 offset:96
    s_add_u32 s32, s31, 360448
    s_waitcnt lgkmcnt(0)
    buffer_store_dwordx4 v[112:115], v139, s[20:23], s32 offen
    ds_read_b128 v[100:103], v137 offset:96
    s_add_u32 s32, s31, 360448
    s_waitcnt lgkmcnt(0)
    buffer_store_dwordx4 v[100:103], v140, s[20:23], s32 offen
    ds_read_b128 v[104:107], v138 offset:96
    s_add_u32 s32, s31, 360448
    s_waitcnt lgkmcnt(0)
    buffer_store_dwordx4 v[104:107], v141, s[20:23], s32 offen
    ds_read_b128 v[108:111], v136 offset:192
    s_add_u32 s32, s31, 720896
    s_waitcnt lgkmcnt(0)
    buffer_store_dwordx4 v[108:111], v139, s[20:23], s32 offen
    ds_read_b128 v[112:115], v137 offset:192
    s_add_u32 s32, s31, 720896
    s_waitcnt lgkmcnt(0)
    buffer_store_dwordx4 v[112:115], v140, s[20:23], s32 offen
    ds_read_b128 v[100:103], v138 offset:192
    s_add_u32 s32, s31, 720896
    s_waitcnt lgkmcnt(0)
    buffer_store_dwordx4 v[100:103], v141, s[20:23], s32 offen
    ds_read_b128 v[104:107], v136 offset:288
    s_add_u32 s32, s31, 1081344
    s_waitcnt lgkmcnt(0)
    buffer_store_dwordx4 v[104:107], v139, s[20:23], s32 offen
    ds_read_b128 v[108:111], v137 offset:288
    s_add_u32 s32, s31, 1081344
    s_waitcnt lgkmcnt(0)
    buffer_store_dwordx4 v[108:111], v140, s[20:23], s32 offen
    ds_read_b128 v[112:115], v138 offset:288
    s_add_u32 s32, s31, 1081344
    s_waitcnt lgkmcnt(0)
    buffer_store_dwordx4 v[112:115], v141, s[20:23], s32 offen
    s_branch k1_kernel_gend_6
k1_kernel_vpath_5:
    v_mov_b32 v20, 0
    v_mov_b32 v21, 0
    v_mov_b32 v22, 0
    v_mov_b32 v23, 0
    v_mov_b32 v24, 0
    v_mov_b32 v25, 0
    v_mov_b32 v26, 0
    v_mov_b32 v27, 0
    v_mov_b32 v28, 0
    v_mov_b32 v29, 0
    v_mov_b32 v30, 0
    v_mov_b32 v31, 0
    v_mov_b32 v32, 0
    v_mov_b32 v33, 0
    v_mov_b32 v34, 0
    v_mov_b32 v35, 0
    v_mov_b32 v36, 0
    v_mov_b32 v37, 0
    v_mov_b32 v38, 0
    v_mov_b32 v39, 0
    v_mov_b32 v40, 0
    v_mov_b32 v41, 0
    v_mov_b32 v42, 0
    v_mov_b32 v43, 0
    v_mov_b32 v44, 0
    v_mov_b32 v45, 0
    v_mov_b32 v46, 0
    v_mov_b32 v47, 0
    v_mov_b32 v48, 0
    v_mov_b32 v49, 0
    v_mov_b32 v50, 0
    v_mov_b32 v51, 0
    v_mov_b32 v52, 0
    v_mov_b32 v53, 0
    v_mov_b32 v54, 0
    v_mov_b32 v55, 0
    v_mov_b32 v56, 0
    v_mov_b32 v57, 0
    v_mov_b32 v58, 0
    v_mov_b32 v59, 0
    v_mov_b32 v60, 0
    v_mov_b32 v61, 0
    v_mov_b32 v62, 0
    v_mov_b32 v63, 0
    v_mov_b32 v64, 0
    v_mov_b32 v65, 0
    v_mov_b32 v66, 0
    v_mov_b32 v67, 0
    v_mov_b32 v68, 0
    v_mov_b32 v69, 0
    v_mov_b32 v70, 0
    v_mov_b32 v71, 0
    v_mov_b32 v72, 0
    v_mov_b32 v73, 0
    v_mov_b32 v74, 0
    v_mov_b32 v75, 0
    v_mov_b32 v76, 0
    v_mov_b32 v77, 0
    v_mov_b32 v78, 0
    v_mov_b32 v79, 0
    v_mov_b32 v80, 0
    v_mov_b32 v81, 0
    v_mov_b32 v82, 0
    v_mov_b32 v83, 0
    v_mov_b32 v84, 0
    v_mov_b32 v85, 0
    v_mov_b32 v86, 0
    v_mov_b32 v87, 0
    v_mov_b32 v88, 0
    v_mov_b32 v89, 0
    v_mov_b32 v90, 0
    v_mov_b32 v91, 0
    s_add_u32 m0, s27, 0
    s_nop 0
    buffer_load_dwordx4 v8, s[12:15], s25 offen lds
    s_add_u32 m0, s27, 1024
    s_nop 0
    buffer_load_dwordx4 v9, s[12:15], s25 offen lds
    s_add_u32 m0, s28, 0
    s_nop 0
    buffer_load_dwordx4 v10, s[16:19], s26 offen lds
    s_add_u32 m0, s28, 4096
    s_nop 0
    buffer_load_dwordx4 v11, s[16:19], s26 offen lds
    s_cmp_ge_u32 s24, 1
    s_cbranch_scc1 k1_kernel_skipw_17
    s_add_u32 m0, s28, 8192
    s_nop 0
    buffer_load_dwordx4 v12, s[16:19], s26 offen lds
k1_kernel_skipw_17:
    s_add_u32 s25, s25, 64
    s_add_u32 s26, s26, 110592
    s_add_u32 m0, s27, 17408
    s_nop 0
    buffer_load_dwordx4 v8, s[12:15], s25 offen lds
    s_add_u32 m0, s27, 18432
    s_nop 0
    buffer_load_dwordx4 v9, s[12:15], s25 offen lds
    s_add_u32 m0, s28, 17408
    s_nop 0
    buffer_load_dwordx4 v10, s[16:19], s26 offen lds
    s_add_u32 m0, s28, 21504
    s_nop 0
    buffer_load_dwordx4 v11, s[16:19], s26 offen lds
    s_cmp_ge_u32 s24, 1
    s_cbranch_scc1 k1_kernel_skipw_18
    s_add_u32 m0, s28, 25600
    s_nop 0
    buffer_load_dwordx4 v12, s[16:19], s26 offen lds
k1_kernel_skipw_18:
    s_add_u32 s25, s25, 64
    s_add_u32 s26, s26, 110592
    s_mov_b32 s42, 0
k1_kernel_gloop_19:
    s_waitcnt vmcnt(4)
    s_barrier
    ds_read_b64 v[92:93], v14 offset:0
    ds_read_b64 v[94:95], v15 offset:0
    ds_read_b64 v[96:97], v14 offset:1024
    ds_read_b64 v[98:99], v15 offset:1024
    ds_read_b64_tr_b16 v[100:101], v16 offset:0
    ds_read_b64_tr_b16 v[102:103], v16 offset:4608
    ds_read_b64_tr_b16 v[104:105], v16 offset:32
    ds_read_b64_tr_b16 v[106:107], v16 offset:4640
    ds_read_b64_tr_b16 v[108:109], v16 offset:64
    ds_read_b64_tr_b16 v[110:111], v16 offset:4672
    ds_read_b64_tr_b16 v[112:113], v16 offset:96
    ds_read_b64_tr_b16 v[114:115], v16 offset:4704
    ds_read_b64_tr_b16 v[116:117], v16 offset:128
    ds_read_b64_tr_b16 v[118:119], v16 offset:4736
    ds_read_b64_tr_b16 v[120:121], v16 offset:160
    ds_read_b64_tr_b16 v[122:123], v16 offset:4768
    ds_read_b64_tr_b16 v[124:125], v16 offset:192
    ds_read_b64_tr_b16 v[126:127], v16 offset:4800
    ds_read_b64_tr_b16 v[128:129], v16 offset:224
    ds_read_b64_tr_b16 v[130:131], v16 offset:4832
    ds_read_b64_tr_b16 v[132:133], v16 offset:256
    ds_read_b64_tr_b16 v[134:135], v16 offset:4864
    s_add_u32 m0, s27, 34816
    s_nop 0
    buffer_load_dwordx4 v8, s[12:15], s25 offen lds
    s_add_u32 m0, s27, 35840
    s_nop 0
    buffer_load_dwordx4 v9, s[12:15], s25 offen lds
    s_add_u32 m0, s28, 34816
    s_nop 0
    buffer_load_dwordx4 v10, s[16:19], s26 offen lds
    s_add_u32 m0, s28, 38912
    s_nop 0
    buffer_load_dwordx4 v11, s[16:19], s26 offen lds
    s_cmp_ge_u32 s24, 1
    s_cbranch_scc1 k1_kernel_skipw_20
    s_add_u32 m0, s28, 43008
    s_nop 0
    buffer_load_dwordx4 v12, s[16:19], s26 offen lds
k1_kernel_skipw_20:
    s_add_u32 s25, s25, 64
    s_add_u32 s26, s26, 110592
    s_waitcnt lgkmcnt(15)
    v_mfma_f32_16x16x32_bf16 v[20:23], v[92:95], v[100:103], v[20:23]
    v_mfma_f32_16x16x32_bf16 v[56:59], v[96:99], v[100:103], v[56:59]
    s_waitcnt lgkmcnt(14)
    v_mfma_f32_16x16x32_bf16 v[24:27], v[92:95], v[104:107], v[24:27]
    v_mfma_f32_16x16x32_bf16 v[60:63], v[96:99], v[104:107], v[60:63]
    s_waitcnt lgkmcnt(12)
    v_mfma_f32_16x16x32_bf16 v[28:31], v[92:95], v[108:111], v[28:31]
    v_mfma_f32_16x16x32_bf16 v[64:67], v[96:99], v[108:111], v[64:67]
    s_waitcnt lgkmcnt(10)
    v_mfma_f32_16x16x32_bf16 v[32:35], v[92:95], v[112:115], v[32:35]
    v_mfma_f32_16x16x32_bf16 v[68:71], v[96:99], v[112:115], v[68:71]
    s_waitcnt lgkmcnt(8)
    v_mfma_f32_16x16x32_bf16 v[36:39], v[92:95], v[116:119], v[36:39]
    v_mfma_f32_16x16x32_bf16 v[72:75], v[96:99], v[116:119], v[72:75]
    s_waitcnt lgkmcnt(6)
    v_mfma_f32_16x16x32_bf16 v[40:43], v[92:95], v[120:123], v[40:43]
    v_mfma_f32_16x16x32_bf16 v[76:79], v[96:99], v[120:123], v[76:79]
    s_waitcnt lgkmcnt(4)
    v_mfma_f32_16x16x32_bf16 v[44:47], v[92:95], v[124:127], v[44:47]
    v_mfma_f32_16x16x32_bf16 v[80:83], v[96:99], v[124:127], v[80:83]
    s_waitcnt lgkmcnt(2)
    v_mfma_f32_16x16x32_bf16 v[48:51], v[92:95], v[128:131], v[48:51]
    v_mfma_f32_16x16x32_bf16 v[84:87], v[96:99], v[128:131], v[84:87]
    s_waitcnt lgkmcnt(0)
    v_mfma_f32_16x16x32_bf16 v[52:55], v[92:95], v[132:135], v[52:55]
    v_mfma_f32_16x16x32_bf16 v[88:91], v[96:99], v[132:135], v[88:91]
    s_waitcnt vmcnt(4)
    s_barrier
    ds_read_b64 v[92:93], v14 offset:17408
    ds_read_b64 v[94:95], v15 offset:17408
    ds_read_b64 v[96:97], v14 offset:18432
    ds_read_b64 v[98:99], v15 offset:18432
    ds_read_b64_tr_b16 v[100:101], v16 offset:17408
    ds_read_b64_tr_b16 v[102:103], v16 offset:22016
    ds_read_b64_tr_b16 v[104:105], v16 offset:17440
    ds_read_b64_tr_b16 v[106:107], v16 offset:22048
    ds_read_b64_tr_b16 v[108:109], v16 offset:17472
    ds_read_b64_tr_b16 v[110:111], v16 offset:22080
    ds_read_b64_tr_b16 v[112:113], v16 offset:17504
    ds_read_b64_tr_b16 v[114:115], v16 offset:22112
    ds_read_b64_tr_b16 v[116:117], v16 offset:17536
    ds_read_b64_tr_b16 v[118:119], v16 offset:22144
    ds_read_b64_tr_b16 v[120:121], v16 offset:17568
    ds_read_b64_tr_b16 v[122:123], v16 offset:22176
    ds_read_b64_tr_b16 v[124:125], v16 offset:17600
    ds_read_b64_tr_b16 v[126:127], v16 offset:22208
    ds_read_b64_tr_b16 v[128:129], v16 offset:17632
    ds_read_b64_tr_b16 v[130:131], v16 offset:22240
    ds_read_b64_tr_b16 v[132:133], v16 offset:17664
    ds_read_b64_tr_b16 v[134:135], v16 offset:22272
    s_cmp_ge_u32 s42, 5
    s_cbranch_scc1 k1_kernel_gd_21
    s_add_u32 m0, s27, 0
    s_nop 0
    buffer_load_dwordx4 v8, s[12:15], s25 offen lds
    s_add_u32 m0, s27, 1024
    s_nop 0
    buffer_load_dwordx4 v9, s[12:15], s25 offen lds
    s_add_u32 m0, s28, 0
    s_nop 0
    buffer_load_dwordx4 v10, s[16:19], s26 offen lds
    s_add_u32 m0, s28, 4096
    s_nop 0
    buffer_load_dwordx4 v11, s[16:19], s26 offen lds
    s_cmp_ge_u32 s24, 1
    s_cbranch_scc1 k1_kernel_skipw_22
    s_add_u32 m0, s28, 8192
    s_nop 0
    buffer_load_dwordx4 v12, s[16:19], s26 offen lds
k1_kernel_skipw_22:
    s_add_u32 s25, s25, 64
    s_add_u32 s26, s26, 110592
k1_kernel_gd_21:
    s_waitcnt lgkmcnt(15)
    v_mfma_f32_16x16x32_bf16 v[20:23], v[92:95], v[100:103], v[20:23]
    v_mfma_f32_16x16x32_bf16 v[56:59], v[96:99], v[100:103], v[56:59]
    s_waitcnt lgkmcnt(14)
    v_mfma_f32_16x16x32_bf16 v[24:27], v[92:95], v[104:107], v[24:27]
    v_mfma_f32_16x16x32_bf16 v[60:63], v[96:99], v[104:107], v[60:63]
    s_waitcnt lgkmcnt(12)
    v_mfma_f32_16x16x32_bf16 v[28:31], v[92:95], v[108:111], v[28:31]
    v_mfma_f32_16x16x32_bf16 v[64:67], v[96:99], v[108:111], v[64:67]
    s_waitcnt lgkmcnt(10)
    v_mfma_f32_16x16x32_bf16 v[32:35], v[92:95], v[112:115], v[32:35]
    v_mfma_f32_16x16x32_bf16 v[68:71], v[96:99], v[112:115], v[68:71]
    s_waitcnt lgkmcnt(8)
    v_mfma_f32_16x16x32_bf16 v[36:39], v[92:95], v[116:119], v[36:39]
    v_mfma_f32_16x16x32_bf16 v[72:75], v[96:99], v[116:119], v[72:75]
    s_waitcnt lgkmcnt(6)
    v_mfma_f32_16x16x32_bf16 v[40:43], v[92:95], v[120:123], v[40:43]
    v_mfma_f32_16x16x32_bf16 v[76:79], v[96:99], v[120:123], v[76:79]
    s_waitcnt lgkmcnt(4)
    v_mfma_f32_16x16x32_bf16 v[44:47], v[92:95], v[124:127], v[44:47]
    v_mfma_f32_16x16x32_bf16 v[80:83], v[96:99], v[124:127], v[80:83]
    s_waitcnt lgkmcnt(2)
    v_mfma_f32_16x16x32_bf16 v[48:51], v[92:95], v[128:131], v[48:51]
    v_mfma_f32_16x16x32_bf16 v[84:87], v[96:99], v[128:131], v[84:87]
    s_waitcnt lgkmcnt(0)
    v_mfma_f32_16x16x32_bf16 v[52:55], v[92:95], v[132:135], v[52:55]
    v_mfma_f32_16x16x32_bf16 v[88:91], v[96:99], v[132:135], v[88:91]
    s_cmp_lt_u32 s42, 5
    s_cbranch_scc1 k1_kernel_gw_23
    s_waitcnt vmcnt(0)
k1_kernel_gw_23:
    s_waitcnt vmcnt(4)
    s_barrier
    ds_read_b64 v[92:93], v14 offset:34816
    ds_read_b64 v[94:95], v15 offset:34816
    ds_read_b64 v[96:97], v14 offset:35840
    ds_read_b64 v[98:99], v15 offset:35840
    ds_read_b64_tr_b16 v[100:101], v16 offset:34816
    ds_read_b64_tr_b16 v[102:103], v16 offset:39424
    ds_read_b64_tr_b16 v[104:105], v16 offset:34848
    ds_read_b64_tr_b16 v[106:107], v16 offset:39456
    ds_read_b64_tr_b16 v[108:109], v16 offset:34880
    ds_read_b64_tr_b16 v[110:111], v16 offset:39488
    ds_read_b64_tr_b16 v[112:113], v16 offset:34912
    ds_read_b64_tr_b16 v[114:115], v16 offset:39520
    ds_read_b64_tr_b16 v[116:117], v16 offset:34944
    ds_read_b64_tr_b16 v[118:119], v16 offset:39552
    ds_read_b64_tr_b16 v[120:121], v16 offset:34976
    ds_read_b64_tr_b16 v[122:123], v16 offset:39584
    ds_read_b64_tr_b16 v[124:125], v16 offset:35008
    ds_read_b64_tr_b16 v[126:127], v16 offset:39616
    ds_read_b64_tr_b16 v[128:129], v16 offset:35040
    ds_read_b64_tr_b16 v[130:131], v16 offset:39648
    ds_read_b64_tr_b16 v[132:133], v16 offset:35072
    ds_read_b64_tr_b16 v[134:135], v16 offset:39680
    s_cmp_ge_u32 s42, 5
    s_cbranch_scc1 k1_kernel_gd_24
    s_add_u32 m0, s27, 17408
    s_nop 0
    buffer_load_dwordx4 v8, s[12:15], s25 offen lds
    s_add_u32 m0, s27, 18432
    s_nop 0
    buffer_load_dwordx4 v9, s[12:15], s25 offen lds
    s_add_u32 m0, s28, 17408
    s_nop 0
    buffer_load_dwordx4 v10, s[16:19], s26 offen lds
    s_add_u32 m0, s28, 21504
    s_nop 0
    buffer_load_dwordx4 v11, s[16:19], s26 offen lds
    s_cmp_ge_u32 s24, 1
    s_cbranch_scc1 k1_kernel_skipw_25
    s_add_u32 m0, s28, 25600
    s_nop 0
    buffer_load_dwordx4 v12, s[16:19], s26 offen lds
k1_kernel_skipw_25:
    s_add_u32 s25, s25, 64
    s_add_u32 s26, s26, 110592
k1_kernel_gd_24:
    s_waitcnt lgkmcnt(15)
    v_mfma_f32_16x16x32_bf16 v[20:23], v[92:95], v[100:103], v[20:23]
    v_mfma_f32_16x16x32_bf16 v[56:59], v[96:99], v[100:103], v[56:59]
    s_waitcnt lgkmcnt(14)
    v_mfma_f32_16x16x32_bf16 v[24:27], v[92:95], v[104:107], v[24:27]
    v_mfma_f32_16x16x32_bf16 v[60:63], v[96:99], v[104:107], v[60:63]
    s_waitcnt lgkmcnt(12)
    v_mfma_f32_16x16x32_bf16 v[28:31], v[92:95], v[108:111], v[28:31]
    v_mfma_f32_16x16x32_bf16 v[64:67], v[96:99], v[108:111], v[64:67]
    s_waitcnt lgkmcnt(10)
    v_mfma_f32_16x16x32_bf16 v[32:35], v[92:95], v[112:115], v[32:35]
    v_mfma_f32_16x16x32_bf16 v[68:71], v[96:99], v[112:115], v[68:71]
    s_waitcnt lgkmcnt(8)
    v_mfma_f32_16x16x32_bf16 v[36:39], v[92:95], v[116:119], v[36:39]
    v_mfma_f32_16x16x32_bf16 v[72:75], v[96:99], v[116:119], v[72:75]
    s_waitcnt lgkmcnt(6)
    v_mfma_f32_16x16x32_bf16 v[40:43], v[92:95], v[120:123], v[40:43]
    v_mfma_f32_16x16x32_bf16 v[76:79], v[96:99], v[120:123], v[76:79]
    s_waitcnt lgkmcnt(4)
    v_mfma_f32_16x16x32_bf16 v[44:47], v[92:95], v[124:127], v[44:47]
    v_mfma_f32_16x16x32_bf16 v[80:83], v[96:99], v[124:127], v[80:83]
    s_waitcnt lgkmcnt(2)
    v_mfma_f32_16x16x32_bf16 v[48:51], v[92:95], v[128:131], v[48:51]
    v_mfma_f32_16x16x32_bf16 v[84:87], v[96:99], v[128:131], v[84:87]
    s_waitcnt lgkmcnt(0)
    v_mfma_f32_16x16x32_bf16 v[52:55], v[92:95], v[132:135], v[52:55]
    v_mfma_f32_16x16x32_bf16 v[88:91], v[96:99], v[132:135], v[88:91]
    s_add_u32 s42, s42, 1
    s_cmp_lt_u32 s42, 6
    s_cbranch_scc1 k1_kernel_gloop_19
    s_barrier
    v_and_b32 v4, 1, v3
    v_lshlrev_b32 v4, 3, v4
    v_and_b32 v5, 2, v3
    v_lshl_add_u32 v4, v5, 1, v4
    v_lshl_add_u32 v4, s24, 5, v4
    v_lshlrev_b32 v4, 1, v4
    v_mul_u32_u24 v5, 272, v2
    v_add_u32 v4, v4, v5
    v_cvt_pk_bf16_f32 v100, v20, v21
    v_cvt_pk_bf16_f32 v101, v22, v23
    ds_write_b64 v4, v[100:101] offset:0
    v_cvt_pk_bf16_f32 v102, v24, v25
    v_cvt_pk_bf16_f32 v103, v26, v27
    ds_write_b64 v4, v[102:103] offset:4352
    v_cvt_pk_bf16_f32 v104, v28, v29
    v_cvt_pk_bf16_f32 v105, v30, v31
    ds_write_b64 v4, v[104:105] offset:8704
    v_cvt_pk_bf16_f32 v106, v32, v33
    v_cvt_pk_bf16_f32 v107, v34, v35
    ds_write_b64 v4, v[106:107] offset:13056
    v_cvt_pk_bf16_f32 v108, v36, v37
    v_cvt_pk_bf16_f32 v109, v38, v39
    ds_write_b64 v4, v[108:109] offset:17408
    v_cvt_pk_bf16_f32 v110, v40, v41
    v_cvt_pk_bf16_f32 v111, v42, v43
    ds_write_b64 v4, v[110:111] offset:21760
    v_cvt_pk_bf16_f32 v112, v44, v45
    v_cvt_pk_bf16_f32 v113, v46, v47
    ds_write_b64 v4, v[112:113] offset:26112
    v_cvt_pk_bf16_f32 v114, v48, v49
    v_cvt_pk_bf16_f32 v115, v50, v51
    ds_write_b64 v4, v[114:115] offset:30464
    v_cvt_pk_bf16_f32 v116, v52, v53
    v_cvt_pk_bf16_f32 v117, v54, v55
    ds_write_b64 v4, v[116:117] offset:34816
    v_cvt_pk_bf16_f32 v118, v56, v57
    v_cvt_pk_bf16_f32 v119, v58, v59
    ds_write_b64 v4, v[118:119] offset:32
    v_cvt_pk_bf16_f32 v120, v60, v61
    v_cvt_pk_bf16_f32 v121, v62, v63
    ds_write_b64 v4, v[120:121] offset:4384
    v_cvt_pk_bf16_f32 v122, v64, v65
    v_cvt_pk_bf16_f32 v123, v66, v67
    ds_write_b64 v4, v[122:123] offset:8736
    v_cvt_pk_bf16_f32 v124, v68, v69
    v_cvt_pk_bf16_f32 v125, v70, v71
    ds_write_b64 v4, v[124:125] offset:13088
    v_cvt_pk_bf16_f32 v126, v72, v73
    v_cvt_pk_bf16_f32 v127, v74, v75
    ds_write_b64 v4, v[126:127] offset:17440
    v_cvt_pk_bf16_f32 v128, v76, v77
    v_cvt_pk_bf16_f32 v129, v78, v79
    ds_write_b64 v4, v[128:129] offset:21792
    v_cvt_pk_bf16_f32 v130, v80, v81
    v_cvt_pk_bf16_f32 v131, v82, v83
    ds_write_b64 v4, v[130:131] offset:26144
    v_cvt_pk_bf16_f32 v100, v84, v85
    v_cvt_pk_bf16_f32 v101, v86, v87
    ds_write_b64 v4, v[100:101] offset:30496
    v_cvt_pk_bf16_f32 v102, v88, v89
    v_cvt_pk_bf16_f32 v103, v90, v91
    ds_write_b64 v4, v[102:103] offset:34848
    s_waitcnt lgkmcnt(0)
    s_barrier
    s_and_b32 s38, s30, 3
    s_lshl_b32 s38, s38, 3
    s_lshr_b32 s31, s39, 8
    s_lshl_b32 s32, s38, 3
    s_add_u32 s31, s31, s32
    s_mul_i32 s31, s31, 22528
    s_and_b32 s32, s39, 255
    s_lshl_b32 s32, s32, 1
    s_add_u32 s31, s31, s32
    s_add_u32 s31, s31, 4206592
    v_lshrrev_b32 v4, 4, v0
    v_and_b32 v5, 15, v0
    v_lshlrev_b32 v5, 4, v5
    s_mov_b32 s33, 180224
    v_add_u32 v6, 0, v4
    v_mul_u32_u24 v116, 272, v6
    v_add_u32 v116, v116, v5
    ds_read_b128 v[100:103], v116
    v_mul_u32_u24 v117, 57, v6
    v_lshrrev_b32 v117, 10, v117
    v_mul_u32_u24 v116, 18, v117
    v_sub_u32 v6, v6, v116
    v_mul_lo_u32 v117, v117, s33
    v_mul_u32_u24 v6, 528, v6
    v_add_u32 v117, v117, v6
    v_add_u32 v117, v117, v5
    s_waitcnt lgkmcnt(0)
    buffer_store_dwordx4 v[100:103], v117, s[20:23], s31 offen
    v_add_u32 v6, 16, v4
    v_mul_u32_u24 v116, 272, v6
    v_add_u32 v116, v116, v5
    ds_read_b128 v[104:107], v116
    v_mul_u32_u24 v117, 57, v6
    v_lshrrev_b32 v117, 10, v117
    v_mul_u32_u24 v116, 18, v117
    v_sub_u32 v6, v6, v116
    v_mul_lo_u32 v117, v117, s33
    v_mul_u32_u24 v6, 528, v6
    v_add_u32 v117, v117, v6
    v_add_u32 v117, v117, v5
    s_waitcnt lgkmcnt(0)
    buffer_store_dwordx4 v[104:107], v117, s[20:23], s31 offen
    v_add_u32 v6, 32, v4
    v_mul_u32_u24 v116, 272, v6
    v_add_u32 v116, v116, v5
    ds_read_b128 v[108:111], v116
    v_mul_u32_u24 v117, 57, v6
    v_lshrrev_b32 v117, 10, v117
    v_mul_u32_u24 v116, 18, v117
    v_sub_u32 v6, v6, v116
    v_mul_lo_u32 v117, v117, s33
    v_mul_u32_u24 v6, 528, v6
    v_add_u32 v117, v117, v6
    v_add_u32 v117, v117, v5
    s_waitcnt lgkmcnt(0)
    buffer_store_dwordx4 v[108:111], v117, s[20:23], s31 offen
    v_add_u32 v6, 48, v4
    v_mul_u32_u24 v116, 272, v6
    v_add_u32 v116, v116, v5
    ds_read_b128 v[112:115], v116
    v_mul_u32_u24 v117, 57, v6
    v_lshrrev_b32 v117, 10, v117
    v_mul_u32_u24 v116, 18, v117
    v_sub_u32 v6, v6, v116
    v_mul_lo_u32 v117, v117, s33
    v_mul_u32_u24 v6, 528, v6
    v_add_u32 v117, v117, v6
    v_add_u32 v117, v117, v5
    s_waitcnt lgkmcnt(0)
    buffer_store_dwordx4 v[112:115], v117, s[20:23], s31 offen
    v_add_u32 v6, 64, v4
    v_mul_u32_u24 v116, 272, v6
    v_add_u32 v116, v116, v5
    ds_read_b128 v[100:103], v116
    v_mul_u32_u24 v117, 57, v6
    v_lshrrev_b32 v117, 10, v117
    v_mul_u32_u24 v116, 18, v117
    v_sub_u32 v6, v6, v116
    v_mul_lo_u32 v117, v117, s33
    v_mul_u32_u24 v6, 528, v6
    v_add_u32 v117, v117, v6
    v_add_u32 v117, v117, v5
    s_waitcnt lgkmcnt(0)
    buffer_store_dwordx4 v[100:103], v117, s[20:23], s31 offen
    v_add_u32 v6, 80, v4
    v_mul_u32_u24 v116, 272, v6
    v_add_u32 v116, v116, v5
    ds_read_b128 v[104:107], v116
    v_mul_u32_u24 v117, 57, v6
    v_lshrrev_b32 v117, 10, v117
    v_mul_u32_u24 v116, 18, v117
    v_sub_u32 v6, v6, v116
    v_mul_lo_u32 v117, v117, s33
    v_mul_u32_u24 v6, 528, v6
    v_add_u32 v117, v117, v6
    v_add_u32 v117, v117, v5
    s_waitcnt lgkmcnt(0)
    buffer_store_dwordx4 v[104:107], v117, s[20:23], s31 offen
    v_add_u32 v6, 96, v4
    v_mul_u32_u24 v116, 272, v6
    v_add_u32 v116, v116, v5
    ds_read_b128 v[108:111], v116
    v_mul_u32_u24 v117, 57, v6
    v_lshrrev_b32 v117, 10, v117
    v_mul_u32_u24 v116, 18, v117
    v_sub_u32 v6, v6, v116
    v_mul_lo_u32 v117, v117, s33
    v_mul_u32_u24 v6, 528, v6
    v_add_u32 v117, v117, v6
    v_add_u32 v117, v117, v5
    s_waitcnt lgkmcnt(0)
    buffer_store_dwordx4 v[108:111], v117, s[20:23], s31 offen
    v_add_u32 v6, 112, v4
    v_mul_u32_u24 v116, 272, v6
    v_add_u32 v116, v116, v5
    ds_read_b128 v[112:115], v116
    v_mul_u32_u24 v117, 57, v6
    v_lshrrev_b32 v117, 10, v117
    v_mul_u32_u24 v116, 18, v117
    v_sub_u32 v6, v6, v116
    v_mul_lo_u32 v117, v117, s33
    v_mul_u32_u24 v6, 528, v6
    v_add_u32 v117, v117, v6
    v_add_u32 v117, v117, v5
    s_waitcnt lgkmcnt(0)
    buffer_store_dwordx4 v[112:115], v117, s[20:23], s31 offen
    v_add_u32 v6, 128, v4
    v_mul_u32_u24 v116, 272, v6
    v_add_u32 v116, v116, v5
    ds_read_b128 v[100:103], v116
    v_mul_u32_u24 v117, 57, v6
    v_lshrrev_b32 v117, 10, v117
    v_mul_u32_u24 v116, 18, v117
    v_sub_u32 v6, v6, v116
    v_mul_lo_u32 v117, v117, s33
    v_mul_u32_u24 v6, 528, v6
    v_add_u32 v117, v117, v6
    v_add_u32 v117, v117, v5
    s_waitcnt lgkmcnt(0)
    buffer_store_dwordx4 v[100:103], v117, s[20:23], s31 offen
    v_cmp_gt_u32 vcc, 128, v0
    s_nop 1
    s_and_saveexec_b64 s[36:37], vcc
    v_mul_lo_u32 v6, v4, s33
    v_add_u32 v6, 9504, v6
    v_add_u32 v6, v6, v5
    v_mov_b32 v100, 0x3F803F80
    v_mov_b32 v101, 0x3F803F80
    v_mov_b32 v102, 0x3F803F80
    v_mov_b32 v103, 0x3F803F80
    buffer_store_dwordx4 v[100:103], v6, s[20:23], s31 offen
    s_mov_b64 exec, s[36:37]
k1_kernel_gend_6:
    s_waitcnt vmcnt(0)
    s_endpgm
k1_kernel_kgen_1:
    s_load_dwordx2 s[44:45], s[0:1], 32
    s_load_dwordx2 s[48:49], s[0:1], 40
    s_load_dwordx2 s[52:53], s[0:1], 48
    s_load_dwordx2 s[56:57], s[0:1], 56
    s_load_dwordx2 s[60:61], s[0:1], 64
    s_waitcnt lgkmcnt(0)
    s_mov_b32 s46, 147456
    s_mov_b32 s47, 0x00020000
    s_mov_b32 s50, 147456
    s_mov_b32 s51, 0x00020000
    s_mov_b32 s54, 147456
    s_mov_b32 s55, 0x00020000
    s_mov_b32 s58, 147456
    s_mov_b32 s59, 0x00020000
    s_mov_b32 s62, 1152
    s_mov_b32 s63, 0x00020000
    v_and_b32 v1, 63, v0
    v_and_b32 v2, 15, v0
    v_lshrrev_b32 v3, 4, v1
    v_lshrrev_b32 v4, 6, v0
    s_nop 0
    v_readfirstlane_b32 s24, v4
    s_sub_u32 s29, s2, 192
    v_and_b32 v4, 127, v0
    v_lshlrev_b32 v4, 1, v4
    s_lshl_b32 s31, s29, 8
    buffer_load_ushort v5, v4, s[44:47], s31 offen
    buffer_load_ushort v6, v4, s[48:51], s31 offen
    buffer_load_ushort v7, v4, s[52:55], s31 offen
    buffer_load_ushort v8, v4, s[56:59], s31 offen
    s_lshl_b32 s32, s29, 1
    v_mov_b32 v9, 0
    buffer_load_ushort v9, v9, s[60:63], s32 offen
    s_waitcnt vmcnt(4)
    v_lshlrev_b32 v5, 16, v5
    s_waitcnt vmcnt(3)
    v_lshlrev_b32 v6, 16, v6
    s_waitcnt vmcnt(2)
    v_lshlrev_b32 v7, 16, v7
    s_waitcnt vmcnt(1)
    v_lshlrev_b32 v8, 16, v8
    s_waitcnt vmcnt(0)
    v_lshlrev_b32 v9, 16, v9
    v_mul_f32 v9, 1069066811, v9
    v_exp_f32 v9, v9
    s_nop 0
    v_cvt_pk_bf16_f32 v10, v9, v9
    v_lshlrev_b32 v9, 16, v10
    v_mul_f32 v5, 1069066811, v5
    v_exp_f32 v5, v5
    s_nop 0
    v_cvt_pk_bf16_f32 v10, v5, v5
    v_lshlrev_b32 v5, 16, v10
    v_mul_f32 v16, v5, v9
    v_mul_f32 v16, 3216550459, v16
    v_mul_f32 v17, v6, v9
    v_mul_f32 v17, 1042479491, v17
    v_mul_f32 v18, v7, v9
    v_add_f32 v18, v18, v18
    v_mul_f32 v19, v8, v9
    v_add_f32 v19, v19, v19
    v_lshlrev_b32 v4, 3, v4
    ds_write_b128 v4, v[16:19]
    s_waitcnt lgkmcnt(0)
    s_barrier
    v_lshlrev_b32 v21, 3, v2
    v_lshrrev_b32 v4, 3, v2
    v_lshlrev_b32 v4, 7, v4
    v_and_b32 v5, 7, v2
    v_add_u32 v20, v4, v5
    v_lshrrev_b32 v4, 2, v2
    v_lshlrev_b32 v4, 7, v4
    v_and_b32 v5, 3, v2
    v_lshl_add_u32 v4, v5, 1, v4
    v_add_u32 v4, 256, v4
    v_lshrrev_b32 v5, 1, v2
    v_lshlrev_b32 v5, 7, v5
    v_and_b32 v6, 1, v2
    v_lshl_add_u32 v5, v6, 2, v5
    v_cmp_gt_u32 vcc, 8, v2
    s_nop 1
    v_cndmask_b32 v44, v5, v4, vcc
    v_lshlrev_b32 v45, 7, v2
    v_add_u32 v45, 1024, v45
    v_cvt_f32_u32 v21, v21
    v_cvt_f32_u32 v20, v20
    v_cvt_f32_u32 v44, v44
    v_cvt_f32_u32 v45, v45
    v_mov_b32 v24, 0
    v_mov_b32 v25, 0
    v_mov_b32 v26, 0
    v_mov_b32 v27, 0
    v_mov_b32 v48, 0
    v_mov_b32 v49, 0
    v_mov_b32 v50, 0
    v_mov_b32 v51, 0
    v_mov_b32 v52, 0
    v_mov_b32 v53, 0
    v_mov_b32 v54, 0
    v_mov_b32 v55, 0
    v_lshlrev_b32 v56, 6, v3
    s_lshl_b32 s31, s24, 9
    v_add_u32 v56, s31, v56
    ds_read_b128 v[60:63], v56 offset:0
    ds_read_b128 v[64:67], v56 offset:16
    ds_read_b128 v[68:71], v56 offset:32
    ds_read_b128 v[72:75], v56 offset:48
    s_waitcnt lgkmcnt(3)
    v_mul_f32 v11, v60, v21
    v_exp_f32 v11, v11
    v_mul_f32 v13, v61, v21
    v_fract_f32 v13, v13
    v_sin_f32 v12, v13
    v_cos_f32 v13, v13
    v_mul_f32 v12, v11, v12
    v_mul_f32 v11, v11, v13
    v_cvt_pk_bf16_f32 v36, v11, v12
    v_lshlrev_b32 v14, 16, v36
    v_and_b32 v15, 0xffff0000, v36
    v_sub_f32 v14, v11, v14
    v_sub_f32 v15, v12, v15
    v_cvt_pk_bf16_f32 v40, v14, v15
    s_waitcnt lgkmcnt(2)
    v_mul_f32 v11, v64, v21
    v_exp_f32 v11, v11
    v_mul_f32 v13, v65, v21
    v_fract_f32 v13, v13
    v_sin_f32 v12, v13
    v_cos_f32 v13, v13
    v_mul_f32 v12, v11, v12
    v_mul_f32 v11, v11, v13
    v_cvt_pk_bf16_f32 v37, v11, v12
    v_lshlrev_b32 v14, 16, v37
    v_and_b32 v15, 0xffff0000, v37
    v_sub_f32 v14, v11, v14
    v_sub_f32 v15, v12, v15
    v_cvt_pk_bf16_f32 v41, v14, v15
    s_waitcnt lgkmcnt(1)
    v_mul_f32 v11, v68, v21
    v_exp_f32 v11, v11
    v_mul_f32 v13, v69, v21
    v_fract_f32 v13, v13
    v_sin_f32 v12, v13
    v_cos_f32 v13, v13
    v_mul_f32 v12, v11, v12
    v_mul_f32 v11, v11, v13
    v_cvt_pk_bf16_f32 v38, v11, v12
    v_lshlrev_b32 v14, 16, v38
    v_and_b32 v15, 0xffff0000, v38
    v_sub_f32 v14, v11, v14
    v_sub_f32 v15, v12, v15
    v_cvt_pk_bf16_f32 v42, v14, v15
    s_waitcnt lgkmcnt(0)
    v_mul_f32 v11, v72, v21
    v_exp_f32 v11, v11
    v_mul_f32 v13, v73, v21
    v_fract_f32 v13, v13
    v_sin_f32 v12, v13
    v_cos_f32 v13, v13
    v_mul_f32 v12, v11, v12
    v_mul_f32 v11, v11, v13
    v_cvt_pk_bf16_f32 v39, v11, v12
    v_lshlrev_b32 v14, 16, v39
    v_and_b32 v15, 0xffff0000, v39
    v_sub_f32 v14, v11, v14
    v_sub_f32 v15, v12, v15
    v_cvt_pk_bf16_f32 v43, v14, v15
    v_mul_f32 v4, v60, v20
    v_exp_f32 v4, v4
    v_mul_f32 v6, v61, v20
    v_fract_f32 v6, v6
    v_sin_f32 v5, v6
    v_cos_f32 v6, v6
    v_mul_f32 v5, v4, v5
    v_mul_f32 v4, v4, v6
    v_mul_f32 v7, v62, v4
    v_fma_f32 v7, -v63, v5, v7
    v_mul_f32 v8, v62, v5
    v_fma_f32 v8, v63, v4, v8
    v_sub_f32 v8, 0, v8
    v_cvt_pk_bf16_f32 v28, v7, v8
    v_lshlrev_b32 v9, 16, v28
    v_and_b32 v10, 0xffff0000, v28
    v_sub_f32 v9, v7, v9
    v_sub_f32 v10, v8, v10
    v_cvt_pk_bf16_f32 v32, v9, v10
    v_mul_f32 v4, v64, v20
    v_exp_f32 v4, v4
    v_mul_f32 v6, v65, v20
    v_fract_f32 v6, v6
    v_sin_f32 v5, v6
    v_cos_f32 v6, v6
    v_mul_f32 v5, v4, v5
    v_mul_f32 v4, v4, v6
    v_mul_f32 v7, v66, v4
    v_fma_f32 v7, -v67, v5, v7
    v_mul_f32 v8, v66, v5
    v_fma_f32 v8, v67, v4, v8
    v_sub_f32 v8, 0, v8
    v_cvt_pk_bf16_f32 v29, v7, v8
    v_lshlrev_b32 v9, 16, v29
    v_and_b32 v10, 0xffff0000, v29
    v_sub_f32 v9, v7, v9
    v_sub_f32 v10, v8, v10
    v_cvt_pk_bf16_f32 v33, v9, v10
    v_mul_f32 v4, v68, v20
    v_exp_f32 v4, v4
    v_mul_f32 v6, v69, v20
    v_fract_f32 v6, v6
    v_sin_f32 v5, v6
    v_cos_f32 v6, v6
    v_mul_f32 v5, v4, v5
    v_mul_f32 v4, v4, v6
    v_mul_f32 v7, v70, v4
    v_fma_f32 v7, -v71, v5, v7
    v_mul_f32 v8, v70, v5
    v_fma_f32 v8, v71, v4, v8
    v_sub_f32 v8, 0, v8
    v_cvt_pk_bf16_f32 v30, v7, v8
    v_lshlrev_b32 v9, 16, v30
    v_and_b32 v10, 0xffff0000, v30
    v_sub_f32 v9, v7, v9
    v_sub_f32 v10, v8, v10
    v_cvt_pk_bf16_f32 v34, v9, v10
    v_mul_f32 v4, v72, v20
    v_exp_f32 v4, v4
    v_mul_f32 v6, v73, v20
    v_fract_f32 v6, v6
    v_sin_f32 v5, v6
    v_cos_f32 v6, v6
    v_mul_f32 v5, v4, v5
    v_mul_f32 v4, v4, v6
    v_mul_f32 v7, v74, v4
    v_fma_f32 v7, -v75, v5, v7
    v_mul_f32 v8, v74, v5
    v_fma_f32 v8, v75, v4, v8
    v_sub_f32 v8, 0, v8
    v_cvt_pk_bf16_f32 v31, v7, v8
    v_lshlrev_b32 v9, 16, v31
    v_and_b32 v10, 0xffff0000, v31
    v_sub_f32 v9, v7, v9
    v_sub_f32 v10, v8, v10
    v_cvt_pk_bf16_f32 v35, v9, v10
    v_mfma_f32_16x16x32_bf16 v[24:27], v[28:31], v[36:39], v[24:27]
    v_mfma_f32_16x16x32_bf16 v[24:27], v[28:31], v[40:43], v[24:27]
    v_mfma_f32_16x16x32_bf16 v[24:27], v[32:35], v[36:39], v[24:27]
    v_mul_f32 v4, v60, v44
    v_exp_f32 v4, v4
    v_mul_f32 v6, v61, v44
    v_fract_f32 v6, v6
    v_sin_f32 v5, v6
    v_cos_f32 v6, v6
    v_mul_f32 v5, v4, v5
    v_mul_f32 v4, v4, v6
    v_mul_f32 v7, v62, v4
    v_fma_f32 v7, -v63, v5, v7
    v_mul_f32 v8, v62, v5
    v_fma_f32 v8, v63, v4, v8
    v_sub_f32 v8, 0, v8
    v_cvt_pk_bf16_f32 v28, v7, v8
    v_lshlrev_b32 v9, 16, v28
    v_and_b32 v10, 0xffff0000, v28
    v_sub_f32 v9, v7, v9
    v_sub_f32 v10, v8, v10
    v_cvt_pk_bf16_f32 v32, v9, v10
    v_mul_f32 v4, v64, v44
    v_exp_f32 v4, v4
    v_mul_f32 v6, v65, v44
    v_fract_f32 v6, v6
    v_sin_f32 v5, v6
    v_cos_f32 v6, v6
    v_mul_f32 v5, v4, v5
    v_mul_f32 v4, v4, v6
    v_mul_f32 v7, v66, v4
    v_fma_f32 v7, -v67, v5, v7
    v_mul_f32 v8, v66, v5
    v_fma_f32 v8, v67, v4, v8
    v_sub_f32 v8, 0, v8
    v_cvt_pk_bf16_f32 v29, v7, v8
    v_lshlrev_b32 v9, 16, v29
    v_and_b32 v10, 0xffff0000, v29
    v_sub_f32 v9, v7, v9
    v_sub_f32 v10, v8, v10
    v_cvt_pk_bf16_f32 v33, v9, v10
    v_mul_f32 v4, v68, v44
    v_exp_f32 v4, v4
    v_mul_f32 v6, v69, v44
    v_fract_f32 v6, v6
    v_sin_f32 v5, v6
    v_cos_f32 v6, v6
    v_mul_f32 v5, v4, v5
    v_mul_f32 v4, v4, v6
    v_mul_f32 v7, v70, v4
    v_fma_f32 v7, -v71, v5, v7
    v_mul_f32 v8, v70, v5
    v_fma_f32 v8, v71, v4, v8
    v_sub_f32 v8, 0, v8
    v_cvt_pk_bf16_f32 v30, v7, v8
    v_lshlrev_b32 v9, 16, v30
    v_and_b32 v10, 0xffff0000, v30
    v_sub_f32 v9, v7, v9
    v_sub_f32 v10, v8, v10
    v_cvt_pk_bf16_f32 v34, v9, v10
    v_mul_f32 v4, v72, v44
    v_exp_f32 v4, v4
    v_mul_f32 v6, v73, v44
    v_fract_f32 v6, v6
    v_sin_f32 v5, v6
    v_cos_f32 v6, v6
    v_mul_f32 v5, v4, v5
    v_mul_f32 v4, v4, v6
    v_mul_f32 v7, v74, v4
    v_fma_f32 v7, -v75, v5, v7
    v_mul_f32 v8, v74, v5
    v_fma_f32 v8, v75, v4, v8
    v_sub_f32 v8, 0, v8
    v_cvt_pk_bf16_f32 v31, v7, v8
    v_lshlrev_b32 v9, 16, v31
    v_and_b32 v10, 0xffff0000, v31
    v_sub_f32 v9, v7, v9
    v_sub_f32 v10, v8, v10
    v_cvt_pk_bf16_f32 v35, v9, v10
    v_mfma_f32_16x16x32_bf16 v[48:51], v[28:31], v[36:39], v[48:51]
    v_mfma_f32_16x16x32_bf16 v[48:51], v[28:31], v[40:43], v[48:51]
    v_mfma_f32_16x16x32_bf16 v[48:51], v[32:35], v[36:39], v[48:51]
    v_mul_f32 v4, v60, v45
    v_exp_f32 v4, v4
    v_mul_f32 v6, v61, v45
    v_fract_f32 v6, v6
    v_sin_f32 v5, v6
    v_cos_f32 v6, v6
    v_mul_f32 v5, v4, v5
    v_mul_f32 v4, v4, v6
    v_mul_f32 v7, v62, v4
    v_fma_f32 v7, -v63, v5, v7
    v_mul_f32 v8, v62, v5
    v_fma_f32 v8, v63, v4, v8
    v_sub_f32 v8, 0, v8
    v_cvt_pk_bf16_f32 v28, v7, v8
    v_lshlrev_b32 v9, 16, v28
    v_and_b32 v10, 0xffff0000, v28
    v_sub_f32 v9, v7, v9
    v_sub_f32 v10, v8, v10
    v_cvt_pk_bf16_f32 v32, v9, v10
    v_mul_f32 v4, v64, v45
    v_exp_f32 v4, v4
    v_mul_f32 v6, v65, v45
    v_fract_f32 v6, v6
    v_sin_f32 v5, v6
    v_cos_f32 v6, v6
    v_mul_f32 v5, v4, v5
    v_mul_f32 v4, v4, v6
    v_mul_f32 v7, v66, v4
    v_fma_f32 v7, -v67, v5, v7
    v_mul_f32 v8, v66, v5
    v_fma_f32 v8, v67, v4, v8
    v_sub_f32 v8, 0, v8
    v_cvt_pk_bf16_f32 v29, v7, v8
    v_lshlrev_b32 v9, 16, v29
    v_and_b32 v10, 0xffff0000, v29
    v_sub_f32 v9, v7, v9
    v_sub_f32 v10, v8, v10
    v_cvt_pk_bf16_f32 v33, v9, v10
    v_mul_f32 v4, v68, v45
    v_exp_f32 v4, v4
    v_mul_f32 v6, v69, v45
    v_fract_f32 v6, v6
    v_sin_f32 v5, v6
    v_cos_f32 v6, v6
    v_mul_f32 v5, v4, v5
    v_mul_f32 v4, v4, v6
    v_mul_f32 v7, v70, v4
    v_fma_f32 v7, -v71, v5, v7
    v_mul_f32 v8, v70, v5
    v_fma_f32 v8, v71, v4, v8
    v_sub_f32 v8, 0, v8
    v_cvt_pk_bf16_f32 v30, v7, v8
    v_lshlrev_b32 v9, 16, v30
    v_and_b32 v10, 0xffff0000, v30
    v_sub_f32 v9, v7, v9
    v_sub_f32 v10, v8, v10
    v_cvt_pk_bf16_f32 v34, v9, v10
    v_mul_f32 v4, v72, v45
    v_exp_f32 v4, v4
    v_mul_f32 v6, v73, v45
    v_fract_f32 v6, v6
    v_sin_f32 v5, v6
    v_cos_f32 v6, v6
    v_mul_f32 v5, v4, v5
    v_mul_f32 v4, v4, v6
    v_mul_f32 v7, v74, v4
    v_fma_f32 v7, -v75, v5, v7
    v_mul_f32 v8, v74, v5
    v_fma_f32 v8, v75, v4, v8
    v_sub_f32 v8, 0, v8
    v_cvt_pk_bf16_f32 v31, v7, v8
    v_lshlrev_b32 v9, 16, v31
    v_and_b32 v10, 0xffff0000, v31
    v_sub_f32 v9, v7, v9
    v_sub_f32 v10, v8, v10
    v_cvt_pk_bf16_f32 v35, v9, v10
    v_mfma_f32_16x16x32_bf16 v[52:55], v[28:31], v[36:39], v[52:55]
    v_mfma_f32_16x16x32_bf16 v[52:55], v[28:31], v[40:43], v[52:55]
    v_mfma_f32_16x16x32_bf16 v[52:55], v[32:35], v[36:39], v[52:55]
    ds_read_b128 v[60:63], v56 offset:256
    ds_read_b128 v[64:67], v56 offset:272
    ds_read_b128 v[68:71], v56 offset:288
    ds_read_b128 v[72:75], v56 offset:304
    s_waitcnt lgkmcnt(3)
    v_mul_f32 v11, v60, v21
    v_exp_f32 v11, v11
    v_mul_f32 v13, v61, v21
    v_fract_f32 v13, v13
    v_sin_f32 v12, v13
    v_cos_f32 v13, v13
    v_mul_f32 v12, v11, v12
    v_mul_f32 v11, v11, v13
    v_cvt_pk_bf16_f32 v36, v11, v12
    v_lshlrev_b32 v14, 16, v36
    v_and_b32 v15, 0xffff0000, v36
    v_sub_f32 v14, v11, v14
    v_sub_f32 v15, v12, v15
    v_cvt_pk_bf16_f32 v40, v14, v15
    s_waitcnt lgkmcnt(2)
    v_mul_f32 v11, v64, v21
    v_exp_f32 v11, v11
    v_mul_f32 v13, v65, v21
    v_fract_f32 v13, v13
    v_sin_f32 v12, v13
    v_cos_f32 v13, v13
    v_mul_f32 v12, v11, v12
    v_mul_f32 v11, v11, v13
    v_cvt_pk_bf16_f32 v37, v11, v12
    v_lshlrev_b32 v14, 16, v37
    v_and_b32 v15, 0xffff0000, v37
    v_sub_f32 v14, v11, v14
    v_sub_f32 v15, v12, v15
    v_cvt_pk_bf16_f32 v41, v14, v15
    s_waitcnt lgkmcnt(1)
    v_mul_f32 v11, v68, v21
    v_exp_f32 v11, v11
    v_mul_f32 v13, v69, v21
    v_fract_f32 v13, v13
    v_sin_f32 v12, v13
    v_cos_f32 v13, v13
    v_mul_f32 v12, v11, v12
    v_mul_f32 v11, v11, v13
    v_cvt_pk_bf16_f32 v38, v11, v12
    v_lshlrev_b32 v14, 16, v38
    v_and_b32 v15, 0xffff0000, v38
    v_sub_f32 v14, v11, v14
    v_sub_f32 v15, v12, v15
    v_cvt_pk_bf16_f32 v42, v14, v15
    s_waitcnt lgkmcnt(0)
    v_mul_f32 v11, v72, v21
    v_exp_f32 v11, v11
    v_mul_f32 v13, v73, v21
    v_fract_f32 v13, v13
    v_sin_f32 v12, v13
    v_cos_f32 v13, v13
    v_mul_f32 v12, v11, v12
    v_mul_f32 v11, v11, v13
    v_cvt_pk_bf16_f32 v39, v11, v12
    v_lshlrev_b32 v14, 16, v39
    v_and_b32 v15, 0xffff0000, v39
    v_sub_f32 v14, v11, v14
    v_sub_f32 v15, v12, v15
    v_cvt_pk_bf16_f32 v43, v14, v15
    v_mul_f32 v4, v60, v20
    v_exp_f32 v4, v4
    v_mul_f32 v6, v61, v20
    v_fract_f32 v6, v6
    v_sin_f32 v5, v6
    v_cos_f32 v6, v6
    v_mul_f32 v5, v4, v5
    v_mul_f32 v4, v4, v6
    v_mul_f32 v7, v62, v4
    v_fma_f32 v7, -v63, v5, v7
    v_mul_f32 v8, v62, v5
    v_fma_f32 v8, v63, v4, v8
    v_sub_f32 v8, 0, v8
    v_cvt_pk_bf16_f32 v28, v7, v8
    v_lshlrev_b32 v9, 16, v28
    v_and_b32 v10, 0xffff0000, v28
    v_sub_f32 v9, v7, v9
    v_sub_f32 v10, v8, v10
    v_cvt_pk_bf16_f32 v32, v9, v10
    v_mul_f32 v4, v64, v20
    v_exp_f32 v4, v4
    v_mul_f32 v6, v65, v20
    v_fract_f32 v6, v6
    v_sin_f32 v5, v6
    v_cos_f32 v6, v6
    v_mul_f32 v5, v4, v5
    v_mul_f32 v4, v4, v6
    v_mul_f32 v7, v66, v4
    v_fma_f32 v7, -v67, v5, v7
    v_mul_f32 v8, v66, v5
    v_fma_f32 v8, v67, v4, v8
    v_sub_f32 v8, 0, v8
    v_cvt_pk_bf16_f32 v29, v7, v8
    v_lshlrev_b32 v9, 16, v29
    v_and_b32 v10, 0xffff0000, v29
    v_sub_f32 v9, v7, v9
    v_sub_f32 v10, v8, v10
    v_cvt_pk_bf16_f32 v33, v9, v10
    v_mul_f32 v4, v68, v20
    v_exp_f32 v4, v4
    v_mul_f32 v6, v69, v20
    v_fract_f32 v6, v6
    v_sin_f32 v5, v6
    v_cos_f32 v6, v6
    v_mul_f32 v5, v4, v5
    v_mul_f32 v4, v4, v6
    v_mul_f32 v7, v70, v4
    v_fma_f32 v7, -v71, v5, v7
    v_mul_f32 v8, v70, v5
    v_fma_f32 v8, v71, v4, v8
    v_sub_f32 v8, 0, v8
    v_cvt_pk_bf16_f32 v30, v7, v8
    v_lshlrev_b32 v9, 16, v30
    v_and_b32 v10, 0xffff0000, v30
    v_sub_f32 v9, v7, v9
    v_sub_f32 v10, v8, v10
    v_cvt_pk_bf16_f32 v34, v9, v10
    v_mul_f32 v4, v72, v20
    v_exp_f32 v4, v4
    v_mul_f32 v6, v73, v20
    v_fract_f32 v6, v6
    v_sin_f32 v5, v6
    v_cos_f32 v6, v6
    v_mul_f32 v5, v4, v5
    v_mul_f32 v4, v4, v6
    v_mul_f32 v7, v74, v4
    v_fma_f32 v7, -v75, v5, v7
    v_mul_f32 v8, v74, v5
    v_fma_f32 v8, v75, v4, v8
    v_sub_f32 v8, 0, v8
    v_cvt_pk_bf16_f32 v31, v7, v8
    v_lshlrev_b32 v9, 16, v31
    v_and_b32 v10, 0xffff0000, v31
    v_sub_f32 v9, v7, v9
    v_sub_f32 v10, v8, v10
    v_cvt_pk_bf16_f32 v35, v9, v10
    v_mfma_f32_16x16x32_bf16 v[24:27], v[28:31], v[36:39], v[24:27]
    v_mfma_f32_16x16x32_bf16 v[24:27], v[28:31], v[40:43], v[24:27]
    v_mfma_f32_16x16x32_bf16 v[24:27], v[32:35], v[36:39], v[24:27]
    v_mul_f32 v4, v60, v44
    v_exp_f32 v4, v4
    v_mul_f32 v6, v61, v44
    v_fract_f32 v6, v6
    v_sin_f32 v5, v6
    v_cos_f32 v6, v6
    v_mul_f32 v5, v4, v5
    v_mul_f32 v4, v4, v6
    v_mul_f32 v7, v62, v4
    v_fma_f32 v7, -v63, v5, v7
    v_mul_f32 v8, v62, v5
    v_fma_f32 v8, v63, v4, v8
    v_sub_f32 v8, 0, v8
    v_cvt_pk_bf16_f32 v28, v7, v8
    v_lshlrev_b32 v9, 16, v28
    v_and_b32 v10, 0xffff0000, v28
    v_sub_f32 v9, v7, v9
    v_sub_f32 v10, v8, v10
    v_cvt_pk_bf16_f32 v32, v9, v10
    v_mul_f32 v4, v64, v44
    v_exp_f32 v4, v4
    v_mul_f32 v6, v65, v44
    v_fract_f32 v6, v6
    v_sin_f32 v5, v6
    v_cos_f32 v6, v6
    v_mul_f32 v5, v4, v5
    v_mul_f32 v4, v4, v6
    v_mul_f32 v7, v66, v4
    v_fma_f32 v7, -v67, v5, v7
    v_mul_f32 v8, v66, v5
    v_fma_f32 v8, v67, v4, v8
    v_sub_f32 v8, 0, v8
    v_cvt_pk_bf16_f32 v29, v7, v8
    v_lshlrev_b32 v9, 16, v29
    v_and_b32 v10, 0xffff0000, v29
    v_sub_f32 v9, v7, v9
    v_sub_f32 v10, v8, v10
    v_cvt_pk_bf16_f32 v33, v9, v10
    v_mul_f32 v4, v68, v44
    v_exp_f32 v4, v4
    v_mul_f32 v6, v69, v44
    v_fract_f32 v6, v6
    v_sin_f32 v5, v6
    v_cos_f32 v6, v6
    v_mul_f32 v5, v4, v5
    v_mul_f32 v4, v4, v6
    v_mul_f32 v7, v70, v4
    v_fma_f32 v7, -v71, v5, v7
    v_mul_f32 v8, v70, v5
    v_fma_f32 v8, v71, v4, v8
    v_sub_f32 v8, 0, v8
    v_cvt_pk_bf16_f32 v30, v7, v8
    v_lshlrev_b32 v9, 16, v30
    v_and_b32 v10, 0xffff0000, v30
    v_sub_f32 v9, v7, v9
    v_sub_f32 v10, v8, v10
    v_cvt_pk_bf16_f32 v34, v9, v10
    v_mul_f32 v4, v72, v44
    v_exp_f32 v4, v4
    v_mul_f32 v6, v73, v44
    v_fract_f32 v6, v6
    v_sin_f32 v5, v6
    v_cos_f32 v6, v6
    v_mul_f32 v5, v4, v5
    v_mul_f32 v4, v4, v6
    v_mul_f32 v7, v74, v4
    v_fma_f32 v7, -v75, v5, v7
    v_mul_f32 v8, v74, v5
    v_fma_f32 v8, v75, v4, v8
    v_sub_f32 v8, 0, v8
    v_cvt_pk_bf16_f32 v31, v7, v8
    v_lshlrev_b32 v9, 16, v31
    v_and_b32 v10, 0xffff0000, v31
    v_sub_f32 v9, v7, v9
    v_sub_f32 v10, v8, v10
    v_cvt_pk_bf16_f32 v35, v9, v10
    v_mfma_f32_16x16x32_bf16 v[48:51], v[28:31], v[36:39], v[48:51]
    v_mfma_f32_16x16x32_bf16 v[48:51], v[28:31], v[40:43], v[48:51]
    v_mfma_f32_16x16x32_bf16 v[48:51], v[32:35], v[36:39], v[48:51]
    v_mul_f32 v4, v60, v45
    v_exp_f32 v4, v4
    v_mul_f32 v6, v61, v45
    v_fract_f32 v6, v6
    v_sin_f32 v5, v6
    v_cos_f32 v6, v6
    v_mul_f32 v5, v4, v5
    v_mul_f32 v4, v4, v6
    v_mul_f32 v7, v62, v4
    v_fma_f32 v7, -v63, v5, v7
    v_mul_f32 v8, v62, v5
    v_fma_f32 v8, v63, v4, v8
    v_sub_f32 v8, 0, v8
    v_cvt_pk_bf16_f32 v28, v7, v8
    v_lshlrev_b32 v9, 16, v28
    v_and_b32 v10, 0xffff0000, v28
    v_sub_f32 v9, v7, v9
    v_sub_f32 v10, v8, v10
    v_cvt_pk_bf16_f32 v32, v9, v10
    v_mul_f32 v4, v64, v45
    v_exp_f32 v4, v4
    v_mul_f32 v6, v65, v45
    v_fract_f32 v6, v6
    v_sin_f32 v5, v6
    v_cos_f32 v6, v6
    v_mul_f32 v5, v4, v5
    v_mul_f32 v4, v4, v6
    v_mul_f32 v7, v66, v4
    v_fma_f32 v7, -v67, v5, v7
    v_mul_f32 v8, v66, v5
    v_fma_f32 v8, v67, v4, v8
    v_sub_f32 v8, 0, v8
    v_cvt_pk_bf16_f32 v29, v7, v8
    v_lshlrev_b32 v9, 16, v29
    v_and_b32 v10, 0xffff0000, v29
    v_sub_f32 v9, v7, v9
    v_sub_f32 v10, v8, v10
    v_cvt_pk_bf16_f32 v33, v9, v10
    v_mul_f32 v4, v68, v45
    v_exp_f32 v4, v4
    v_mul_f32 v6, v69, v45
    v_fract_f32 v6, v6
    v_sin_f32 v5, v6
    v_cos_f32 v6, v6
    v_mul_f32 v5, v4, v5
    v_mul_f32 v4, v4, v6
    v_mul_f32 v7, v70, v4
    v_fma_f32 v7, -v71, v5, v7
    v_mul_f32 v8, v70, v5
    v_fma_f32 v8, v71, v4, v8
    v_sub_f32 v8, 0, v8
    v_cvt_pk_bf16_f32 v30, v7, v8
    v_lshlrev_b32 v9, 16, v30
    v_and_b32 v10, 0xffff0000, v30
    v_sub_f32 v9, v7, v9
    v_sub_f32 v10, v8, v10
    v_cvt_pk_bf16_f32 v34, v9, v10
    v_mul_f32 v4, v72, v45
    v_exp_f32 v4, v4
    v_mul_f32 v6, v73, v45
    v_fract_f32 v6, v6
    v_sin_f32 v5, v6
    v_cos_f32 v6, v6
    v_mul_f32 v5, v4, v5
    v_mul_f32 v4, v4, v6
    v_mul_f32 v7, v74, v4
    v_fma_f32 v7, -v75, v5, v7
    v_mul_f32 v8, v74, v5
    v_fma_f32 v8, v75, v4, v8
    v_sub_f32 v8, 0, v8
    v_cvt_pk_bf16_f32 v31, v7, v8
    v_lshlrev_b32 v9, 16, v31
    v_and_b32 v10, 0xffff0000, v31
    v_sub_f32 v9, v7, v9
    v_sub_f32 v10, v8, v10
    v_cvt_pk_bf16_f32 v35, v9, v10
    v_mfma_f32_16x16x32_bf16 v[52:55], v[28:31], v[36:39], v[52:55]
    v_mfma_f32_16x16x32_bf16 v[52:55], v[28:31], v[40:43], v[52:55]
    v_mfma_f32_16x16x32_bf16 v[52:55], v[32:35], v[36:39], v[52:55]
    v_lshlrev_b32 v4, 4, v1
    s_mul_i32 s31, s24, 3072
    v_add_u32 v5, s31, v4
    ds_write_b128 v5, v[24:27] offset:8192
    ds_write_b128 v5, v[48:51] offset:9216
    s_nop 2
    ds_write_b128 v5, v[52:55] offset:10240
    s_waitcnt lgkmcnt(0)
    s_barrier
    s_cmp_ge_u32 s24, 3
    s_cbranch_scc1 k1_kernel_kg_t3_26
    s_lshl_b32 s31, s24, 10
    v_add_u32 v5, s31, v4
    ds_read_b128 v[60:63], v5 offset:8192
    ds_read_b128 v[64:67], v5 offset:11264
    ds_read_b128 v[68:71], v5 offset:14336
    ds_read_b128 v[72:75], v5 offset:17408
    s_waitcnt lgkmcnt(2)
    v_add_f32 v60, v60, v64
    s_waitcnt lgkmcnt(0)
    v_add_f32 v68, v68, v72
    v_add_f32 v60, v60, v68
    v_add_f32 v61, v61, v65
    v_add_f32 v69, v69, v73
    v_add_f32 v61, v61, v69
    v_add_f32 v62, v62, v66
    v_add_f32 v70, v70, v74
    v_add_f32 v62, v62, v70
    v_add_f32 v63, v63, v67
    v_add_f32 v71, v71, v75
    v_add_f32 v63, v63, v71
    s_cmp_eq_u32 s24, 1
    s_cbranch_scc1 k1_kernel_kg_t1_27
    s_cmp_eq_u32 s24, 2
    s_cbranch_scc1 k1_kernel_kg_t2_28
    v_lshrrev_b32 v6, 1, v3
    v_lshlrev_b32 v6, 7, v6
    v_and_b32 v10, 1, v3
    v_lshl_add_u32 v6, v10, 2, v6
    v_lshl_add_u32 v6, v2, 3, v6
    v_mov_b32 v7, 4
    v_mov_b32 v8, 8
    v_mov_b32 v9, 12
    s_branch k1_kernel_kg_tw_29
k1_kernel_kg_t1_27:
    v_lshlrev_b32 v6, 6, v3
    v_add_u32 v6, 256, v6
    v_cmp_gt_u32 vcc, 2, v3
    s_nop 1
    v_cndmask_b32 v10, 1, 2, vcc
    v_lshlrev_b32 v10, v10, v2
    v_add_u32 v6, v6, v10
    v_mov_b32 v7, 4
    v_mov_b32 v8, 128
    v_cndmask_b32 v8, v8, 8, vcc
    v_mov_b32 v10, 132
    v_cndmask_b32 v9, v10, 12, vcc
    s_branch k1_kernel_kg_tw_29
k1_kernel_kg_t2_28:
    v_lshlrev_b32 v6, 6, v3
    v_add_u32 v6, 512, v6
    v_add_u32 v6, v6, v2
    v_mov_b32 v7, 64
    v_mov_b32 v8, 128
    v_mov_b32 v9, 192
k1_kernel_kg_tw_29:
    v_lshlrev_b32 v6, 2, v6
    ds_write_b32 v6, v60 offset:2048
    v_add_u32 v7, v7, v6
    ds_write_b32 v7, v61 offset:2048
    v_add_u32 v8, v8, v6
    ds_write_b32 v8, v62 offset:2048
    v_add_u32 v9, v9, v6
    ds_write_b32 v9, v63 offset:2048
k1_kernel_kg_t3_26:
    s_waitcnt lgkmcnt(0)
    s_barrier
    v_lshlrev_b32 v4, 3, v0
    v_sub_u32 v4, 2047, v4
    v_subrev_u32 v5, 0, v4
    v_cvt_f32_u32 v7, v5
    v_cvt_pk_bf16_f32 v7, v7, v7
    v_and_b32 v7, 0xffff, v7
    v_subrev_u32 v7, 17024, v7
    v_cmp_gt_u32 vcc, 256, v5
    s_nop 1
    v_cndmask_b32 v7, v7, v5, vcc
    v_lshlrev_b32 v7, 2, v7
    ds_read_b32 v76, v7 offset:2048
    v_subrev_u32 v5, 1, v4
    v_cvt_f32_u32 v7, v5
    v_cvt_pk_bf16_f32 v7, v7, v7
    v_and_b32 v7, 0xffff, v7
    v_subrev_u32 v7, 17024, v7
    v_cmp_gt_u32 vcc, 256, v5
    s_nop 1
    v_cndmask_b32 v7, v7, v5, vcc
    v_lshlrev_b32 v7, 2, v7
    ds_read_b32 v77, v7 offset:2048
    v_subrev_u32 v5, 2, v4
    v_cvt_f32_u32 v7, v5
    v_cvt_pk_bf16_f32 v7, v7, v7
    v_and_b32 v7, 0xffff, v7
    v_subrev_u32 v7, 17024, v7
    v_cmp_gt_u32 vcc, 256, v5
    s_nop 1
    v_cndmask_b32 v7, v7, v5, vcc
    v_lshlrev_b32 v7, 2, v7
    ds_read_b32 v78, v7 offset:2048
    v_subrev_u32 v5, 3, v4
    v_cvt_f32_u32 v7, v5
    v_cvt_pk_bf16_f32 v7, v7, v7
    v_and_b32 v7, 0xffff, v7
    v_subrev_u32 v7, 17024, v7
    v_cmp_gt_u32 vcc, 256, v5
    s_nop 1
    v_cndmask_b32 v7, v7, v5, vcc
    v_lshlrev_b32 v7, 2, v7
    ds_read_b32 v79, v7 offset:2048
    v_subrev_u32 v5, 4, v4
    v_cvt_f32_u32 v7, v5
    v_cvt_pk_bf16_f32 v7, v7, v7
    v_and_b32 v7, 0xffff, v7
    v_subrev_u32 v7, 17024, v7
    v_cmp_gt_u32 vcc, 256, v5
    s_nop 1
    v_cndmask_b32 v7, v7, v5, vcc
    v_lshlrev_b32 v7, 2, v7
    ds_read_b32 v80, v7 offset:2048
    v_subrev_u32 v5, 5, v4
    v_cvt_f32_u32 v7, v5
    v_cvt_pk_bf16_f32 v7, v7, v7
    v_and_b32 v7, 0xffff, v7
    v_subrev_u32 v7, 17024, v7
    v_cmp_gt_u32 vcc, 256, v5
    s_nop 1
    v_cndmask_b32 v7, v7, v5, vcc
    v_lshlrev_b32 v7, 2, v7
    ds_read_b32 v81, v7 offset:2048
    v_subrev_u32 v5, 6, v4
    v_cvt_f32_u32 v7, v5
    v_cvt_pk_bf16_f32 v7, v7, v7
    v_and_b32 v7, 0xffff, v7
    v_subrev_u32 v7, 17024, v7
    v_cmp_gt_u32 vcc, 256, v5
    s_nop 1
    v_cndmask_b32 v7, v7, v5, vcc
    v_lshlrev_b32 v7, 2, v7
    ds_read_b32 v82, v7 offset:2048
    v_subrev_u32 v5, 7, v4
    v_cvt_f32_u32 v7, v5
    v_cvt_pk_bf16_f32 v7, v7, v7
    v_and_b32 v7, 0xffff, v7
    v_subrev_u32 v7, 17024, v7
    v_cmp_gt_u32 vcc, 256, v5
    s_nop 1
    v_cndmask_b32 v7, v7, v5, vcc
    v_lshlrev_b32 v7, 2, v7
    ds_read_b32 v83, v7 offset:2048
    v_subrev_u32 v5, 8, v4
    v_max_i32 v5, 0, v5
    v_cvt_f32_u32 v7, v5
    v_cvt_pk_bf16_f32 v7, v7, v7
    v_and_b32 v7, 0xffff, v7
    v_subrev_u32 v7, 17024, v7
    v_cmp_gt_u32 vcc, 256, v5
    s_nop 1
    v_cndmask_b32 v7, v7, v5, vcc
    v_lshlrev_b32 v7, 2, v7
    ds_read_b32 v84, v7 offset:2048
    v_cmp_gt_u32 vcc, 8, v4
    s_waitcnt lgkmcnt(0)
    s_nop 0
    v_cndmask_b32 v84, v84, 0, vcc
    v_cvt_pk_bf16_f32 v88, v76, v77
    v_cvt_pk_bf16_f32 v92, v77, v78
    v_cvt_pk_bf16_f32 v89, v78, v79
    v_cvt_pk_bf16_f32 v93, v79, v80
    v_cvt_pk_bf16_f32 v90, v80, v81
    v_cvt_pk_bf16_f32 v94, v81, v82
    v_cvt_pk_bf16_f32 v91, v82, v83
    v_cvt_pk_bf16_f32 v95, v83, v84
    s_mul_i32 s31, s29, 8224
    s_add_u32 s31, s31, 12320768
    v_lshlrev_b32 v5, 4, v0
    buffer_store_dwordx4 v[88:91], v5, s[20:23], s31 offen
    s_add_u32 s32, s31, 4112
    buffer_store_dwordx4 v[92:95], v5, s[20:23], s32 offen
    v_mov_b32 v28, 0
    v_mov_b32 v29, 0
    v_mov_b32 v30, 0
    v_mov_b32 v31, 0
    v_mul_u32_u24 v5, 4112, v0
    v_cmp_gt_u32 vcc, 2, v0
    s_nop 1
    s_and_saveexec_b64 s[36:37], vcc
    s_add_u32 s32, s31, 4096
    buffer_store_dwordx4 v[28:31], v5, s[20:23], s32 offen
    s_mov_b64 exec, s[36:37]
    s_endpgm
k1_kernel_xt_2:
    v_and_b32 v1, 63, v0
    v_and_b32 v2, 15, v0
    v_lshrrev_b32 v3, 4, v1
    v_lshrrev_b32 v4, 6, v0
    s_nop 0
    v_readfirstlane_b32 s24, v4
    s_sub_u32 s31, s2, 768
    s_and_b32 s29, s31, 31
    s_lshr_b32 s30, s31, 5
    v_lshrrev_b32 v4, 3, v0
    v_and_b32 v5, 7, v0
    v_mul_u32_u24 v6, 1152, v4
    v_lshl_add_u32 v6, v5, 4, v6
    s_mul_i32 s32, s29, 73728
    s_lshl_b32 s33, s30, 7
    s_add_u32 s32, s32, s33
    s_add_u32 s33, s32, 36864
    buffer_load_dwordx4 v[8:11], v6, s[12:15], s32 offen
    buffer_load_dwordx4 v[12:15], v6, s[12:15], s33 offen
    v_mul_u32_u24 v4, 144, v4
    v_lshl_add_u32 v4, v5, 4, v4
    s_waitcnt vmcnt(1)
    ds_write_b128 v4, v[8:11]
    s_waitcnt vmcnt(0)
    ds_write_b128 v4, v[12:15] offset:4608
    s_waitcnt lgkmcnt(0)
    s_barrier
    v_lshrrev_b32 v4, 2, v2
    v_lshl_add_u32 v4, v3, 3, v4
    v_mul_u32_u24 v4, 144, v4
    v_and_b32 v5, 3, v2
    v_lshl_add_u32 v4, v5, 3, v4
    s_lshl_b32 s32, s24, 5
    v_add_u32 v4, s32, v4
    ds_read_b64_tr_b16 v[8:9], v4 offset:0
    ds_read_b64_tr_b16 v[10:11], v4 offset:576
    ds_read_b64_tr_b16 v[12:13], v4 offset:4608
    ds_read_b64_tr_b16 v[14:15], v4 offset:5184
    v_lshlrev_b32 v5, 12, v2
    v_lshl_add_u32 v5, v3, 4, v5
    s_lshl_b32 s32, s30, 6
    s_lshl_b32 s33, s24, 4
    s_add_u32 s32, s32, s33
    s_lshl_b32 s32, s32, 12
    s_lshl_b32 s33, s29, 7
    s_add_u32 s32, s32, s33
    s_add_u32 s32, s32, 9961472
    s_waitcnt lgkmcnt(2)
    buffer_store_dwordx4 v[8:11], v5, s[20:23], s32 offen
    s_waitcnt lgkmcnt(0)
    buffer_store_dwordx4 v[12:15], v5, s[20:23], s32 offen offset:64
    s_endpgm
k1_kernel_gate_3:
    s_load_dwordx2 s[4:5], s[0:1], 80
    s_waitcnt lgkmcnt(0)
    s_mov_b32 s16, s4
    s_mov_b32 s17, s5
    s_mov_b32 s18, 1152
    s_mov_b32 s19, 0x00020000
    v_and_b32 v1, 63, v0
    v_lshrrev_b32 v2, 6, v0
    s_nop 0
    v_readfirstlane_b32 s24, v2
    v_lshlrev_b32 v2, 1, v1
    buffer_load_ushort v8, v2, s[16:19], 0 offen offset:0
    buffer_load_ushort v9, v2, s[16:19], 0 offen offset:128
    buffer_load_ushort v10, v2, s[16:19], 0 offen offset:256
    buffer_load_ushort v11, v2, s[16:19], 0 offen offset:384
    buffer_load_ushort v12, v2, s[16:19], 0 offen offset:512
    buffer_load_ushort v13, v2, s[16:19], 0 offen offset:640
    buffer_load_ushort v14, v2, s[16:19], 0 offen offset:768
    buffer_load_ushort v15, v2, s[16:19], 0 offen offset:896
    buffer_load_ushort v16, v2, s[16:19], 0 offen offset:1024
    s_sub_u32 s31, s2, 1056
    s_lshl_b32 s31, s31, 5
    s_lshl_b32 s32, s24, 3
    s_add_u32 s31, s31, s32
    s_mul_i32 s33, s31, 1152
    v_mov_b32 v30, 0
    s_waitcnt vmcnt(8)
    v_lshlrev_b32 v8, 16, v8
    s_waitcnt vmcnt(7)
    v_lshlrev_b32 v9, 16, v9
    s_waitcnt vmcnt(6)
    v_lshlrev_b32 v10, 16, v10
    s_waitcnt vmcnt(5)
    v_lshlrev_b32 v11, 16, v11
    s_waitcnt vmcnt(4)
    v_lshlrev_b32 v12, 16, v12
    s_waitcnt vmcnt(3)
    v_lshlrev_b32 v13, 16, v13
    s_waitcnt vmcnt(2)
    v_lshlrev_b32 v14, 16, v14
    s_waitcnt vmcnt(1)
    v_lshlrev_b32 v15, 16, v15
    s_waitcnt vmcnt(0)
    v_lshlrev_b32 v16, 16, v16
    buffer_load_ushort v20, v2, s[12:15], s33 offen offset:0
    buffer_load_ushort v21, v2, s[12:15], s33 offen offset:128
    buffer_load_ushort v22, v2, s[12:15], s33 offen offset:256
    buffer_load_ushort v23, v2, s[12:15], s33 offen offset:384
    buffer_load_ushort v24, v2, s[12:15], s33 offen offset:512
    buffer_load_ushort v25, v2, s[12:15], s33 offen offset:640
    buffer_load_ushort v26, v2, s[12:15], s33 offen offset:768
    buffer_load_ushort v27, v2, s[12:15], s33 offen offset:896
    buffer_load_ushort v28, v2, s[12:15], s33 offen offset:1024
    s_add_u32 s33, s33, 1152
    v_mov_b32 v29, 0
    s_waitcnt vmcnt(8)
    v_lshlrev_b32 v3, 16, v20
    v_mul_f32 v3, v3, v8
    v_cvt_pk_bf16_f32 v3, v3, v3
    v_lshlrev_b32 v3, 16, v3
    v_add_f32 v29, v29, v3
    s_waitcnt vmcnt(7)
    v_lshlrev_b32 v3, 16, v21
    v_mul_f32 v3, v3, v9
    v_cvt_pk_bf16_f32 v3, v3, v3
    v_lshlrev_b32 v3, 16, v3
    v_add_f32 v29, v29, v3
    s_waitcnt vmcnt(6)
    v_lshlrev_b32 v3, 16, v22
    v_mul_f32 v3, v3, v10
    v_cvt_pk_bf16_f32 v3, v3, v3
    v_lshlrev_b32 v3, 16, v3
    v_add_f32 v29, v29, v3
    s_waitcnt vmcnt(5)
    v_lshlrev_b32 v3, 16, v23
    v_mul_f32 v3, v3, v11
    v_cvt_pk_bf16_f32 v3, v3, v3
    v_lshlrev_b32 v3, 16, v3
    v_add_f32 v29, v29, v3
    s_waitcnt vmcnt(4)
    v_lshlrev_b32 v3, 16, v24
    v_mul_f32 v3, v3, v12
    v_cvt_pk_bf16_f32 v3, v3, v3
    v_lshlrev_b32 v3, 16, v3
    v_add_f32 v29, v29, v3
    s_waitcnt vmcnt(3)
    v_lshlrev_b32 v3, 16, v25
    v_mul_f32 v3, v3, v13
    v_cvt_pk_bf16_f32 v3, v3, v3
    v_lshlrev_b32 v3, 16, v3
    v_add_f32 v29, v29, v3
    s_waitcnt vmcnt(2)
    v_lshlrev_b32 v3, 16, v26
    v_mul_f32 v3, v3, v14
    v_cvt_pk_bf16_f32 v3, v3, v3
    v_lshlrev_b32 v3, 16, v3
    v_add_f32 v29, v29, v3
    s_waitcnt vmcnt(1)
    v_lshlrev_b32 v3, 16, v27
    v_mul_f32 v3, v3, v15
    v_cvt_pk_bf16_f32 v3, v3, v3
    v_lshlrev_b32 v3, 16, v3
    v_add_f32 v29, v29, v3
    s_waitcnt vmcnt(0)
    v_lshlrev_b32 v3, 16, v28
    v_mul_f32 v3, v3, v16
    v_cvt_pk_bf16_f32 v3, v3, v3
    v_lshlrev_b32 v3, 16, v3
    v_add_f32 v29, v29, v3
    s_nop 1
    v_add_f32 v29, v29, v29 quad_perm:[1,0,3,2] row_mask:0xf bank_mask:0xf
    s_nop 1
    v_add_f32 v29, v29, v29 quad_perm:[2,3,0,1] row_mask:0xf bank_mask:0xf
    s_nop 1
    v_add_f32 v29, v29, v29 row_half_mirror row_mask:0xf bank_mask:0xf
    s_nop 1
    v_add_f32 v29, v29, v29 row_mirror row_mask:0xf bank_mask:0xf
    s_nop 0
    v_readlane_b32 s32, v29, 0
    v_readlane_b32 s34, v29, 16
    v_readlane_b32 s40, v29, 32
    v_readlane_b32 s41, v29, 48
    v_mov_b32 v3, s32
    v_add_f32 v3, s34, v3
    v_add_f32 v3, s40, v3
    v_add_f32 v3, s41, v3
    v_cmp_eq_u32 vcc, 0, v1
    s_nop 1
    v_cndmask_b32 v30, v30, v3, vcc
    buffer_load_ushort v20, v2, s[12:15], s33 offen offset:0
    buffer_load_ushort v21, v2, s[12:15], s33 offen offset:128
    buffer_load_ushort v22, v2, s[12:15], s33 offen offset:256
    buffer_load_ushort v23, v2, s[12:15], s33 offen offset:384
    buffer_load_ushort v24, v2, s[12:15], s33 offen offset:512
    buffer_load_ushort v25, v2, s[12:15], s33 offen offset:640
    buffer_load_ushort v26, v2, s[12:15], s33 offen offset:768
    buffer_load_ushort v27, v2, s[12:15], s33 offen offset:896
    buffer_load_ushort v28, v2, s[12:15], s33 offen offset:1024
    s_add_u32 s33, s33, 1152
    v_mov_b32 v29, 0
    s_waitcnt vmcnt(8)
    v_lshlrev_b32 v3, 16, v20
    v_mul_f32 v3, v3, v8
    v_cvt_pk_bf16_f32 v3, v3, v3
    v_lshlrev_b32 v3, 16, v3
    v_add_f32 v29, v29, v3
    s_waitcnt vmcnt(7)
    v_lshlrev_b32 v3, 16, v21
    v_mul_f32 v3, v3, v9
    v_cvt_pk_bf16_f32 v3, v3, v3
    v_lshlrev_b32 v3, 16, v3
    v_add_f32 v29, v29, v3
    s_waitcnt vmcnt(6)
    v_lshlrev_b32 v3, 16, v22
    v_mul_f32 v3, v3, v10
    v_cvt_pk_bf16_f32 v3, v3, v3
    v_lshlrev_b32 v3, 16, v3
    v_add_f32 v29, v29, v3
    s_waitcnt vmcnt(5)
    v_lshlrev_b32 v3, 16, v23
    v_mul_f32 v3, v3, v11
    v_cvt_pk_bf16_f32 v3, v3, v3
    v_lshlrev_b32 v3, 16, v3
    v_add_f32 v29, v29, v3
    s_waitcnt vmcnt(4)
    v_lshlrev_b32 v3, 16, v24
    v_mul_f32 v3, v3, v12
    v_cvt_pk_bf16_f32 v3, v3, v3
    v_lshlrev_b32 v3, 16, v3
    v_add_f32 v29, v29, v3
    s_waitcnt vmcnt(3)
    v_lshlrev_b32 v3, 16, v25
    v_mul_f32 v3, v3, v13
    v_cvt_pk_bf16_f32 v3, v3, v3
    v_lshlrev_b32 v3, 16, v3
    v_add_f32 v29, v29, v3
    s_waitcnt vmcnt(2)
    v_lshlrev_b32 v3, 16, v26
    v_mul_f32 v3, v3, v14
    v_cvt_pk_bf16_f32 v3, v3, v3
    v_lshlrev_b32 v3, 16, v3
    v_add_f32 v29, v29, v3
    s_waitcnt vmcnt(1)
    v_lshlrev_b32 v3, 16, v27
    v_mul_f32 v3, v3, v15
    v_cvt_pk_bf16_f32 v3, v3, v3
    v_lshlrev_b32 v3, 16, v3
    v_add_f32 v29, v29, v3
    s_waitcnt vmcnt(0)
    v_lshlrev_b32 v3, 16, v28
    v_mul_f32 v3, v3, v16
    v_cvt_pk_bf16_f32 v3, v3, v3
    v_lshlrev_b32 v3, 16, v3
    v_add_f32 v29, v29, v3
    s_nop 1
    v_add_f32 v29, v29, v29 quad_perm:[1,0,3,2] row_mask:0xf bank_mask:0xf
    s_nop 1
    v_add_f32 v29, v29, v29 quad_perm:[2,3,0,1] row_mask:0xf bank_mask:0xf
    s_nop 1
    v_add_f32 v29, v29, v29 row_half_mirror row_mask:0xf bank_mask:0xf
    s_nop 1
    v_add_f32 v29, v29, v29 row_mirror row_mask:0xf bank_mask:0xf
    s_nop 0
    v_readlane_b32 s32, v29, 0
    v_readlane_b32 s34, v29, 16
    v_readlane_b32 s40, v29, 32
    v_readlane_b32 s41, v29, 48
    v_mov_b32 v3, s32
    v_add_f32 v3, s34, v3
    v_add_f32 v3, s40, v3
    v_add_f32 v3, s41, v3
    v_cmp_eq_u32 vcc, 1, v1
    s_nop 1
    v_cndmask_b32 v30, v30, v3, vcc
    buffer_load_ushort v20, v2, s[12:15], s33 offen offset:0
    buffer_load_ushort v21, v2, s[12:15], s33 offen offset:128
    buffer_load_ushort v22, v2, s[12:15], s33 offen offset:256
    buffer_load_ushort v23, v2, s[12:15], s33 offen offset:384
    buffer_load_ushort v24, v2, s[12:15], s33 offen offset:512
    buffer_load_ushort v25, v2, s[12:15], s33 offen offset:640
    buffer_load_ushort v26, v2, s[12:15], s33 offen offset:768
    buffer_load_ushort v27, v2, s[12:15], s33 offen offset:896
    buffer_load_ushort v28, v2, s[12:15], s33 offen offset:1024
    s_add_u32 s33, s33, 1152
    v_mov_b32 v29, 0
    s_waitcnt vmcnt(8)
    v_lshlrev_b32 v3, 16, v20
    v_mul_f32 v3, v3, v8
    v_cvt_pk_bf16_f32 v3, v3, v3
    v_lshlrev_b32 v3, 16, v3
    v_add_f32 v29, v29, v3
    s_waitcnt vmcnt(7)
    v_lshlrev_b32 v3, 16, v21
    v_mul_f32 v3, v3, v9
    v_cvt_pk_bf16_f32 v3, v3, v3
    v_lshlrev_b32 v3, 16, v3
    v_add_f32 v29, v29, v3
    s_waitcnt vmcnt(6)
    v_lshlrev_b32 v3, 16, v22
    v_mul_f32 v3, v3, v10
    v_cvt_pk_bf16_f32 v3, v3, v3
    v_lshlrev_b32 v3, 16, v3
    v_add_f32 v29, v29, v3
    s_waitcnt vmcnt(5)
    v_lshlrev_b32 v3, 16, v23
    v_mul_f32 v3, v3, v11
    v_cvt_pk_bf16_f32 v3, v3, v3
    v_lshlrev_b32 v3, 16, v3
    v_add_f32 v29, v29, v3
    s_waitcnt vmcnt(4)
    v_lshlrev_b32 v3, 16, v24
    v_mul_f32 v3, v3, v12
    v_cvt_pk_bf16_f32 v3, v3, v3
    v_lshlrev_b32 v3, 16, v3
    v_add_f32 v29, v29, v3
    s_waitcnt vmcnt(3)
    v_lshlrev_b32 v3, 16, v25
    v_mul_f32 v3, v3, v13
    v_cvt_pk_bf16_f32 v3, v3, v3
    v_lshlrev_b32 v3, 16, v3
    v_add_f32 v29, v29, v3
    s_waitcnt vmcnt(2)
    v_lshlrev_b32 v3, 16, v26
    v_mul_f32 v3, v3, v14
    v_cvt_pk_bf16_f32 v3, v3, v3
    v_lshlrev_b32 v3, 16, v3
    v_add_f32 v29, v29, v3
    s_waitcnt vmcnt(1)
    v_lshlrev_b32 v3, 16, v27
    v_mul_f32 v3, v3, v15
    v_cvt_pk_bf16_f32 v3, v3, v3
    v_lshlrev_b32 v3, 16, v3
    v_add_f32 v29, v29, v3
    s_waitcnt vmcnt(0)
    v_lshlrev_b32 v3, 16, v28
    v_mul_f32 v3, v3, v16
    v_cvt_pk_bf16_f32 v3, v3, v3
    v_lshlrev_b32 v3, 16, v3
    v_add_f32 v29, v29, v3
    s_nop 1
    v_add_f32 v29, v29, v29 quad_perm:[1,0,3,2] row_mask:0xf bank_mask:0xf
    s_nop 1
    v_add_f32 v29, v29, v29 quad_perm:[2,3,0,1] row_mask:0xf bank_mask:0xf
    s_nop 1
    v_add_f32 v29, v29, v29 row_half_mirror row_mask:0xf bank_mask:0xf
    s_nop 1
    v_add_f32 v29, v29, v29 row_mirror row_mask:0xf bank_mask:0xf
    s_nop 0
    v_readlane_b32 s32, v29, 0
    v_readlane_b32 s34, v29, 16
    v_readlane_b32 s40, v29, 32
    v_readlane_b32 s41, v29, 48
    v_mov_b32 v3, s32
    v_add_f32 v3, s34, v3
    v_add_f32 v3, s40, v3
    v_add_f32 v3, s41, v3
    v_cmp_eq_u32 vcc, 2, v1
    s_nop 1
    v_cndmask_b32 v30, v30, v3, vcc
    buffer_load_ushort v20, v2, s[12:15], s33 offen offset:0
    buffer_load_ushort v21, v2, s[12:15], s33 offen offset:128
    buffer_load_ushort v22, v2, s[12:15], s33 offen offset:256
    buffer_load_ushort v23, v2, s[12:15], s33 offen offset:384
    buffer_load_ushort v24, v2, s[12:15], s33 offen offset:512
    buffer_load_ushort v25, v2, s[12:15], s33 offen offset:640
    buffer_load_ushort v26, v2, s[12:15], s33 offen offset:768
    buffer_load_ushort v27, v2, s[12:15], s33 offen offset:896
    buffer_load_ushort v28, v2, s[12:15], s33 offen offset:1024
    s_add_u32 s33, s33, 1152
    v_mov_b32 v29, 0
    s_waitcnt vmcnt(8)
    v_lshlrev_b32 v3, 16, v20
    v_mul_f32 v3, v3, v8
    v_cvt_pk_bf16_f32 v3, v3, v3
    v_lshlrev_b32 v3, 16, v3
    v_add_f32 v29, v29, v3
    s_waitcnt vmcnt(7)
    v_lshlrev_b32 v3, 16, v21
    v_mul_f32 v3, v3, v9
    v_cvt_pk_bf16_f32 v3, v3, v3
    v_lshlrev_b32 v3, 16, v3
    v_add_f32 v29, v29, v3
    s_waitcnt vmcnt(6)
    v_lshlrev_b32 v3, 16, v22
    v_mul_f32 v3, v3, v10
    v_cvt_pk_bf16_f32 v3, v3, v3
    v_lshlrev_b32 v3, 16, v3
    v_add_f32 v29, v29, v3
    s_waitcnt vmcnt(5)
    v_lshlrev_b32 v3, 16, v23
    v_mul_f32 v3, v3, v11
    v_cvt_pk_bf16_f32 v3, v3, v3
    v_lshlrev_b32 v3, 16, v3
    v_add_f32 v29, v29, v3
    s_waitcnt vmcnt(4)
    v_lshlrev_b32 v3, 16, v24
    v_mul_f32 v3, v3, v12
    v_cvt_pk_bf16_f32 v3, v3, v3
    v_lshlrev_b32 v3, 16, v3
    v_add_f32 v29, v29, v3
    s_waitcnt vmcnt(3)
    v_lshlrev_b32 v3, 16, v25
    v_mul_f32 v3, v3, v13
    v_cvt_pk_bf16_f32 v3, v3, v3
    v_lshlrev_b32 v3, 16, v3
    v_add_f32 v29, v29, v3
    s_waitcnt vmcnt(2)
    v_lshlrev_b32 v3, 16, v26
    v_mul_f32 v3, v3, v14
    v_cvt_pk_bf16_f32 v3, v3, v3
    v_lshlrev_b32 v3, 16, v3
    v_add_f32 v29, v29, v3
    s_waitcnt vmcnt(1)
    v_lshlrev_b32 v3, 16, v27
    v_mul_f32 v3, v3, v15
    v_cvt_pk_bf16_f32 v3, v3, v3
    v_lshlrev_b32 v3, 16, v3
    v_add_f32 v29, v29, v3
    s_waitcnt vmcnt(0)
    v_lshlrev_b32 v3, 16, v28
    v_mul_f32 v3, v3, v16
    v_cvt_pk_bf16_f32 v3, v3, v3
    v_lshlrev_b32 v3, 16, v3
    v_add_f32 v29, v29, v3
    s_nop 1
    v_add_f32 v29, v29, v29 quad_perm:[1,0,3,2] row_mask:0xf bank_mask:0xf
    s_nop 1
    v_add_f32 v29, v29, v29 quad_perm:[2,3,0,1] row_mask:0xf bank_mask:0xf
    s_nop 1
    v_add_f32 v29, v29, v29 row_half_mirror row_mask:0xf bank_mask:0xf
    s_nop 1
    v_add_f32 v29, v29, v29 row_mirror row_mask:0xf bank_mask:0xf
    s_nop 0
    v_readlane_b32 s32, v29, 0
    v_readlane_b32 s34, v29, 16
    v_readlane_b32 s40, v29, 32
    v_readlane_b32 s41, v29, 48
    v_mov_b32 v3, s32
    v_add_f32 v3, s34, v3
    v_add_f32 v3, s40, v3
    v_add_f32 v3, s41, v3
    v_cmp_eq_u32 vcc, 3, v1
    s_nop 1
    v_cndmask_b32 v30, v30, v3, vcc
    buffer_load_ushort v20, v2, s[12:15], s33 offen offset:0
    buffer_load_ushort v21, v2, s[12:15], s33 offen offset:128
    buffer_load_ushort v22, v2, s[12:15], s33 offen offset:256
    buffer_load_ushort v23, v2, s[12:15], s33 offen offset:384
    buffer_load_ushort v24, v2, s[12:15], s33 offen offset:512
    buffer_load_ushort v25, v2, s[12:15], s33 offen offset:640
    buffer_load_ushort v26, v2, s[12:15], s33 offen offset:768
    buffer_load_ushort v27, v2, s[12:15], s33 offen offset:896
    buffer_load_ushort v28, v2, s[12:15], s33 offen offset:1024
    s_add_u32 s33, s33, 1152
    v_mov_b32 v29, 0
    s_waitcnt vmcnt(8)
    v_lshlrev_b32 v3, 16, v20
    v_mul_f32 v3, v3, v8
    v_cvt_pk_bf16_f32 v3, v3, v3
    v_lshlrev_b32 v3, 16, v3
    v_add_f32 v29, v29, v3
    s_waitcnt vmcnt(7)
    v_lshlrev_b32 v3, 16, v21
    v_mul_f32 v3, v3, v9
    v_cvt_pk_bf16_f32 v3, v3, v3
    v_lshlrev_b32 v3, 16, v3
    v_add_f32 v29, v29, v3
    s_waitcnt vmcnt(6)
    v_lshlrev_b32 v3, 16, v22
    v_mul_f32 v3, v3, v10
    v_cvt_pk_bf16_f32 v3, v3, v3
    v_lshlrev_b32 v3, 16, v3
    v_add_f32 v29, v29, v3
    s_waitcnt vmcnt(5)
    v_lshlrev_b32 v3, 16, v23
    v_mul_f32 v3, v3, v11
    v_cvt_pk_bf16_f32 v3, v3, v3
    v_lshlrev_b32 v3, 16, v3
    v_add_f32 v29, v29, v3
    s_waitcnt vmcnt(4)
    v_lshlrev_b32 v3, 16, v24
    v_mul_f32 v3, v3, v12
    v_cvt_pk_bf16_f32 v3, v3, v3
    v_lshlrev_b32 v3, 16, v3
    v_add_f32 v29, v29, v3
    s_waitcnt vmcnt(3)
    v_lshlrev_b32 v3, 16, v25
    v_mul_f32 v3, v3, v13
    v_cvt_pk_bf16_f32 v3, v3, v3
    v_lshlrev_b32 v3, 16, v3
    v_add_f32 v29, v29, v3
    s_waitcnt vmcnt(2)
    v_lshlrev_b32 v3, 16, v26
    v_mul_f32 v3, v3, v14
    v_cvt_pk_bf16_f32 v3, v3, v3
    v_lshlrev_b32 v3, 16, v3
    v_add_f32 v29, v29, v3
    s_waitcnt vmcnt(1)
    v_lshlrev_b32 v3, 16, v27
    v_mul_f32 v3, v3, v15
    v_cvt_pk_bf16_f32 v3, v3, v3
    v_lshlrev_b32 v3, 16, v3
    v_add_f32 v29, v29, v3
    s_waitcnt vmcnt(0)
    v_lshlrev_b32 v3, 16, v28
    v_mul_f32 v3, v3, v16
    v_cvt_pk_bf16_f32 v3, v3, v3
    v_lshlrev_b32 v3, 16, v3
    v_add_f32 v29, v29, v3
    s_nop 1
    v_add_f32 v29, v29, v29 quad_perm:[1,0,3,2] row_mask:0xf bank_mask:0xf
    s_nop 1
    v_add_f32 v29, v29, v29 quad_perm:[2,3,0,1] row_mask:0xf bank_mask:0xf
    s_nop 1
    v_add_f32 v29, v29, v29 row_half_mirror row_mask:0xf bank_mask:0xf
    s_nop 1
    v_add_f32 v29, v29, v29 row_mirror row_mask:0xf bank_mask:0xf
    s_nop 0
    v_readlane_b32 s32, v29, 0
    v_readlane_b32 s34, v29, 16
    v_readlane_b32 s40, v29, 32
    v_readlane_b32 s41, v29, 48
    v_mov_b32 v3, s32
    v_add_f32 v3, s34, v3
    v_add_f32 v3, s40, v3
    v_add_f32 v3, s41, v3
    v_cmp_eq_u32 vcc, 4, v1
    s_nop 1
    v_cndmask_b32 v30, v30, v3, vcc
    buffer_load_ushort v20, v2, s[12:15], s33 offen offset:0
    buffer_load_ushort v21, v2, s[12:15], s33 offen offset:128
    buffer_load_ushort v22, v2, s[12:15], s33 offen offset:256
    buffer_load_ushort v23, v2, s[12:15], s33 offen offset:384
    buffer_load_ushort v24, v2, s[12:15], s33 offen offset:512
    buffer_load_ushort v25, v2, s[12:15], s33 offen offset:640
    buffer_load_ushort v26, v2, s[12:15], s33 offen offset:768
    buffer_load_ushort v27, v2, s[12:15], s33 offen offset:896
    buffer_load_ushort v28, v2, s[12:15], s33 offen offset:1024
    s_add_u32 s33, s33, 1152
    v_mov_b32 v29, 0
    s_waitcnt vmcnt(8)
    v_lshlrev_b32 v3, 16, v20
    v_mul_f32 v3, v3, v8
    v_cvt_pk_bf16_f32 v3, v3, v3
    v_lshlrev_b32 v3, 16, v3
    v_add_f32 v29, v29, v3
    s_waitcnt vmcnt(7)
    v_lshlrev_b32 v3, 16, v21
    v_mul_f32 v3, v3, v9
    v_cvt_pk_bf16_f32 v3, v3, v3
    v_lshlrev_b32 v3, 16, v3
    v_add_f32 v29, v29, v3
    s_waitcnt vmcnt(6)
    v_lshlrev_b32 v3, 16, v22
    v_mul_f32 v3, v3, v10
    v_cvt_pk_bf16_f32 v3, v3, v3
    v_lshlrev_b32 v3, 16, v3
    v_add_f32 v29, v29, v3
    s_waitcnt vmcnt(5)
    v_lshlrev_b32 v3, 16, v23
    v_mul_f32 v3, v3, v11
    v_cvt_pk_bf16_f32 v3, v3, v3
    v_lshlrev_b32 v3, 16, v3
    v_add_f32 v29, v29, v3
    s_waitcnt vmcnt(4)
    v_lshlrev_b32 v3, 16, v24
    v_mul_f32 v3, v3, v12
    v_cvt_pk_bf16_f32 v3, v3, v3
    v_lshlrev_b32 v3, 16, v3
    v_add_f32 v29, v29, v3
    s_waitcnt vmcnt(3)
    v_lshlrev_b32 v3, 16, v25
    v_mul_f32 v3, v3, v13
    v_cvt_pk_bf16_f32 v3, v3, v3
    v_lshlrev_b32 v3, 16, v3
    v_add_f32 v29, v29, v3
    s_waitcnt vmcnt(2)
    v_lshlrev_b32 v3, 16, v26
    v_mul_f32 v3, v3, v14
    v_cvt_pk_bf16_f32 v3, v3, v3
    v_lshlrev_b32 v3, 16, v3
    v_add_f32 v29, v29, v3
    s_waitcnt vmcnt(1)
    v_lshlrev_b32 v3, 16, v27
    v_mul_f32 v3, v3, v15
    v_cvt_pk_bf16_f32 v3, v3, v3
    v_lshlrev_b32 v3, 16, v3
    v_add_f32 v29, v29, v3
    s_waitcnt vmcnt(0)
    v_lshlrev_b32 v3, 16, v28
    v_mul_f32 v3, v3, v16
    v_cvt_pk_bf16_f32 v3, v3, v3
    v_lshlrev_b32 v3, 16, v3
    v_add_f32 v29, v29, v3
    s_nop 1
    v_add_f32 v29, v29, v29 quad_perm:[1,0,3,2] row_mask:0xf bank_mask:0xf
    s_nop 1
    v_add_f32 v29, v29, v29 quad_perm:[2,3,0,1] row_mask:0xf bank_mask:0xf
    s_nop 1
    v_add_f32 v29, v29, v29 row_half_mirror row_mask:0xf bank_mask:0xf
    s_nop 1
    v_add_f32 v29, v29, v29 row_mirror row_mask:0xf bank_mask:0xf
    s_nop 0
    v_readlane_b32 s32, v29, 0
    v_readlane_b32 s34, v29, 16
    v_readlane_b32 s40, v29, 32
    v_readlane_b32 s41, v29, 48
    v_mov_b32 v3, s32
    v_add_f32 v3, s34, v3
    v_add_f32 v3, s40, v3
    v_add_f32 v3, s41, v3
    v_cmp_eq_u32 vcc, 5, v1
    s_nop 1
    v_cndmask_b32 v30, v30, v3, vcc
    buffer_load_ushort v20, v2, s[12:15], s33 offen offset:0
    buffer_load_ushort v21, v2, s[12:15], s33 offen offset:128
    buffer_load_ushort v22, v2, s[12:15], s33 offen offset:256
    buffer_load_ushort v23, v2, s[12:15], s33 offen offset:384
    buffer_load_ushort v24, v2, s[12:15], s33 offen offset:512
    buffer_load_ushort v25, v2, s[12:15], s33 offen offset:640
    buffer_load_ushort v26, v2, s[12:15], s33 offen offset:768
    buffer_load_ushort v27, v2, s[12:15], s33 offen offset:896
    buffer_load_ushort v28, v2, s[12:15], s33 offen offset:1024
    s_add_u32 s33, s33, 1152
    v_mov_b32 v29, 0
    s_waitcnt vmcnt(8)
    v_lshlrev_b32 v3, 16, v20
    v_mul_f32 v3, v3, v8
    v_cvt_pk_bf16_f32 v3, v3, v3
    v_lshlrev_b32 v3, 16, v3
    v_add_f32 v29, v29, v3
    s_waitcnt vmcnt(7)
    v_lshlrev_b32 v3, 16, v21
    v_mul_f32 v3, v3, v9
    v_cvt_pk_bf16_f32 v3, v3, v3
    v_lshlrev_b32 v3, 16, v3
    v_add_f32 v29, v29, v3
    s_waitcnt vmcnt(6)
    v_lshlrev_b32 v3, 16, v22
    v_mul_f32 v3, v3, v10
    v_cvt_pk_bf16_f32 v3, v3, v3
    v_lshlrev_b32 v3, 16, v3
    v_add_f32 v29, v29, v3
    s_waitcnt vmcnt(5)
    v_lshlrev_b32 v3, 16, v23
    v_mul_f32 v3, v3, v11
    v_cvt_pk_bf16_f32 v3, v3, v3
    v_lshlrev_b32 v3, 16, v3
    v_add_f32 v29, v29, v3
    s_waitcnt vmcnt(4)
    v_lshlrev_b32 v3, 16, v24
    v_mul_f32 v3, v3, v12
    v_cvt_pk_bf16_f32 v3, v3, v3
    v_lshlrev_b32 v3, 16, v3
    v_add_f32 v29, v29, v3
    s_waitcnt vmcnt(3)
    v_lshlrev_b32 v3, 16, v25
    v_mul_f32 v3, v3, v13
    v_cvt_pk_bf16_f32 v3, v3, v3
    v_lshlrev_b32 v3, 16, v3
    v_add_f32 v29, v29, v3
    s_waitcnt vmcnt(2)
    v_lshlrev_b32 v3, 16, v26
    v_mul_f32 v3, v3, v14
    v_cvt_pk_bf16_f32 v3, v3, v3
    v_lshlrev_b32 v3, 16, v3
    v_add_f32 v29, v29, v3
    s_waitcnt vmcnt(1)
    v_lshlrev_b32 v3, 16, v27
    v_mul_f32 v3, v3, v15
    v_cvt_pk_bf16_f32 v3, v3, v3
    v_lshlrev_b32 v3, 16, v3
    v_add_f32 v29, v29, v3
    s_waitcnt vmcnt(0)
    v_lshlrev_b32 v3, 16, v28
    v_mul_f32 v3, v3, v16
    v_cvt_pk_bf16_f32 v3, v3, v3
    v_lshlrev_b32 v3, 16, v3
    v_add_f32 v29, v29, v3
    s_nop 1
    v_add_f32 v29, v29, v29 quad_perm:[1,0,3,2] row_mask:0xf bank_mask:0xf
    s_nop 1
    v_add_f32 v29, v29, v29 quad_perm:[2,3,0,1] row_mask:0xf bank_mask:0xf
    s_nop 1
    v_add_f32 v29, v29, v29 row_half_mirror row_mask:0xf bank_mask:0xf
    s_nop 1
    v_add_f32 v29, v29, v29 row_mirror row_mask:0xf bank_mask:0xf
    s_nop 0
    v_readlane_b32 s32, v29, 0
    v_readlane_b32 s34, v29, 16
    v_readlane_b32 s40, v29, 32
    v_readlane_b32 s41, v29, 48
    v_mov_b32 v3, s32
    v_add_f32 v3, s34, v3
    v_add_f32 v3, s40, v3
    v_add_f32 v3, s41, v3
    v_cmp_eq_u32 vcc, 6, v1
    s_nop 1
    v_cndmask_b32 v30, v30, v3, vcc
    buffer_load_ushort v20, v2, s[12:15], s33 offen offset:0
    buffer_load_ushort v21, v2, s[12:15], s33 offen offset:128
    buffer_load_ushort v22, v2, s[12:15], s33 offen offset:256
    buffer_load_ushort v23, v2, s[12:15], s33 offen offset:384
    buffer_load_ushort v24, v2, s[12:15], s33 offen offset:512
    buffer_load_ushort v25, v2, s[12:15], s33 offen offset:640
    buffer_load_ushort v26, v2, s[12:15], s33 offen offset:768
    buffer_load_ushort v27, v2, s[12:15], s33 offen offset:896
    buffer_load_ushort v28, v2, s[12:15], s33 offen offset:1024
    s_add_u32 s33, s33, 1152
    v_mov_b32 v29, 0
    s_waitcnt vmcnt(8)
    v_lshlrev_b32 v3, 16, v20
    v_mul_f32 v3, v3, v8
    v_cvt_pk_bf16_f32 v3, v3, v3
    v_lshlrev_b32 v3, 16, v3
    v_add_f32 v29, v29, v3
    s_waitcnt vmcnt(7)
    v_lshlrev_b32 v3, 16, v21
    v_mul_f32 v3, v3, v9
    v_cvt_pk_bf16_f32 v3, v3, v3
    v_lshlrev_b32 v3, 16, v3
    v_add_f32 v29, v29, v3
    s_waitcnt vmcnt(6)
    v_lshlrev_b32 v3, 16, v22
    v_mul_f32 v3, v3, v10
    v_cvt_pk_bf16_f32 v3, v3, v3
    v_lshlrev_b32 v3, 16, v3
    v_add_f32 v29, v29, v3
    s_waitcnt vmcnt(5)
    v_lshlrev_b32 v3, 16, v23
    v_mul_f32 v3, v3, v11
    v_cvt_pk_bf16_f32 v3, v3, v3
    v_lshlrev_b32 v3, 16, v3
    v_add_f32 v29, v29, v3
    s_waitcnt vmcnt(4)
    v_lshlrev_b32 v3, 16, v24
    v_mul_f32 v3, v3, v12
    v_cvt_pk_bf16_f32 v3, v3, v3
    v_lshlrev_b32 v3, 16, v3
    v_add_f32 v29, v29, v3
    s_waitcnt vmcnt(3)
    v_lshlrev_b32 v3, 16, v25
    v_mul_f32 v3, v3, v13
    v_cvt_pk_bf16_f32 v3, v3, v3
    v_lshlrev_b32 v3, 16, v3
    v_add_f32 v29, v29, v3
    s_waitcnt vmcnt(2)
    v_lshlrev_b32 v3, 16, v26
    v_mul_f32 v3, v3, v14
    v_cvt_pk_bf16_f32 v3, v3, v3
    v_lshlrev_b32 v3, 16, v3
    v_add_f32 v29, v29, v3
    s_waitcnt vmcnt(1)
    v_lshlrev_b32 v3, 16, v27
    v_mul_f32 v3, v3, v15
    v_cvt_pk_bf16_f32 v3, v3, v3
    v_lshlrev_b32 v3, 16, v3
    v_add_f32 v29, v29, v3
    s_waitcnt vmcnt(0)
    v_lshlrev_b32 v3, 16, v28
    v_mul_f32 v3, v3, v16
    v_cvt_pk_bf16_f32 v3, v3, v3
    v_lshlrev_b32 v3, 16, v3
    v_add_f32 v29, v29, v3
    s_nop 1
    v_add_f32 v29, v29, v29 quad_perm:[1,0,3,2] row_mask:0xf bank_mask:0xf
    s_nop 1
    v_add_f32 v29, v29, v29 quad_perm:[2,3,0,1] row_mask:0xf bank_mask:0xf
    s_nop 1
    v_add_f32 v29, v29, v29 row_half_mirror row_mask:0xf bank_mask:0xf
    s_nop 1
    v_add_f32 v29, v29, v29 row_mirror row_mask:0xf bank_mask:0xf
    s_nop 0
    v_readlane_b32 s32, v29, 0
    v_readlane_b32 s34, v29, 16
    v_readlane_b32 s40, v29, 32
    v_readlane_b32 s41, v29, 48
    v_mov_b32 v3, s32
    v_add_f32 v3, s34, v3
    v_add_f32 v3, s40, v3
    v_add_f32 v3, s41, v3
    v_cmp_eq_u32 vcc, 7, v1
    s_nop 1
    v_cndmask_b32 v30, v30, v3, vcc
    v_cvt_pk_bf16_f32 v3, v30, v30
    v_lshlrev_b32 v30, 16, v3
    v_mul_f32 v3, 3216550459, v30
    v_exp_f32 v3, v3
    s_nop 0
    v_add_f32 v3, 1.0, v3
    v_rcp_f32 v3, v3
    s_nop 0
    v_cvt_pk_bf16_f32 v4, v3, v3
    v_lshlrev_b32 v3, 16, v4
    v_cmp_gt_u32 vcc, 8, v1
    s_nop 1
    s_and_saveexec_b64 s[36:37], vcc
    s_lshl_b32 s31, s31, 2
    s_add_u32 s31, s31, 17057792
    v_lshlrev_b32 v4, 2, v1
    buffer_store_dword v3, v4, s[20:23], s31 offen
    s_mov_b64 exec, s[36:37]
    s_endpgm
k1_kernel_exit_4:
    s_endpgm
.globl k2_kernel
.p2align 8
.type k2_kernel,@function
k2_kernel:
    s_load_dwordx2 s[8:9], s[0:1], 104
    s_load_dwordx2 s[4:5], s[0:1], 72
    s_waitcnt lgkmcnt(0)
    s_mov_b32 s12, s8
    s_mov_b32 s13, s9
    s_mov_b32 s14, 21784576
    s_mov_b32 s15, 0x00020000
    s_cmp_ge_u32 s2, 400
    s_cbranch_scc1 k2_kernel_exit_1
    s_cmp_ge_u32 s2, 256
    s_cbranch_scc1 k2_kernel_conv_2
    v_and_b32 v1, 63, v0
    v_and_b32 v2, 31, v0
    v_bfe_u32 v3, v0, 5, 1
    v_lshrrev_b32 v4, 6, v0
    s_nop 0
    v_readfirstlane_b32 s16, v4
    s_and_b32 s19, s2, 7
    s_lshl_b32 s19, s19, 2
    s_lshr_b32 s20, s2, 3
    s_and_b32 s20, s20, 3
    s_add_u32 s17, s19, s20
    s_lshr_b32 s18, s2, 5
    v_lshlrev_b32 v8, 4, v1
    s_lshl_b32 s19, s16, 10
    v_add_u32 v8, s19, v8
    s_mul_i32 s24, s17, 180224
    s_add_u32 s24, s24, 4194304
    s_mov_b32 s23, s19
    s_mov_b32 s30, s19
    s_mov_b32 s31, s24
    s_add_u32 m0, s23, 0
    s_add_u32 s20, s24, 0
    buffer_load_dwordx4 v8, s[12:15], s20 offen lds
    s_add_u32 m0, s23, 8192
    s_add_u32 s20, s24, 8192
    buffer_load_dwordx4 v8, s[12:15], s20 offen lds
    s_cmp_ge_u32 s16, 6
    s_cbranch_scc1 k2_kernel_skipd_3
    s_add_u32 m0, s23, 16384
    s_add_u32 s20, s24, 16384
    buffer_load_dwordx4 v8, s[12:15], s20 offen lds
k2_kernel_skipd_3:
    s_add_u32 s24, s24, 22528
    s_add_u32 s23, s23, 22528
    s_add_u32 s20, s30, 67584
    s_cmp_ge_u32 s23, s20
    s_cselect_b32 s23, s30, s23
    s_add_u32 m0, s23, 0
    s_add_u32 s20, s24, 0
    buffer_load_dwordx4 v8, s[12:15], s20 offen lds
    s_add_u32 m0, s23, 8192
    s_add_u32 s20, s24, 8192
    buffer_load_dwordx4 v8, s[12:15], s20 offen lds
    s_cmp_ge_u32 s16, 6
    s_cbranch_scc1 k2_kernel_skipd_4
    s_add_u32 m0, s23, 16384
    s_add_u32 s20, s24, 16384
    buffer_load_dwordx4 v8, s[12:15], s20 offen lds
k2_kernel_skipd_4:
    s_add_u32 s24, s24, 22528
    s_add_u32 s23, s23, 22528
    s_add_u32 s20, s30, 67584
    s_cmp_ge_u32 s23, s20
    s_cselect_b32 s23, s30, s23
    s_lshl_b32 s19, s17, 11
    s_lshl_b32 s20, s18, 8
    s_add_u32 s19, s19, s20
    s_lshl_b32 s20, s16, 5
    s_add_u32 s19, s19, s20
    s_lshl_b32 s19, s19, 6
    s_add_u32 s19, s19, 0
    v_lshlrev_b32 v4, 6, v2
    v_lshl_add_u32 v4, v3, 4, v4
    buffer_load_dwordx4 v[12:15], v4, s[12:15], s19 offen
    buffer_load_dwordx4 v[16:19], v4, s[12:15], s19 offen offset:32
    v_mul_u32_u24 v9, 48, v2
    v_lshl_add_u32 v9, v3, 4, v9
    v_mul_u32_u24 v10, 528, v2
    v_lshl_add_u32 v10, v3, 4, v10
    v_add_u32 v10, 12288, v10
    v_mov_b32 v52, 0
    v_mov_b32 v53, 0
    v_mov_b32 v54, 0
    v_mov_b32 v55, 0
    v_mov_b32 v56, 0
    v_mov_b32 v57, 0
    v_mov_b32 v58, 0
    v_mov_b32 v59, 0
    v_mov_b32 v60, 0
    v_mov_b32 v61, 0
    v_mov_b32 v62, 0
    v_mov_b32 v63, 0
    v_mov_b32 v64, 0
    v_mov_b32 v65, 0
    v_mov_b32 v66, 0
    v_mov_b32 v67, 0
    s_waitcnt vmcnt(0)
    s_barrier
    ds_read_b128 v[68:71], v9 offset:0
    ds_read_b128 v[72:75], v9 offset:32
    ds_read_b128 v[76:79], v9 offset:1536
    ds_read_b128 v[80:83], v9 offset:1568
    ds_read_b128 v[84:87], v10 offset:0
    ds_read_b128 v[88:91], v10 offset:32
    s_waitcnt lgkmcnt(5)
    v_mfma_f32_32x32x16_bf16 v[20:35], v[68:71], v[12:15], 0
    s_waitcnt lgkmcnt(4)
    v_mfma_f32_32x32x16_bf16 v[20:35], v[72:75], v[16:19], v[20:35]
    s_nop 11
    v_max3_f32 v108, v20, v21, v22
    v_max3_f32 v109, v23, v24, v25
    v_max3_f32 v110, v26, v27, v28
    v_max3_f32 v111, v29, v30, v31
    v_max3_f32 v112, v32, v33, v34
    v_max3_f32 v108, v108, v109, v35
    v_max3_f32 v110, v110, v111, v112
    v_max_f32 v108, v108, v110
    v_mov_b32 v109, v108
    s_nop 1
    v_permlane32_swap_b32 v108, v109
    v_max_f32 v108, v108, v109
    v_sub_f32 v11, 0, v108
    v_cvt_pk_bf16_f32 v6, v11, v11
    v_lshlrev_b32 v7, 16, v6
    v_sub_f32 v11, v11, v7
    v_cvt_pk_bf16_f32 v6, v7, v11
    v_and_b32 v11, 0xffff0000, v6
    v_add_f32 v11, v11, v7
    v_cmp_eq_u32 vcc, 0, v3
    s_nop 1
    v_cndmask_b32 v17, v17, v6, vcc
    v_mfma_f32_32x32x16_bf16 v[20:35], v[68:71], v[12:15], 0
    s_nop 0
    v_mfma_f32_32x32x16_bf16 v[20:35], v[72:75], v[16:19], v[20:35]
    s_mov_b32 s25, 0
    s_mov_b32 s26, 0
k2_kernel_loop_6:
    s_waitcnt lgkmcnt(3)
    v_mfma_f32_32x32x16_bf16 v[36:51], v[76:79], v[12:15], 0
    s_nop 7
    v_exp_f32 v20, v20
    v_exp_f32 v21, v21
    v_exp_f32 v22, v22
    v_exp_f32 v23, v23
    s_waitcnt lgkmcnt(2)
    v_mfma_f32_32x32x16_bf16 v[36:51], v[80:83], v[16:19], v[36:51]
    ds_read_b128 v[68:71], v9 offset:3072
    ds_read_b128 v[72:75], v9 offset:3104
    ds_read_b128 v[92:95], v10 offset:64
    ds_read_b128 v[96:99], v10 offset:96
    v_exp_f32 v24, v24
    v_exp_f32 v25, v25
    v_exp_f32 v26, v26
    v_exp_f32 v27, v27
    v_cvt_pk_bf16_f32 v100, v20, v21
    v_cvt_pk_bf16_f32 v101, v22, v23
    v_cvt_pk_bf16_f32 v102, v24, v25
    v_cvt_pk_bf16_f32 v103, v26, v27
    v_exp_f32 v28, v28
    v_exp_f32 v29, v29
    v_exp_f32 v30, v30
    v_exp_f32 v31, v31
    s_waitcnt lgkmcnt(5)
    v_mfma_f32_32x32x16_bf16 v[52:67], v[84:87], v[100:103], v[52:67]
    v_exp_f32 v32, v32
    v_exp_f32 v33, v33
    v_exp_f32 v34, v34
    v_exp_f32 v35, v35
    v_cvt_pk_bf16_f32 v104, v28, v29
    v_cvt_pk_bf16_f32 v105, v30, v31
    v_cvt_pk_bf16_f32 v106, v32, v33
    v_cvt_pk_bf16_f32 v107, v34, v35
    s_waitcnt lgkmcnt(4)
    s_nop 0
    v_mfma_f32_32x32x16_bf16 v[52:67], v[88:91], v[104:107], v[52:67]
    s_waitcnt lgkmcnt(3)
    v_mfma_f32_32x32x16_bf16 v[20:35], v[68:71], v[12:15], 0
    v_exp_f32 v36, v36
    v_exp_f32 v37, v37
    v_exp_f32 v38, v38
    v_exp_f32 v39, v39
    s_waitcnt lgkmcnt(2)
    v_mfma_f32_32x32x16_bf16 v[20:35], v[72:75], v[16:19], v[20:35]
    ds_read_b128 v[76:79], v9 offset:4608
    ds_read_b128 v[80:83], v9 offset:4640
    ds_read_b128 v[84:87], v10 offset:128
    ds_read_b128 v[88:91], v10 offset:160
    v_exp_f32 v40, v40
    v_exp_f32 v41, v41
    v_exp_f32 v42, v42
    v_exp_f32 v43, v43
    v_cvt_pk_bf16_f32 v100, v36, v37
    v_cvt_pk_bf16_f32 v101, v38, v39
    v_cvt_pk_bf16_f32 v102, v40, v41
    v_cvt_pk_bf16_f32 v103, v42, v43
    v_exp_f32 v44, v44
    v_exp_f32 v45, v45
    v_exp_f32 v46, v46
    v_exp_f32 v47, v47
    s_waitcnt lgkmcnt(5)
    v_mfma_f32_32x32x16_bf16 v[52:67], v[92:95], v[100:103], v[52:67]
    v_exp_f32 v48, v48
    v_exp_f32 v49, v49
    v_exp_f32 v50, v50
    v_exp_f32 v51, v51
    v_cvt_pk_bf16_f32 v104, v44, v45
    v_cvt_pk_bf16_f32 v105, v46, v47
    v_cvt_pk_bf16_f32 v106, v48, v49
    v_cvt_pk_bf16_f32 v107, v50, v51
    s_waitcnt lgkmcnt(4)
    s_nop 0
    v_mfma_f32_32x32x16_bf16 v[52:67], v[96:99], v[104:107], v[52:67]
    s_waitcnt lgkmcnt(3)
    v_mfma_f32_32x32x16_bf16 v[36:51], v[76:79], v[12:15], 0
    v_exp_f32 v20, v20
    v_exp_f32 v21, v21
    v_exp_f32 v22, v22
    v_exp_f32 v23, v23
    s_waitcnt lgkmcnt(2)
    v_mfma_f32_32x32x16_bf16 v[36:51], v[80:83], v[16:19], v[36:51]
    ds_read_b128 v[68:71], v9 offset:6144
    ds_read_b128 v[72:75], v9 offset:6176
    ds_read_b128 v[92:95], v10 offset:192
    ds_read_b128 v[96:99], v10 offset:224
    v_exp_f32 v24, v24
    v_exp_f32 v25, v25
    v_exp_f32 v26, v26
    v_exp_f32 v27, v27
    v_cvt_pk_bf16_f32 v100, v20, v21
    v_cvt_pk_bf16_f32 v101, v22, v23
    v_cvt_pk_bf16_f32 v102, v24, v25
    v_cvt_pk_bf16_f32 v103, v26, v27
    v_exp_f32 v28, v28
    v_exp_f32 v29, v29
    v_exp_f32 v30, v30
    v_exp_f32 v31, v31
    s_waitcnt lgkmcnt(5)
    v_mfma_f32_32x32x16_bf16 v[52:67], v[84:87], v[100:103], v[52:67]
    v_exp_f32 v32, v32
    v_exp_f32 v33, v33
    v_exp_f32 v34, v34
    v_exp_f32 v35, v35
    v_cvt_pk_bf16_f32 v104, v28, v29
    v_cvt_pk_bf16_f32 v105, v30, v31
    v_cvt_pk_bf16_f32 v106, v32, v33
    v_cvt_pk_bf16_f32 v107, v34, v35
    s_waitcnt lgkmcnt(4)
    s_nop 0
    v_mfma_f32_32x32x16_bf16 v[52:67], v[88:91], v[104:107], v[52:67]
    s_waitcnt lgkmcnt(3)
    v_mfma_f32_32x32x16_bf16 v[20:35], v[68:71], v[12:15], 0
    v_exp_f32 v36, v36
    v_exp_f32 v37, v37
    v_exp_f32 v38, v38
    v_exp_f32 v39, v39
    s_waitcnt lgkmcnt(2)
    v_mfma_f32_32x32x16_bf16 v[20:35], v[72:75], v[16:19], v[20:35]
    ds_read_b128 v[76:79], v9 offset:7680
    ds_read_b128 v[80:83], v9 offset:7712
    ds_read_b128 v[84:87], v10 offset:256
    ds_read_b128 v[88:91], v10 offset:288
    v_exp_f32 v40, v40
    v_exp_f32 v41, v41
    v_exp_f32 v42, v42
    v_exp_f32 v43, v43
    v_cvt_pk_bf16_f32 v100, v36, v37
    v_cvt_pk_bf16_f32 v101, v38, v39
    v_cvt_pk_bf16_f32 v102, v40, v41
    v_cvt_pk_bf16_f32 v103, v42, v43
    v_exp_f32 v44, v44
    v_exp_f32 v45, v45
    v_exp_f32 v46, v46
    v_exp_f32 v47, v47
    s_waitcnt lgkmcnt(5)
    v_mfma_f32_32x32x16_bf16 v[52:67], v[92:95], v[100:103], v[52:67]
    v_exp_f32 v48, v48
    v_exp_f32 v49, v49
    v_exp_f32 v50, v50
    v_exp_f32 v51, v51
    v_cvt_pk_bf16_f32 v104, v44, v45
    v_cvt_pk_bf16_f32 v105, v46, v47
    v_cvt_pk_bf16_f32 v106, v48, v49
    v_cvt_pk_bf16_f32 v107, v50, v51
    s_waitcnt lgkmcnt(4)
    s_nop 0
    v_mfma_f32_32x32x16_bf16 v[52:67], v[96:99], v[104:107], v[52:67]
    s_waitcnt lgkmcnt(3)
    v_mfma_f32_32x32x16_bf16 v[36:51], v[76:79], v[12:15], 0
    v_exp_f32 v20, v20
    v_exp_f32 v21, v21
    v_exp_f32 v22, v22
    v_exp_f32 v23, v23
    s_waitcnt lgkmcnt(2)
    v_mfma_f32_32x32x16_bf16 v[36:51], v[80:83], v[16:19], v[36:51]
    ds_read_b128 v[68:71], v9 offset:9216
    ds_read_b128 v[72:75], v9 offset:9248
    ds_read_b128 v[92:95], v10 offset:320
    ds_read_b128 v[96:99], v10 offset:352
    v_exp_f32 v24, v24
    v_exp_f32 v25, v25
    v_exp_f32 v26, v26
    v_exp_f32 v27, v27
    v_cvt_pk_bf16_f32 v100, v20, v21
    v_cvt_pk_bf16_f32 v101, v22, v23
    v_cvt_pk_bf16_f32 v102, v24, v25
    v_cvt_pk_bf16_f32 v103, v26, v27
    v_exp_f32 v28, v28
    v_exp_f32 v29, v29
    v_exp_f32 v30, v30
    v_exp_f32 v31, v31
    s_waitcnt lgkmcnt(5)
    v_mfma_f32_32x32x16_bf16 v[52:67], v[84:87], v[100:103], v[52:67]
    v_exp_f32 v32, v32
    v_exp_f32 v33, v33
    v_exp_f32 v34, v34
    v_exp_f32 v35, v35
    v_cvt_pk_bf16_f32 v104, v28, v29
    v_cvt_pk_bf16_f32 v105, v30, v31
    v_cvt_pk_bf16_f32 v106, v32, v33
    v_cvt_pk_bf16_f32 v107, v34, v35
    s_waitcnt lgkmcnt(4)
    s_nop 0
    v_mfma_f32_32x32x16_bf16 v[52:67], v[88:91], v[104:107], v[52:67]
    s_waitcnt lgkmcnt(3)
    v_mfma_f32_32x32x16_bf16 v[20:35], v[68:71], v[12:15], 0
    v_exp_f32 v36, v36
    v_exp_f32 v37, v37
    v_exp_f32 v38, v38
    v_exp_f32 v39, v39
    s_waitcnt lgkmcnt(2)
    v_mfma_f32_32x32x16_bf16 v[20:35], v[72:75], v[16:19], v[20:35]
    ds_read_b128 v[76:79], v9 offset:10752
    ds_read_b128 v[80:83], v9 offset:10784
    ds_read_b128 v[84:87], v10 offset:384
    ds_read_b128 v[88:91], v10 offset:416
    v_exp_f32 v40, v40
    v_exp_f32 v41, v41
    v_exp_f32 v42, v42
    v_exp_f32 v43, v43
    v_cvt_pk_bf16_f32 v100, v36, v37
    v_cvt_pk_bf16_f32 v101, v38, v39
    v_cvt_pk_bf16_f32 v102, v40, v41
    v_cvt_pk_bf16_f32 v103, v42, v43
    v_exp_f32 v44, v44
    v_exp_f32 v45, v45
    v_exp_f32 v46, v46
    v_exp_f32 v47, v47
    s_waitcnt lgkmcnt(5)
    v_mfma_f32_32x32x16_bf16 v[52:67], v[92:95], v[100:103], v[52:67]
    v_exp_f32 v48, v48
    v_exp_f32 v49, v49
    v_exp_f32 v50, v50
    v_exp_f32 v51, v51
    v_cvt_pk_bf16_f32 v104, v44, v45
    v_cvt_pk_bf16_f32 v105, v46, v47
    v_cvt_pk_bf16_f32 v106, v48, v49
    v_cvt_pk_bf16_f32 v107, v50, v51
    s_waitcnt lgkmcnt(4)
    s_nop 0
    v_mfma_f32_32x32x16_bf16 v[52:67], v[96:99], v[104:107], v[52:67]
    s_waitcnt lgkmcnt(3)
    v_mfma_f32_32x32x16_bf16 v[36:51], v[76:79], v[12:15], 0
    v_exp_f32 v20, v20
    v_exp_f32 v21, v21
    v_exp_f32 v22, v22
    v_exp_f32 v23, v23
    s_waitcnt lgkmcnt(2)
    v_mfma_f32_32x32x16_bf16 v[36:51], v[80:83], v[16:19], v[36:51]
    s_waitcnt vmcnt(0)
    s_barrier
    s_cmp_ge_u32 s25, 6
    s_cbranch_scc1 k2_kernel_nodma_7
    s_add_u32 m0, s23, 0
    s_add_u32 s20, s24, 0
    buffer_load_dwordx4 v8, s[12:15], s20 offen lds
    s_add_u32 m0, s23, 8192
    s_add_u32 s20, s24, 8192
    buffer_load_dwordx4 v8, s[12:15], s20 offen lds
    s_cmp_ge_u32 s16, 6
    s_cbranch_scc1 k2_kernel_skipd_8
    s_add_u32 m0, s23, 16384
    s_add_u32 s20, s24, 16384
    buffer_load_dwordx4 v8, s[12:15], s20 offen lds
k2_kernel_skipd_8:
    s_add_u32 s24, s24, 22528
    s_add_u32 s23, s23, 22528
    s_add_u32 s20, s30, 67584
    s_cmp_ge_u32 s23, s20
    s_cselect_b32 s23, s30, s23
k2_kernel_nodma_7:
    s_add_u32 s26, s26, 1
    s_cmp_ge_u32 s26, 3
    s_cselect_b32 s26, 0, s26
    s_mov_b32 s19, 22528
    s_cselect_b32 s19, -45056, s19
    v_add_u32 v9, s19, v9
    ds_read_b128 v[68:71], v9 offset:0
    ds_read_b128 v[72:75], v9 offset:32
    ds_read_b128 v[92:95], v10 offset:448
    ds_read_b128 v[96:99], v10 offset:480
    v_exp_f32 v24, v24
    v_exp_f32 v25, v25
    v_exp_f32 v26, v26
    v_exp_f32 v27, v27
    v_cvt_pk_bf16_f32 v100, v20, v21
    v_cvt_pk_bf16_f32 v101, v22, v23
    v_cvt_pk_bf16_f32 v102, v24, v25
    v_cvt_pk_bf16_f32 v103, v26, v27
    v_exp_f32 v28, v28
    v_exp_f32 v29, v29
    v_exp_f32 v30, v30
    v_exp_f32 v31, v31
    s_waitcnt lgkmcnt(5)
    v_mfma_f32_32x32x16_bf16 v[52:67], v[84:87], v[100:103], v[52:67]
    v_exp_f32 v32, v32
    v_exp_f32 v33, v33
    v_exp_f32 v34, v34
    v_exp_f32 v35, v35
    v_cvt_pk_bf16_f32 v104, v28, v29
    v_cvt_pk_bf16_f32 v105, v30, v31
    v_cvt_pk_bf16_f32 v106, v32, v33
    v_cvt_pk_bf16_f32 v107, v34, v35
    s_waitcnt lgkmcnt(4)
    s_nop 0
    v_mfma_f32_32x32x16_bf16 v[52:67], v[88:91], v[104:107], v[52:67]
    s_waitcnt lgkmcnt(3)
    v_mfma_f32_32x32x16_bf16 v[20:35], v[68:71], v[12:15], 0
    v_exp_f32 v36, v36
    v_exp_f32 v37, v37
    v_exp_f32 v38, v38
    v_exp_f32 v39, v39
    s_waitcnt lgkmcnt(2)
    v_mfma_f32_32x32x16_bf16 v[20:35], v[72:75], v[16:19], v[20:35]
    v_add_u32 v10, s19, v10
    ds_read_b128 v[76:79], v9 offset:1536
    ds_read_b128 v[80:83], v9 offset:1568
    ds_read_b128 v[84:87], v10 offset:0
    ds_read_b128 v[88:91], v10 offset:32
    v_exp_f32 v40, v40
    v_exp_f32 v41, v41
    v_exp_f32 v42, v42
    v_exp_f32 v43, v43
    v_cvt_pk_bf16_f32 v100, v36, v37
    v_cvt_pk_bf16_f32 v101, v38, v39
    v_cvt_pk_bf16_f32 v102, v40, v41
    v_cvt_pk_bf16_f32 v103, v42, v43
    v_exp_f32 v44, v44
    v_exp_f32 v45, v45
    v_exp_f32 v46, v46
    v_exp_f32 v47, v47
    s_waitcnt lgkmcnt(5)
    v_mfma_f32_32x32x16_bf16 v[52:67], v[92:95], v[100:103], v[52:67]
    v_exp_f32 v48, v48
    v_exp_f32 v49, v49
    v_exp_f32 v50, v50
    v_exp_f32 v51, v51
    v_cvt_pk_bf16_f32 v104, v44, v45
    v_cvt_pk_bf16_f32 v105, v46, v47
    v_cvt_pk_bf16_f32 v106, v48, v49
    v_cvt_pk_bf16_f32 v107, v50, v51
    s_waitcnt lgkmcnt(4)
    s_nop 0
    v_mfma_f32_32x32x16_bf16 v[52:67], v[96:99], v[104:107], v[52:67]
    s_add_u32 s25, s25, 1
    s_cmp_lt_u32 s25, 8
    s_cbranch_scc1 k2_kernel_loop_6
    s_mov_b32 s19, 1568669696
    s_nop 7
    v_cmp_nlt_f32 vcc, v62, s19
    s_nop 1
    s_cmp_lg_u32 vcc_lo, 0
    s_cselect_b32 s19, 1, 0
    v_mov_b32 v4, s19
    s_lshl_b32 s20, s16, 2
    s_add_u32 s20, s20, 67584
    v_mov_b32 v5, s20
    ds_write_b32 v5, v4
    v_mov_b32 v5, 67584
    s_waitcnt lgkmcnt(0)
    s_barrier
    ds_read_b128 v[100:103], v5
    ds_read_b128 v[104:107], v5 offset:16
    s_waitcnt lgkmcnt(1)
    v_or3_b32 v4, v100, v101, v102
    s_waitcnt lgkmcnt(0)
    v_or3_b32 v5, v103, v104, v105
    v_or3_b32 v4, v4, v106, v107
    v_or_b32 v4, v4, v5
    s_nop 0
    v_readfirstlane_b32 s19, v4
    s_nop 1
    s_cmp_eq_u32 s19, 0
    s_cbranch_scc1 k2_kernel_done_5
    s_mov_b32 s24, s31
    s_mov_b32 s23, s30
    s_add_u32 m0, s23, 0
    s_add_u32 s20, s24, 0
    buffer_load_dwordx4 v8, s[12:15], s20 offen lds
    s_add_u32 m0, s23, 8192
    s_add_u32 s20, s24, 8192
    buffer_load_dwordx4 v8, s[12:15], s20 offen lds
    s_cmp_ge_u32 s16, 6
    s_cbranch_scc1 k2_kernel_skipd_9
    s_add_u32 m0, s23, 16384
    s_add_u32 s20, s24, 16384
    buffer_load_dwordx4 v8, s[12:15], s20 offen lds
k2_kernel_skipd_9:
    s_add_u32 s24, s24, 22528
    s_add_u32 s23, s23, 22528
    s_add_u32 s20, s30, 67584
    s_cmp_ge_u32 s23, s20
    s_cselect_b32 s23, s30, s23
    s_add_u32 m0, s23, 0
    s_add_u32 s20, s24, 0
    buffer_load_dwordx4 v8, s[12:15], s20 offen lds
    s_add_u32 m0, s23, 8192
    s_add_u32 s20, s24, 8192
    buffer_load_dwordx4 v8, s[12:15], s20 offen lds
    s_cmp_ge_u32 s16, 6
    s_cbranch_scc1 k2_kernel_skipd_10
    s_add_u32 m0, s23, 16384
    s_add_u32 s20, s24, 16384
    buffer_load_dwordx4 v8, s[12:15], s20 offen lds
k2_kernel_skipd_10:
    s_add_u32 s24, s24, 22528
    s_add_u32 s23, s23, 22528
    s_add_u32 s20, s30, 67584
    s_cmp_ge_u32 s23, s20
    s_cselect_b32 s23, s30, s23
    v_mul_u32_u24 v9, 48, v2
    v_lshl_add_u32 v9, v3, 4, v9
    v_mul_u32_u24 v10, 528, v2
    v_lshl_add_u32 v10, v3, 4, v10
    v_add_u32 v10, 12288, v10
    v_mov_b32 v52, 0
    v_mov_b32 v53, 0
    v_mov_b32 v54, 0
    v_mov_b32 v55, 0
    v_mov_b32 v56, 0
    v_mov_b32 v57, 0
    v_mov_b32 v58, 0
    v_mov_b32 v59, 0
    v_mov_b32 v60, 0
    v_mov_b32 v61, 0
    v_mov_b32 v62, 0
    v_mov_b32 v63, 0
    v_mov_b32 v64, 0
    v_mov_b32 v65, 0
    v_mov_b32 v66, 0
    v_mov_b32 v67, 0
    s_waitcnt vmcnt(0)
    s_barrier
    ds_read_b128 v[68:71], v9 offset:0
    ds_read_b128 v[72:75], v9 offset:32
    ds_read_b128 v[76:79], v9 offset:1536
    ds_read_b128 v[80:83], v9 offset:1568
    ds_read_b128 v[84:87], v10 offset:0
    ds_read_b128 v[88:91], v10 offset:32
    v_cmp_eq_u32 vcc, 0, v3
    v_mov_b32 v6, 0
    s_nop 0
    v_cndmask_b32 v17, v17, v6, vcc
    s_waitcnt lgkmcnt(5)
    v_mfma_f32_32x32x16_bf16 v[20:35], v[68:71], v[12:15], 0
    s_waitcnt lgkmcnt(4)
    v_mfma_f32_32x32x16_bf16 v[20:35], v[72:75], v[16:19], v[20:35]
    s_nop 11
    v_max3_f32 v108, v20, v21, v22
    v_max3_f32 v109, v23, v24, v25
    v_max3_f32 v110, v26, v27, v28
    v_max3_f32 v111, v29, v30, v31
    v_max3_f32 v112, v32, v33, v34
    v_max3_f32 v108, v108, v109, v35
    v_max3_f32 v110, v110, v111, v112
    v_max_f32 v108, v108, v110
    v_mov_b32 v109, v108
    s_nop 1
    v_permlane32_swap_b32 v108, v109
    v_max_f32 v108, v108, v109
    v_sub_f32 v11, 0, v108
    v_cvt_pk_bf16_f32 v6, v11, v11
    v_lshlrev_b32 v7, 16, v6
    v_sub_f32 v11, v11, v7
    v_cvt_pk_bf16_f32 v6, v7, v11
    v_and_b32 v11, 0xffff0000, v6
    v_add_f32 v11, v11, v7
    v_cmp_eq_u32 vcc, 0, v3
    s_nop 1
    v_cndmask_b32 v17, v17, v6, vcc
    v_mfma_f32_32x32x16_bf16 v[20:35], v[68:71], v[12:15], 0
    s_nop 0
    v_mfma_f32_32x32x16_bf16 v[20:35], v[72:75], v[16:19], v[20:35]
    s_mov_b32 s25, 0
    s_mov_b32 s26, 0
k2_kernel_loop_11:
    s_nop 9
    v_max3_f32 v108, v20, v21, v22
    v_max3_f32 v109, v23, v24, v25
    v_max3_f32 v110, v26, v27, v28
    v_max3_f32 v111, v29, v30, v31
    v_max3_f32 v112, v32, v33, v34
    v_max3_f32 v108, v108, v109, v35
    v_max3_f32 v110, v110, v111, v112
    v_max_f32 v108, v108, v110
    v_cmp_lt_f32 vcc, 1090519040, v108
    s_nop 4
    s_cbranch_vccnz k2_kernel_slow_12
k2_kernel_back_13:
    s_waitcnt lgkmcnt(3)
    v_mfma_f32_32x32x16_bf16 v[36:51], v[76:79], v[12:15], 0
    v_exp_f32 v20, v20
    v_exp_f32 v21, v21
    v_exp_f32 v22, v22
    v_exp_f32 v23, v23
    s_waitcnt lgkmcnt(2)
    v_mfma_f32_32x32x16_bf16 v[36:51], v[80:83], v[16:19], v[36:51]
    ds_read_b128 v[68:71], v9 offset:3072
    ds_read_b128 v[72:75], v9 offset:3104
    ds_read_b128 v[92:95], v10 offset:64
    ds_read_b128 v[96:99], v10 offset:96
    v_exp_f32 v24, v24
    v_exp_f32 v25, v25
    v_exp_f32 v26, v26
    v_exp_f32 v27, v27
    v_cvt_pk_bf16_f32 v100, v20, v21
    v_cvt_pk_bf16_f32 v101, v22, v23
    v_cvt_pk_bf16_f32 v102, v24, v25
    v_cvt_pk_bf16_f32 v103, v26, v27
    v_exp_f32 v28, v28
    v_exp_f32 v29, v29
    v_exp_f32 v30, v30
    v_exp_f32 v31, v31
    s_waitcnt lgkmcnt(5)
    v_mfma_f32_32x32x16_bf16 v[52:67], v[84:87], v[100:103], v[52:67]
    v_exp_f32 v32, v32
    v_exp_f32 v33, v33
    v_exp_f32 v34, v34
    v_exp_f32 v35, v35
    v_cvt_pk_bf16_f32 v104, v28, v29
    v_cvt_pk_bf16_f32 v105, v30, v31
    v_cvt_pk_bf16_f32 v106, v32, v33
    v_cvt_pk_bf16_f32 v107, v34, v35
    s_waitcnt lgkmcnt(4)
    s_nop 0
    v_mfma_f32_32x32x16_bf16 v[52:67], v[88:91], v[104:107], v[52:67]
    v_max3_f32 v108, v36, v37, v38
    v_max3_f32 v109, v39, v40, v41
    v_max3_f32 v110, v42, v43, v44
    v_max3_f32 v111, v45, v46, v47
    v_max3_f32 v112, v48, v49, v50
    v_max3_f32 v108, v108, v109, v51
    v_max3_f32 v110, v110, v111, v112
    v_max_f32 v108, v108, v110
    v_cmp_lt_f32 vcc, 1090519040, v108
    s_nop 4
    s_cbranch_vccnz k2_kernel_slow_14
k2_kernel_back_15:
    s_waitcnt lgkmcnt(3)
    v_mfma_f32_32x32x16_bf16 v[20:35], v[68:71], v[12:15], 0
    v_exp_f32 v36, v36
    v_exp_f32 v37, v37
    v_exp_f32 v38, v38
    v_exp_f32 v39, v39
    s_waitcnt lgkmcnt(2)
    v_mfma_f32_32x32x16_bf16 v[20:35], v[72:75], v[16:19], v[20:35]
    ds_read_b128 v[76:79], v9 offset:4608
    ds_read_b128 v[80:83], v9 offset:4640
    ds_read_b128 v[84:87], v10 offset:128
    ds_read_b128 v[88:91], v10 offset:160
    v_exp_f32 v40, v40
    v_exp_f32 v41, v41
    v_exp_f32 v42, v42
    v_exp_f32 v43, v43
    v_cvt_pk_bf16_f32 v100, v36, v37
    v_cvt_pk_bf16_f32 v101, v38, v39
    v_cvt_pk_bf16_f32 v102, v40, v41
    v_cvt_pk_bf16_f32 v103, v42, v43
    v_exp_f32 v44, v44
    v_exp_f32 v45, v45
    v_exp_f32 v46, v46
    v_exp_f32 v47, v47
    s_waitcnt lgkmcnt(5)
    v_mfma_f32_32x32x16_bf16 v[52:67], v[92:95], v[100:103], v[52:67]
    v_exp_f32 v48, v48
    v_exp_f32 v49, v49
    v_exp_f32 v50, v50
    v_exp_f32 v51, v51
    v_cvt_pk_bf16_f32 v104, v44, v45
    v_cvt_pk_bf16_f32 v105, v46, v47
    v_cvt_pk_bf16_f32 v106, v48, v49
    v_cvt_pk_bf16_f32 v107, v50, v51
    s_waitcnt lgkmcnt(4)
    s_nop 0
    v_mfma_f32_32x32x16_bf16 v[52:67], v[96:99], v[104:107], v[52:67]
    v_max3_f32 v108, v20, v21, v22
    v_max3_f32 v109, v23, v24, v25
    v_max3_f32 v110, v26, v27, v28
    v_max3_f32 v111, v29, v30, v31
    v_max3_f32 v112, v32, v33, v34
    v_max3_f32 v108, v108, v109, v35
    v_max3_f32 v110, v110, v111, v112
    v_max_f32 v108, v108, v110
    v_cmp_lt_f32 vcc, 1090519040, v108
    s_nop 4
    s_cbranch_vccnz k2_kernel_slow_16
k2_kernel_back_17:
    s_waitcnt lgkmcnt(3)
    v_mfma_f32_32x32x16_bf16 v[36:51], v[76:79], v[12:15], 0
    v_exp_f32 v20, v20
    v_exp_f32 v21, v21
    v_exp_f32 v22, v22
    v_exp_f32 v23, v23
    s_waitcnt lgkmcnt(2)
    v_mfma_f32_32x32x16_bf16 v[36:51], v[80:83], v[16:19], v[36:51]
    ds_read_b128 v[68:71], v9 offset:6144
    ds_read_b128 v[72:75], v9 offset:6176
    ds_read_b128 v[92:95], v10 offset:192
    ds_read_b128 v[96:99], v10 offset:224
    v_exp_f32 v24, v24
    v_exp_f32 v25, v25
    v_exp_f32 v26, v26
    v_exp_f32 v27, v27
    v_cvt_pk_bf16_f32 v100, v20, v21
    v_cvt_pk_bf16_f32 v101, v22, v23
    v_cvt_pk_bf16_f32 v102, v24, v25
    v_cvt_pk_bf16_f32 v103, v26, v27
    v_exp_f32 v28, v28
    v_exp_f32 v29, v29
    v_exp_f32 v30, v30
    v_exp_f32 v31, v31
    s_waitcnt lgkmcnt(5)
    v_mfma_f32_32x32x16_bf16 v[52:67], v[84:87], v[100:103], v[52:67]
    v_exp_f32 v32, v32
    v_exp_f32 v33, v33
    v_exp_f32 v34, v34
    v_exp_f32 v35, v35
    v_cvt_pk_bf16_f32 v104, v28, v29
    v_cvt_pk_bf16_f32 v105, v30, v31
    v_cvt_pk_bf16_f32 v106, v32, v33
    v_cvt_pk_bf16_f32 v107, v34, v35
    s_waitcnt lgkmcnt(4)
    s_nop 0
    v_mfma_f32_32x32x16_bf16 v[52:67], v[88:91], v[104:107], v[52:67]
    v_max3_f32 v108, v36, v37, v38
    v_max3_f32 v109, v39, v40, v41
    v_max3_f32 v110, v42, v43, v44
    v_max3_f32 v111, v45, v46, v47
    v_max3_f32 v112, v48, v49, v50
    v_max3_f32 v108, v108, v109, v51
    v_max3_f32 v110, v110, v111, v112
    v_max_f32 v108, v108, v110
    v_cmp_lt_f32 vcc, 1090519040, v108
    s_nop 4
    s_cbranch_vccnz k2_kernel_slow_18
k2_kernel_back_19:
    s_waitcnt lgkmcnt(3)
    v_mfma_f32_32x32x16_bf16 v[20:35], v[68:71], v[12:15], 0
    v_exp_f32 v36, v36
    v_exp_f32 v37, v37
    v_exp_f32 v38, v38
    v_exp_f32 v39, v39
    s_waitcnt lgkmcnt(2)
    v_mfma_f32_32x32x16_bf16 v[20:35], v[72:75], v[16:19], v[20:35]
    ds_read_b128 v[76:79], v9 offset:7680
    ds_read_b128 v[80:83], v9 offset:7712
    ds_read_b128 v[84:87], v10 offset:256
    ds_read_b128 v[88:91], v10 offset:288
    v_exp_f32 v40, v40
    v_exp_f32 v41, v41
    v_exp_f32 v42, v42
    v_exp_f32 v43, v43
    v_cvt_pk_bf16_f32 v100, v36, v37
    v_cvt_pk_bf16_f32 v101, v38, v39
    v_cvt_pk_bf16_f32 v102, v40, v41
    v_cvt_pk_bf16_f32 v103, v42, v43
    v_exp_f32 v44, v44
    v_exp_f32 v45, v45
    v_exp_f32 v46, v46
    v_exp_f32 v47, v47
    s_waitcnt lgkmcnt(5)
    v_mfma_f32_32x32x16_bf16 v[52:67], v[92:95], v[100:103], v[52:67]
    v_exp_f32 v48, v48
    v_exp_f32 v49, v49
    v_exp_f32 v50, v50
    v_exp_f32 v51, v51
    v_cvt_pk_bf16_f32 v104, v44, v45
    v_cvt_pk_bf16_f32 v105, v46, v47
    v_cvt_pk_bf16_f32 v106, v48, v49
    v_cvt_pk_bf16_f32 v107, v50, v51
    s_waitcnt lgkmcnt(4)
    s_nop 0
    v_mfma_f32_32x32x16_bf16 v[52:67], v[96:99], v[104:107], v[52:67]
    v_max3_f32 v108, v20, v21, v22
    v_max3_f32 v109, v23, v24, v25
    v_max3_f32 v110, v26, v27, v28
    v_max3_f32 v111, v29, v30, v31
    v_max3_f32 v112, v32, v33, v34
    v_max3_f32 v108, v108, v109, v35
    v_max3_f32 v110, v110, v111, v112
    v_max_f32 v108, v108, v110
    v_cmp_lt_f32 vcc, 1090519040, v108
    s_nop 4
    s_cbranch_vccnz k2_kernel_slow_20
k2_kernel_back_21:
    s_waitcnt lgkmcnt(3)
    v_mfma_f32_32x32x16_bf16 v[36:51], v[76:79], v[12:15], 0
    v_exp_f32 v20, v20
    v_exp_f32 v21, v21
    v_exp_f32 v22, v22
    v_exp_f32 v23, v23
    s_waitcnt lgkmcnt(2)
    v_mfma_f32_32x32x16_bf16 v[36:51], v[80:83], v[16:19], v[36:51]
    ds_read_b128 v[68:71], v9 offset:9216
    ds_read_b128 v[72:75], v9 offset:9248
    ds_read_b128 v[92:95], v10 offset:320
    ds_read_b128 v[96:99], v10 offset:352
    v_exp_f32 v24, v24
    v_exp_f32 v25, v25
    v_exp_f32 v26, v26
    v_exp_f32 v27, v27
    v_cvt_pk_bf16_f32 v100, v20, v21
    v_cvt_pk_bf16_f32 v101, v22, v23
    v_cvt_pk_bf16_f32 v102, v24, v25
    v_cvt_pk_bf16_f32 v103, v26, v27
    v_exp_f32 v28, v28
    v_exp_f32 v29, v29
    v_exp_f32 v30, v30
    v_exp_f32 v31, v31
    s_waitcnt lgkmcnt(5)
    v_mfma_f32_32x32x16_bf16 v[52:67], v[84:87], v[100:103], v[52:67]
    v_exp_f32 v32, v32
    v_exp_f32 v33, v33
    v_exp_f32 v34, v34
    v_exp_f32 v35, v35
    v_cvt_pk_bf16_f32 v104, v28, v29
    v_cvt_pk_bf16_f32 v105, v30, v31
    v_cvt_pk_bf16_f32 v106, v32, v33
    v_cvt_pk_bf16_f32 v107, v34, v35
    s_waitcnt lgkmcnt(4)
    s_nop 0
    v_mfma_f32_32x32x16_bf16 v[52:67], v[88:91], v[104:107], v[52:67]
    v_max3_f32 v108, v36, v37, v38
    v_max3_f32 v109, v39, v40, v41
    v_max3_f32 v110, v42, v43, v44
    v_max3_f32 v111, v45, v46, v47
    v_max3_f32 v112, v48, v49, v50
    v_max3_f32 v108, v108, v109, v51
    v_max3_f32 v110, v110, v111, v112
    v_max_f32 v108, v108, v110
    v_cmp_lt_f32 vcc, 1090519040, v108
    s_nop 4
    s_cbranch_vccnz k2_kernel_slow_22
k2_kernel_back_23:
    s_waitcnt lgkmcnt(3)
    v_mfma_f32_32x32x16_bf16 v[20:35], v[68:71], v[12:15], 0
    v_exp_f32 v36, v36
    v_exp_f32 v37, v37
    v_exp_f32 v38, v38
    v_exp_f32 v39, v39
    s_waitcnt lgkmcnt(2)
    v_mfma_f32_32x32x16_bf16 v[20:35], v[72:75], v[16:19], v[20:35]
    ds_read_b128 v[76:79], v9 offset:10752
    ds_read_b128 v[80:83], v9 offset:10784
    ds_read_b128 v[84:87], v10 offset:384
    ds_read_b128 v[88:91], v10 offset:416
    v_exp_f32 v40, v40
    v_exp_f32 v41, v41
    v_exp_f32 v42, v42
    v_exp_f32 v43, v43
    v_cvt_pk_bf16_f32 v100, v36, v37
    v_cvt_pk_bf16_f32 v101, v38, v39
    v_cvt_pk_bf16_f32 v102, v40, v41
    v_cvt_pk_bf16_f32 v103, v42, v43
    v_exp_f32 v44, v44
    v_exp_f32 v45, v45
    v_exp_f32 v46, v46
    v_exp_f32 v47, v47
    s_waitcnt lgkmcnt(5)
    v_mfma_f32_32x32x16_bf16 v[52:67], v[92:95], v[100:103], v[52:67]
    v_exp_f32 v48, v48
    v_exp_f32 v49, v49
    v_exp_f32 v50, v50
    v_exp_f32 v51, v51
    v_cvt_pk_bf16_f32 v104, v44, v45
    v_cvt_pk_bf16_f32 v105, v46, v47
    v_cvt_pk_bf16_f32 v106, v48, v49
    v_cvt_pk_bf16_f32 v107, v50, v51
    s_waitcnt lgkmcnt(4)
    s_nop 0
    v_mfma_f32_32x32x16_bf16 v[52:67], v[96:99], v[104:107], v[52:67]
    v_max3_f32 v108, v20, v21, v22
    v_max3_f32 v109, v23, v24, v25
    v_max3_f32 v110, v26, v27, v28
    v_max3_f32 v111, v29, v30, v31
    v_max3_f32 v112, v32, v33, v34
    v_max3_f32 v108, v108, v109, v35
    v_max3_f32 v110, v110, v111, v112
    v_max_f32 v108, v108, v110
    v_cmp_lt_f32 vcc, 1090519040, v108
    s_nop 4
    s_cbranch_vccnz k2_kernel_slow_24
k2_kernel_back_25:
    s_waitcnt lgkmcnt(3)
    v_mfma_f32_32x32x16_bf16 v[36:51], v[76:79], v[12:15], 0
    v_exp_f32 v20, v20
    v_exp_f32 v21, v21
    v_exp_f32 v22, v22
    v_exp_f32 v23, v23
    s_waitcnt lgkmcnt(2)
    v_mfma_f32_32x32x16_bf16 v[36:51], v[80:83], v[16:19], v[36:51]
    s_waitcnt vmcnt(0)
    s_barrier
    s_cmp_ge_u32 s25, 6
    s_cbranch_scc1 k2_kernel_nodma_26
    s_add_u32 m0, s23, 0
    s_add_u32 s20, s24, 0
    buffer_load_dwordx4 v8, s[12:15], s20 offen lds
    s_add_u32 m0, s23, 8192
    s_add_u32 s20, s24, 8192
    buffer_load_dwordx4 v8, s[12:15], s20 offen lds
    s_cmp_ge_u32 s16, 6
    s_cbranch_scc1 k2_kernel_skipd_27
    s_add_u32 m0, s23, 16384
    s_add_u32 s20, s24, 16384
    buffer_load_dwordx4 v8, s[12:15], s20 offen lds
k2_kernel_skipd_27:
    s_add_u32 s24, s24, 22528
    s_add_u32 s23, s23, 22528
    s_add_u32 s20, s30, 67584
    s_cmp_ge_u32 s23, s20
    s_cselect_b32 s23, s30, s23
k2_kernel_nodma_26:
    s_add_u32 s26, s26, 1
    s_cmp_ge_u32 s26, 3
    s_cselect_b32 s26, 0, s26
    s_mov_b32 s19, 22528
    s_cselect_b32 s19, -45056, s19
    v_add_u32 v9, s19, v9
    ds_read_b128 v[68:71], v9 offset:0
    ds_read_b128 v[72:75], v9 offset:32
    ds_read_b128 v[92:95], v10 offset:448
    ds_read_b128 v[96:99], v10 offset:480
    v_exp_f32 v24, v24
    v_exp_f32 v25, v25
    v_exp_f32 v26, v26
    v_exp_f32 v27, v27
    v_cvt_pk_bf16_f32 v100, v20, v21
    v_cvt_pk_bf16_f32 v101, v22, v23
    v_cvt_pk_bf16_f32 v102, v24, v25
    v_cvt_pk_bf16_f32 v103, v26, v27
    v_exp_f32 v28, v28
    v_exp_f32 v29, v29
    v_exp_f32 v30, v30
    v_exp_f32 v31, v31
    s_waitcnt lgkmcnt(5)
    v_mfma_f32_32x32x16_bf16 v[52:67], v[84:87], v[100:103], v[52:67]
    v_exp_f32 v32, v32
    v_exp_f32 v33, v33
    v_exp_f32 v34, v34
    v_exp_f32 v35, v35
    v_cvt_pk_bf16_f32 v104, v28, v29
    v_cvt_pk_bf16_f32 v105, v30, v31
    v_cvt_pk_bf16_f32 v106, v32, v33
    v_cvt_pk_bf16_f32 v107, v34, v35
    s_waitcnt lgkmcnt(4)
    s_nop 0
    v_mfma_f32_32x32x16_bf16 v[52:67], v[88:91], v[104:107], v[52:67]
    v_max3_f32 v108, v36, v37, v38
    v_max3_f32 v109, v39, v40, v41
    v_max3_f32 v110, v42, v43, v44
    v_max3_f32 v111, v45, v46, v47
    v_max3_f32 v112, v48, v49, v50
    v_max3_f32 v108, v108, v109, v51
    v_max3_f32 v110, v110, v111, v112
    v_max_f32 v108, v108, v110
    v_cmp_lt_f32 vcc, 1090519040, v108
    s_nop 4
    s_cbranch_vccnz k2_kernel_slow_28
k2_kernel_back_29:
    s_waitcnt lgkmcnt(3)
    v_mfma_f32_32x32x16_bf16 v[20:35], v[68:71], v[12:15], 0
    v_exp_f32 v36, v36
    v_exp_f32 v37, v37
    v_exp_f32 v38, v38
    v_exp_f32 v39, v39
    s_waitcnt lgkmcnt(2)
    v_mfma_f32_32x32x16_bf16 v[20:35], v[72:75], v[16:19], v[20:35]
    v_add_u32 v10, s19, v10
    ds_read_b128 v[76:79], v9 offset:1536
    ds_read_b128 v[80:83], v9 offset:1568
    ds_read_b128 v[84:87], v10 offset:0
    ds_read_b128 v[88:91], v10 offset:32
    v_exp_f32 v40, v40
    v_exp_f32 v41, v41
    v_exp_f32 v42, v42
    v_exp_f32 v43, v43
    v_cvt_pk_bf16_f32 v100, v36, v37
    v_cvt_pk_bf16_f32 v101, v38, v39
    v_cvt_pk_bf16_f32 v102, v40, v41
    v_cvt_pk_bf16_f32 v103, v42, v43
    v_exp_f32 v44, v44
    v_exp_f32 v45, v45
    v_exp_f32 v46, v46
    v_exp_f32 v47, v47
    s_waitcnt lgkmcnt(5)
    v_mfma_f32_32x32x16_bf16 v[52:67], v[92:95], v[100:103], v[52:67]
    v_exp_f32 v48, v48
    v_exp_f32 v49, v49
    v_exp_f32 v50, v50
    v_exp_f32 v51, v51
    v_cvt_pk_bf16_f32 v104, v44, v45
    v_cvt_pk_bf16_f32 v105, v46, v47
    v_cvt_pk_bf16_f32 v106, v48, v49
    v_cvt_pk_bf16_f32 v107, v50, v51
    s_waitcnt lgkmcnt(4)
    s_nop 0
    v_mfma_f32_32x32x16_bf16 v[52:67], v[96:99], v[104:107], v[52:67]
    s_add_u32 s25, s25, 1
    s_cmp_lt_u32 s25, 8
    s_cbranch_scc1 k2_kernel_loop_11
    s_branch k2_kernel_done_5
k2_kernel_slow_12:
    v_mov_b32 v109, v108
    s_nop 1
    v_permlane32_swap_b32 v108, v109
    v_max_f32 v108, v108, v109
    v_max_f32 v108, 0, v108
    v_sub_f32 v5, v11, v108
    v_cvt_pk_bf16_f32 v6, v5, v5
    v_lshlrev_b32 v7, 16, v6
    v_sub_f32 v5, v5, v7
    v_cvt_pk_bf16_f32 v6, v7, v5
    v_and_b32 v5, 0xffff0000, v6
    v_add_f32 v5, v5, v7
    v_cmp_eq_u32 vcc, 0, v3
    s_nop 1
    v_cndmask_b32 v17, v17, v6, vcc
    v_sub_f32 v108, v11, v5
    v_mov_b32 v11, v5
    v_sub_f32 v4, 0, v108
    v_exp_f32 v4, v4
    v_sub_f32 v20, v20, v108
    v_sub_f32 v21, v21, v108
    v_sub_f32 v22, v22, v108
    v_sub_f32 v23, v23, v108
    v_sub_f32 v24, v24, v108
    v_sub_f32 v25, v25, v108
    v_sub_f32 v26, v26, v108
    v_sub_f32 v27, v27, v108
    v_sub_f32 v28, v28, v108
    v_sub_f32 v29, v29, v108
    v_sub_f32 v30, v30, v108
    v_sub_f32 v31, v31, v108
    v_sub_f32 v32, v32, v108
    v_sub_f32 v33, v33, v108
    v_sub_f32 v34, v34, v108
    v_sub_f32 v35, v35, v108
    v_mul_f32 v52, v52, v4
    v_mul_f32 v53, v53, v4
    v_mul_f32 v54, v54, v4
    v_mul_f32 v55, v55, v4
    v_mul_f32 v56, v56, v4
    v_mul_f32 v57, v57, v4
    v_mul_f32 v58, v58, v4
    v_mul_f32 v59, v59, v4
    v_mul_f32 v60, v60, v4
    v_mul_f32 v61, v61, v4
    v_mul_f32 v62, v62, v4
    v_mul_f32 v63, v63, v4
    v_mul_f32 v64, v64, v4
    v_mul_f32 v65, v65, v4
    v_mul_f32 v66, v66, v4
    v_mul_f32 v67, v67, v4
    s_branch k2_kernel_back_13
k2_kernel_slow_14:
    v_mov_b32 v109, v108
    s_nop 1
    v_permlane32_swap_b32 v108, v109
    v_max_f32 v108, v108, v109
    v_max_f32 v108, 0, v108
    v_sub_f32 v5, v11, v108
    v_cvt_pk_bf16_f32 v6, v5, v5
    v_lshlrev_b32 v7, 16, v6
    v_sub_f32 v5, v5, v7
    v_cvt_pk_bf16_f32 v6, v7, v5
    v_and_b32 v5, 0xffff0000, v6
    v_add_f32 v5, v5, v7
    v_cmp_eq_u32 vcc, 0, v3
    s_nop 1
    v_cndmask_b32 v17, v17, v6, vcc
    v_sub_f32 v108, v11, v5
    v_mov_b32 v11, v5
    v_sub_f32 v4, 0, v108
    v_exp_f32 v4, v4
    v_sub_f32 v36, v36, v108
    v_sub_f32 v37, v37, v108
    v_sub_f32 v38, v38, v108
    v_sub_f32 v39, v39, v108
    v_sub_f32 v40, v40, v108
    v_sub_f32 v41, v41, v108
    v_sub_f32 v42, v42, v108
    v_sub_f32 v43, v43, v108
    v_sub_f32 v44, v44, v108
    v_sub_f32 v45, v45, v108
    v_sub_f32 v46, v46, v108
    v_sub_f32 v47, v47, v108
    v_sub_f32 v48, v48, v108
    v_sub_f32 v49, v49, v108
    v_sub_f32 v50, v50, v108
    v_sub_f32 v51, v51, v108
    v_mul_f32 v52, v52, v4
    v_mul_f32 v53, v53, v4
    v_mul_f32 v54, v54, v4
    v_mul_f32 v55, v55, v4
    v_mul_f32 v56, v56, v4
    v_mul_f32 v57, v57, v4
    v_mul_f32 v58, v58, v4
    v_mul_f32 v59, v59, v4
    v_mul_f32 v60, v60, v4
    v_mul_f32 v61, v61, v4
    v_mul_f32 v62, v62, v4
    v_mul_f32 v63, v63, v4
    v_mul_f32 v64, v64, v4
    v_mul_f32 v65, v65, v4
    v_mul_f32 v66, v66, v4
    v_mul_f32 v67, v67, v4
    s_branch k2_kernel_back_15
k2_kernel_slow_16:
    v_mov_b32 v109, v108
    s_nop 1
    v_permlane32_swap_b32 v108, v109
    v_max_f32 v108, v108, v109
    v_max_f32 v108, 0, v108
    v_sub_f32 v5, v11, v108
    v_cvt_pk_bf16_f32 v6, v5, v5
    v_lshlrev_b32 v7, 16, v6
    v_sub_f32 v5, v5, v7
    v_cvt_pk_bf16_f32 v6, v7, v5
    v_and_b32 v5, 0xffff0000, v6
    v_add_f32 v5, v5, v7
    v_cmp_eq_u32 vcc, 0, v3
    s_nop 1
    v_cndmask_b32 v17, v17, v6, vcc
    v_sub_f32 v108, v11, v5
    v_mov_b32 v11, v5
    v_sub_f32 v4, 0, v108
    v_exp_f32 v4, v4
    v_sub_f32 v20, v20, v108
    v_sub_f32 v21, v21, v108
    v_sub_f32 v22, v22, v108
    v_sub_f32 v23, v23, v108
    v_sub_f32 v24, v24, v108
    v_sub_f32 v25, v25, v108
    v_sub_f32 v26, v26, v108
    v_sub_f32 v27, v27, v108
    v_sub_f32 v28, v28, v108
    v_sub_f32 v29, v29, v108
    v_sub_f32 v30, v30, v108
    v_sub_f32 v31, v31, v108
    v_sub_f32 v32, v32, v108
    v_sub_f32 v33, v33, v108
    v_sub_f32 v34, v34, v108
    v_sub_f32 v35, v35, v108
    v_mul_f32 v52, v52, v4
    v_mul_f32 v53, v53, v4
    v_mul_f32 v54, v54, v4
    v_mul_f32 v55, v55, v4
    v_mul_f32 v56, v56, v4
    v_mul_f32 v57, v57, v4
    v_mul_f32 v58, v58, v4
    v_mul_f32 v59, v59, v4
    v_mul_f32 v60, v60, v4
    v_mul_f32 v61, v61, v4
    v_mul_f32 v62, v62, v4
    v_mul_f32 v63, v63, v4
    v_mul_f32 v64, v64, v4
    v_mul_f32 v65, v65, v4
    v_mul_f32 v66, v66, v4
    v_mul_f32 v67, v67, v4
    s_branch k2_kernel_back_17
k2_kernel_slow_18:
    v_mov_b32 v109, v108
    s_nop 1
    v_permlane32_swap_b32 v108, v109
    v_max_f32 v108, v108, v109
    v_max_f32 v108, 0, v108
    v_sub_f32 v5, v11, v108
    v_cvt_pk_bf16_f32 v6, v5, v5
    v_lshlrev_b32 v7, 16, v6
    v_sub_f32 v5, v5, v7
    v_cvt_pk_bf16_f32 v6, v7, v5
    v_and_b32 v5, 0xffff0000, v6
    v_add_f32 v5, v5, v7
    v_cmp_eq_u32 vcc, 0, v3
    s_nop 1
    v_cndmask_b32 v17, v17, v6, vcc
    v_sub_f32 v108, v11, v5
    v_mov_b32 v11, v5
    v_sub_f32 v4, 0, v108
    v_exp_f32 v4, v4
    v_sub_f32 v36, v36, v108
    v_sub_f32 v37, v37, v108
    v_sub_f32 v38, v38, v108
    v_sub_f32 v39, v39, v108
    v_sub_f32 v40, v40, v108
    v_sub_f32 v41, v41, v108
    v_sub_f32 v42, v42, v108
    v_sub_f32 v43, v43, v108
    v_sub_f32 v44, v44, v108
    v_sub_f32 v45, v45, v108
    v_sub_f32 v46, v46, v108
    v_sub_f32 v47, v47, v108
    v_sub_f32 v48, v48, v108
    v_sub_f32 v49, v49, v108
    v_sub_f32 v50, v50, v108
    v_sub_f32 v51, v51, v108
    v_mul_f32 v52, v52, v4
    v_mul_f32 v53, v53, v4
    v_mul_f32 v54, v54, v4
    v_mul_f32 v55, v55, v4
    v_mul_f32 v56, v56, v4
    v_mul_f32 v57, v57, v4
    v_mul_f32 v58, v58, v4
    v_mul_f32 v59, v59, v4
    v_mul_f32 v60, v60, v4
    v_mul_f32 v61, v61, v4
    v_mul_f32 v62, v62, v4
    v_mul_f32 v63, v63, v4
    v_mul_f32 v64, v64, v4
    v_mul_f32 v65, v65, v4
    v_mul_f32 v66, v66, v4
    v_mul_f32 v67, v67, v4
    s_branch k2_kernel_back_19
k2_kernel_slow_20:
    v_mov_b32 v109, v108
    s_nop 1
    v_permlane32_swap_b32 v108, v109
    v_max_f32 v108, v108, v109
    v_max_f32 v108, 0, v108
    v_sub_f32 v5, v11, v108
    v_cvt_pk_bf16_f32 v6, v5, v5
    v_lshlrev_b32 v7, 16, v6
    v_sub_f32 v5, v5, v7
    v_cvt_pk_bf16_f32 v6, v7, v5
    v_and_b32 v5, 0xffff0000, v6
    v_add_f32 v5, v5, v7
    v_cmp_eq_u32 vcc, 0, v3
    s_nop 1
    v_cndmask_b32 v17, v17, v6, vcc
    v_sub_f32 v108, v11, v5
    v_mov_b32 v11, v5
    v_sub_f32 v4, 0, v108
    v_exp_f32 v4, v4
    v_sub_f32 v20, v20, v108
    v_sub_f32 v21, v21, v108
    v_sub_f32 v22, v22, v108
    v_sub_f32 v23, v23, v108
    v_sub_f32 v24, v24, v108
    v_sub_f32 v25, v25, v108
    v_sub_f32 v26, v26, v108
    v_sub_f32 v27, v27, v108
    v_sub_f32 v28, v28, v108
    v_sub_f32 v29, v29, v108
    v_sub_f32 v30, v30, v108
    v_sub_f32 v31, v31, v108
    v_sub_f32 v32, v32, v108
    v_sub_f32 v33, v33, v108
    v_sub_f32 v34, v34, v108
    v_sub_f32 v35, v35, v108
    v_mul_f32 v52, v52, v4
    v_mul_f32 v53, v53, v4
    v_mul_f32 v54, v54, v4
    v_mul_f32 v55, v55, v4
    v_mul_f32 v56, v56, v4
    v_mul_f32 v57, v57, v4
    v_mul_f32 v58, v58, v4
    v_mul_f32 v59, v59, v4
    v_mul_f32 v60, v60, v4
    v_mul_f32 v61, v61, v4
    v_mul_f32 v62, v62, v4
    v_mul_f32 v63, v63, v4
    v_mul_f32 v64, v64, v4
    v_mul_f32 v65, v65, v4
    v_mul_f32 v66, v66, v4
    v_mul_f32 v67, v67, v4
    s_branch k2_kernel_back_21
k2_kernel_slow_22:
    v_mov_b32 v109, v108
    s_nop 1
    v_permlane32_swap_b32 v108, v109
    v_max_f32 v108, v108, v109
    v_max_f32 v108, 0, v108
    v_sub_f32 v5, v11, v108
    v_cvt_pk_bf16_f32 v6, v5, v5
    v_lshlrev_b32 v7, 16, v6
    v_sub_f32 v5, v5, v7
    v_cvt_pk_bf16_f32 v6, v7, v5
    v_and_b32 v5, 0xffff0000, v6
    v_add_f32 v5, v5, v7
    v_cmp_eq_u32 vcc, 0, v3
    s_nop 1
    v_cndmask_b32 v17, v17, v6, vcc
    v_sub_f32 v108, v11, v5
    v_mov_b32 v11, v5
    v_sub_f32 v4, 0, v108
    v_exp_f32 v4, v4
    v_sub_f32 v36, v36, v108
    v_sub_f32 v37, v37, v108
    v_sub_f32 v38, v38, v108
    v_sub_f32 v39, v39, v108
    v_sub_f32 v40, v40, v108
    v_sub_f32 v41, v41, v108
    v_sub_f32 v42, v42, v108
    v_sub_f32 v43, v43, v108
    v_sub_f32 v44, v44, v108
    v_sub_f32 v45, v45, v108
    v_sub_f32 v46, v46, v108
    v_sub_f32 v47, v47, v108
    v_sub_f32 v48, v48, v108
    v_sub_f32 v49, v49, v108
    v_sub_f32 v50, v50, v108
    v_sub_f32 v51, v51, v108
    v_mul_f32 v52, v52, v4
    v_mul_f32 v53, v53, v4
    v_mul_f32 v54, v54, v4
    v_mul_f32 v55, v55, v4
    v_mul_f32 v56, v56, v4
    v_mul_f32 v57, v57, v4
    v_mul_f32 v58, v58, v4
    v_mul_f32 v59, v59, v4
    v_mul_f32 v60, v60, v4
    v_mul_f32 v61, v61, v4
    v_mul_f32 v62, v62, v4
    v_mul_f32 v63, v63, v4
    v_mul_f32 v64, v64, v4
    v_mul_f32 v65, v65, v4
    v_mul_f32 v66, v66, v4
    v_mul_f32 v67, v67, v4
    s_branch k2_kernel_back_23
k2_kernel_slow_24:
    v_mov_b32 v109, v108
    s_nop 1
    v_permlane32_swap_b32 v108, v109
    v_max_f32 v108, v108, v109
    v_max_f32 v108, 0, v108
    v_sub_f32 v5, v11, v108
    v_cvt_pk_bf16_f32 v6, v5, v5
    v_lshlrev_b32 v7, 16, v6
    v_sub_f32 v5, v5, v7
    v_cvt_pk_bf16_f32 v6, v7, v5
    v_and_b32 v5, 0xffff0000, v6
    v_add_f32 v5, v5, v7
    v_cmp_eq_u32 vcc, 0, v3
    s_nop 1
    v_cndmask_b32 v17, v17, v6, vcc
    v_sub_f32 v108, v11, v5
    v_mov_b32 v11, v5
    v_sub_f32 v4, 0, v108
    v_exp_f32 v4, v4
    v_sub_f32 v20, v20, v108
    v_sub_f32 v21, v21, v108
    v_sub_f32 v22, v22, v108
    v_sub_f32 v23, v23, v108
    v_sub_f32 v24, v24, v108
    v_sub_f32 v25, v25, v108
    v_sub_f32 v26, v26, v108
    v_sub_f32 v27, v27, v108
    v_sub_f32 v28, v28, v108
    v_sub_f32 v29, v29, v108
    v_sub_f32 v30, v30, v108
    v_sub_f32 v31, v31, v108
    v_sub_f32 v32, v32, v108
    v_sub_f32 v33, v33, v108
    v_sub_f32 v34, v34, v108
    v_sub_f32 v35, v35, v108
    v_mul_f32 v52, v52, v4
    v_mul_f32 v53, v53, v4
    v_mul_f32 v54, v54, v4
    v_mul_f32 v55, v55, v4
    v_mul_f32 v56, v56, v4
    v_mul_f32 v57, v57, v4
    v_mul_f32 v58, v58, v4
    v_mul_f32 v59, v59, v4
    v_mul_f32 v60, v60, v4
    v_mul_f32 v61, v61, v4
    v_mul_f32 v62, v62, v4
    v_mul_f32 v63, v63, v4
    v_mul_f32 v64, v64, v4
    v_mul_f32 v65, v65, v4
    v_mul_f32 v66, v66, v4
    v_mul_f32 v67, v67, v4
    s_branch k2_kernel_back_25
k2_kernel_slow_28:
    v_mov_b32 v109, v108
    s_nop 1
    v_permlane32_swap_b32 v108, v109
    v_max_f32 v108, v108, v109
    v_max_f32 v108, 0, v108
    v_sub_f32 v5, v11, v108
    v_cvt_pk_bf16_f32 v6, v5, v5
    v_lshlrev_b32 v7, 16, v6
    v_sub_f32 v5, v5, v7
    v_cvt_pk_bf16_f32 v6, v7, v5
    v_and_b32 v5, 0xffff0000, v6
    v_add_f32 v5, v5, v7
    v_cmp_eq_u32 vcc, 0, v3
    s_nop 1
    v_cndmask_b32 v17, v17, v6, vcc
    v_sub_f32 v108, v11, v5
    v_mov_b32 v11, v5
    v_sub_f32 v4, 0, v108
    v_exp_f32 v4, v4
    v_sub_f32 v36, v36, v108
    v_sub_f32 v37, v37, v108
    v_sub_f32 v38, v38, v108
    v_sub_f32 v39, v39, v108
    v_sub_f32 v40, v40, v108
    v_sub_f32 v41, v41, v108
    v_sub_f32 v42, v42, v108
    v_sub_f32 v43, v43, v108
    v_sub_f32 v44, v44, v108
    v_sub_f32 v45, v45, v108
    v_sub_f32 v46, v46, v108
    v_sub_f32 v47, v47, v108
    v_sub_f32 v48, v48, v108
    v_sub_f32 v49, v49, v108
    v_sub_f32 v50, v50, v108
    v_sub_f32 v51, v51, v108
    v_mul_f32 v52, v52, v4
    v_mul_f32 v53, v53, v4
    v_mul_f32 v54, v54, v4
    v_mul_f32 v55, v55, v4
    v_mul_f32 v56, v56, v4
    v_mul_f32 v57, v57, v4
    v_mul_f32 v58, v58, v4
    v_mul_f32 v59, v59, v4
    v_mul_f32 v60, v60, v4
    v_mul_f32 v61, v61, v4
    v_mul_f32 v62, v62, v4
    v_mul_f32 v63, v63, v4
    v_mul_f32 v64, v64, v4
    v_mul_f32 v65, v65, v4
    v_mul_f32 v66, v66, v4
    v_mul_f32 v67, v67, v4
    s_branch k2_kernel_back_29
k2_kernel_done_5:
    s_nop 7
    v_mov_b32 v4, v62
    v_mov_b32 v5, v62
    s_nop 1
    v_permlane32_swap_b32 v4, v5
    v_rcp_f32 v4, v4
    s_nop 0
    v_mul_f32 v52, v52, v4
    v_mul_f32 v53, v53, v4
    v_mul_f32 v54, v54, v4
    v_mul_f32 v55, v55, v4
    v_mul_f32 v56, v56, v4
    v_mul_f32 v57, v57, v4
    v_mul_f32 v58, v58, v4
    v_mul_f32 v59, v59, v4
    v_mul_f32 v60, v60, v4
    v_mul_f32 v61, v61, v4
    v_cvt_pk_bf16_f32 v100, v52, v53
    v_cvt_pk_bf16_f32 v101, v54, v55
    v_cvt_pk_bf16_f32 v102, v56, v57
    v_cvt_pk_bf16_f32 v103, v58, v59
    v_cvt_pk_bf16_f32 v104, v60, v61
    s_lshl_b32 s19, s18, 8
    s_lshl_b32 s20, s16, 5
    s_add_u32 s19, s19, s20
    s_mul_i32 s19, s19, 1152
    s_mul_i32 s20, s17, 36
    s_add_u32 s19, s19, s20
    s_add_u32 s19, s19, 17065984
    v_mul_u32_u24 v5, 1152, v2
    v_lshl_add_u32 v5, v3, 3, v5
    buffer_store_dword v100, v5, s[12:15], s19 offen offset:0
    buffer_store_dword v101, v5, s[12:15], s19 offen offset:4
    buffer_store_dword v102, v5, s[12:15], s19 offen offset:16
    buffer_store_dword v103, v5, s[12:15], s19 offen offset:20
    v_cmp_eq_u32 vcc, 0, v3
    s_nop 1
    s_and_saveexec_b64 s[28:29], vcc
    buffer_store_dword v104, v5, s[12:15], s19 offen offset:32
    s_mov_b64 exec, s[28:29]
    s_endpgm
k2_kernel_conv_2:
    v_and_b32 v1, 63, v0
    v_and_b32 v2, 31, v0
    v_bfe_u32 v3, v0, 5, 1
    v_lshrrev_b32 v4, 6, v0
    s_nop 0
    v_readfirstlane_b32 s16, v4
    s_sub_u32 s19, s2, 256
    s_lshl_b32 s17, s19, 2
    s_lshl_b32 s20, s19, 3
    s_load_dwordx2 s[32:33], s[4:5], s20
    v_lshlrev_b32 v18, 4, v1
    s_mul_i32 s35, s17, 8224
    s_and_b32 s20, s16, 1
    s_mul_i32 s20, s20, 4112
    s_add_u32 s35, s35, s20
    s_lshr_b32 s20, s16, 1
    s_lshl_b32 s20, s20, 2
    s_add_u32 s35, s35, s20
    s_add_u32 s35, s35, 12320768
    s_mul_i32 s36, s16, 4416
    v_cmp_le_u32 vcc, 256, v0
    s_nop 1
    s_mov_b64 s[30:31], vcc
    v_subrev_u32 v4, 256, v0
    v_lshrrev_b32 v5, 3, v4
    v_mul_u32_u24 v5, 144, v5
    v_and_b32 v6, 7, v4
    v_lshl_add_u32 v5, v6, 4, v5
    v_add_u32 v17, 39936, v5
    v_lshlrev_b32 v5, 4, v4
    s_lshl_b32 s20, s17, 12
    s_add_u32 s20, s20, 9961472
    v_add_u32 v16, s20, v5
    s_add_u32 m0, s36, 0
    s_add_u32 s20, s35, 0
    buffer_load_dwordx4 v18, s[12:15], s20 offen lds
    s_add_u32 m0, s36, 1024
    s_add_u32 s20, s35, 1024
    buffer_load_dwordx4 v18, s[12:15], s20 offen lds
    s_add_u32 m0, s36, 2048
    s_add_u32 s20, s35, 2048
    buffer_load_dwordx4 v18, s[12:15], s20 offen lds
    s_add_u32 m0, s36, 3072
    s_add_u32 s20, s35, 3072
    buffer_load_dwordx4 v18, s[12:15], s20 offen lds
    s_add_u32 s35, s35, 8224
    s_mov_b64 s[28:29], exec
    s_mov_b64 exec, s[30:31]
    buffer_load_dwordx4 v[12:15], v16, s[12:15], 0 offen
    v_add_u32 v16, 4096, v16
    s_mov_b64 exec, s[28:29]
    v_mov_b32 v88, 0
    v_mov_b32 v89, 0
    v_mov_b32 v90, 0
    v_mov_b32 v91, 0
    v_cmp_gt_u32 vcc, 288, v0
    s_nop 1
    s_and_saveexec_b64 s[28:29], vcc
    v_lshlrev_b32 v4, 4, v0
    ds_write_b128 v4, v[88:91] offset:35328
    s_mov_b64 exec, s[28:29]
    v_cmp_gt_u32 vcc, 144, v0
    s_nop 1
    s_and_saveexec_b64 s[28:29], vcc
    v_mul_u32_u24 v4, 57, v0
    v_lshrrev_b32 v4, 10, v4
    v_mul_u32_u24 v5, 18, v4
    v_sub_u32 v5, v0, v5
    v_mul_u32_u24 v4, 4416, v4
    v_lshl_add_u32 v4, v5, 4, v4
    ds_write_b128 v4, v[88:91] offset:4096
    s_mov_b64 exec, s[28:29]
    s_and_b32 s19, s16, 1
    s_lshr_b32 s20, s16, 1
    v_sub_u32 v4, 2047, v2
    v_and_b32 v5, 7, v4
    v_mul_u32_u24 v5, 4416, v5
    v_lshrrev_b32 v4, 3, v4
    v_add_u32 v4, v4, v3
    s_lshl_b32 s21, s19, 2
    s_lshl_b32 s22, s20, 3
    s_add_u32 s21, s21, s22
    s_add_u32 s21, s21, 224
    v_subrev_u32 v4, s21, v4
    v_lshl_add_u32 v68, v4, 4, v5
    s_sub_u32 s21, 4, s20
    v_add_u32 v4, s21, v2
    v_mul_u32_u24 v4, 144, v4
    v_lshl_add_u32 v4, v3, 4, v4
    v_add_u32 v69, 35328, v4
    s_mul_i32 s21, s20, 8448
    s_mul_i32 s22, s19, 4224
    s_add_u32 s21, s21, s22
    s_add_u32 s21, s21, 44544
    v_mul_u32_u24 v4, 528, v3
    v_lshl_add_u32 v4, v2, 4, v4
    v_add_u32 v92, s21, v4
    v_and_b32 v4, 15, v1
    v_lshrrev_b32 v5, 4, v1
    s_lshl_b32 s21, s16, 2
    v_add_u32 v5, s21, v5
    v_mul_u32_u24 v6, 528, v4
    v_lshl_add_u32 v6, v5, 4, v6
    v_add_u32 v93, 44544, v6
    v_mul_u32_u24 v6, 144, v5
    v_lshl_add_u32 v6, v4, 3, v6
    v_add_u32 v94, 39936, v6
    v_lshlrev_b32 v95, 3, v1
    s_lshl_b32 s22, s17, 12
    s_lshl_b32 s21, s16, 9
    s_add_u32 s22, s22, s21
    s_add_u32 s22, s22, 19425280
    s_waitcnt lgkmcnt(0)
    s_waitcnt vmcnt(0)
    s_mov_b64 s[28:29], exec
    s_mov_b64 exec, s[30:31]
    ds_write_b128 v17, v[12:15]
    s_mov_b64 exec, s[28:29]
    s_waitcnt lgkmcnt(0)
    s_barrier
    ds_read_b64 v[80:81], v94
    v_mov_b32 v20, 0
    v_mov_b32 v21, 0
    v_mov_b32 v22, 0
    v_mov_b32 v23, 0
    v_mov_b32 v24, 0
    v_mov_b32 v25, 0
    v_mov_b32 v26, 0
    v_mov_b32 v27, 0
    v_mov_b32 v28, 0
    v_mov_b32 v29, 0
    v_mov_b32 v30, 0
    v_mov_b32 v31, 0
    v_mov_b32 v32, 0
    v_mov_b32 v33, 0
    v_mov_b32 v34, 0
    v_mov_b32 v35, 0
    ds_read_b128 v[36:39], v68 offset:3584
    ds_read_b128 v[52:55], v69 offset:4032
    ds_read_b128 v[40:43], v68 offset:3616
    ds_read_b128 v[56:59], v69 offset:4064
    ds_read_b128 v[44:47], v68 offset:3648
    ds_read_b128 v[60:63], v69 offset:4096
    ds_read_b128 v[48:51], v68 offset:3680
    ds_read_b128 v[64:67], v69 offset:4128
    s_waitcnt lgkmcnt(6)
    v_mfma_f32_32x32x16_bf16 v[20:35], v[36:39], v[52:55], v[20:35]
    ds_read_b128 v[36:39], v68 offset:3072
    ds_read_b128 v[52:55], v69 offset:3456
    s_waitcnt lgkmcnt(6)
    v_mfma_f32_32x32x16_bf16 v[20:35], v[40:43], v[56:59], v[20:35]
    ds_read_b128 v[40:43], v68 offset:3104
    ds_read_b128 v[56:59], v69 offset:3488
    s_waitcnt lgkmcnt(6)
    v_mfma_f32_32x32x16_bf16 v[20:35], v[44:47], v[60:63], v[20:35]
    ds_read_b128 v[44:47], v68 offset:3136
    ds_read_b128 v[60:63], v69 offset:3520
    s_waitcnt lgkmcnt(6)
    v_mfma_f32_32x32x16_bf16 v[20:35], v[48:51], v[64:67], v[20:35]
    ds_read_b128 v[48:51], v68 offset:3168
    ds_read_b128 v[64:67], v69 offset:3552
    s_waitcnt lgkmcnt(6)
    v_mfma_f32_32x32x16_bf16 v[20:35], v[36:39], v[52:55], v[20:35]
    ds_read_b128 v[36:39], v68 offset:2560
    ds_read_b128 v[52:55], v69 offset:2880
    s_waitcnt lgkmcnt(6)
    v_mfma_f32_32x32x16_bf16 v[20:35], v[40:43], v[56:59], v[20:35]
    ds_read_b128 v[40:43], v68 offset:2592
    ds_read_b128 v[56:59], v69 offset:2912
    s_waitcnt lgkmcnt(6)
    v_mfma_f32_32x32x16_bf16 v[20:35], v[44:47], v[60:63], v[20:35]
    ds_read_b128 v[44:47], v68 offset:2624
    ds_read_b128 v[60:63], v69 offset:2944
    s_waitcnt lgkmcnt(6)
    v_mfma_f32_32x32x16_bf16 v[20:35], v[48:51], v[64:67], v[20:35]
    ds_read_b128 v[48:51], v68 offset:2656
    ds_read_b128 v[64:67], v69 offset:2976
    s_waitcnt lgkmcnt(6)
    v_mfma_f32_32x32x16_bf16 v[20:35], v[36:39], v[52:55], v[20:35]
    ds_read_b128 v[36:39], v68 offset:2048
    ds_read_b128 v[52:55], v69 offset:2304
    s_waitcnt lgkmcnt(6)
    v_mfma_f32_32x32x16_bf16 v[20:35], v[40:43], v[56:59], v[20:35]
    ds_read_b128 v[40:43], v68 offset:2080
    ds_read_b128 v[56:59], v69 offset:2336
    s_waitcnt lgkmcnt(6)
    v_mfma_f32_32x32x16_bf16 v[20:35], v[44:47], v[60:63], v[20:35]
    ds_read_b128 v[44:47], v68 offset:2112
    ds_read_b128 v[60:63], v69 offset:2368
    s_waitcnt lgkmcnt(6)
    v_mfma_f32_32x32x16_bf16 v[20:35], v[48:51], v[64:67], v[20:35]
    ds_read_b128 v[48:51], v68 offset:2144
    ds_read_b128 v[64:67], v69 offset:2400
    s_waitcnt lgkmcnt(6)
    v_mfma_f32_32x32x16_bf16 v[20:35], v[36:39], v[52:55], v[20:35]
    ds_read_b128 v[36:39], v68 offset:1536
    ds_read_b128 v[52:55], v69 offset:1728
    s_waitcnt lgkmcnt(6)
    v_mfma_f32_32x32x16_bf16 v[20:35], v[40:43], v[56:59], v[20:35]
    ds_read_b128 v[40:43], v68 offset:1568
    ds_read_b128 v[56:59], v69 offset:1760
    s_waitcnt lgkmcnt(6)
    v_mfma_f32_32x32x16_bf16 v[20:35], v[44:47], v[60:63], v[20:35]
    ds_read_b128 v[44:47], v68 offset:1600
    ds_read_b128 v[60:63], v69 offset:1792
    s_waitcnt lgkmcnt(6)
    v_mfma_f32_32x32x16_bf16 v[20:35], v[48:51], v[64:67], v[20:35]
    ds_read_b128 v[48:51], v68 offset:1632
    ds_read_b128 v[64:67], v69 offset:1824
    s_waitcnt lgkmcnt(6)
    v_mfma_f32_32x32x16_bf16 v[20:35], v[36:39], v[52:55], v[20:35]
    ds_read_b128 v[36:39], v68 offset:1024
    ds_read_b128 v[52:55], v69 offset:1152
    s_waitcnt lgkmcnt(6)
    v_mfma_f32_32x32x16_bf16 v[20:35], v[40:43], v[56:59], v[20:35]
    ds_read_b128 v[40:43], v68 offset:1056
    ds_read_b128 v[56:59], v69 offset:1184
    s_waitcnt lgkmcnt(6)
    v_mfma_f32_32x32x16_bf16 v[20:35], v[44:47], v[60:63], v[20:35]
    ds_read_b128 v[44:47], v68 offset:1088
    ds_read_b128 v[60:63], v69 offset:1216
    s_waitcnt lgkmcnt(6)
    v_mfma_f32_32x32x16_bf16 v[20:35], v[48:51], v[64:67], v[20:35]
    ds_read_b128 v[48:51], v68 offset:1120
    ds_read_b128 v[64:67], v69 offset:1248
    s_waitcnt lgkmcnt(6)
    v_mfma_f32_32x32x16_bf16 v[20:35], v[36:39], v[52:55], v[20:35]
    ds_read_b128 v[36:39], v68 offset:512
    ds_read_b128 v[52:55], v69 offset:576
    s_waitcnt lgkmcnt(6)
    v_mfma_f32_32x32x16_bf16 v[20:35], v[40:43], v[56:59], v[20:35]
    ds_read_b128 v[40:43], v68 offset:544
    ds_read_b128 v[56:59], v69 offset:608
    s_waitcnt lgkmcnt(6)
    v_mfma_f32_32x32x16_bf16 v[20:35], v[44:47], v[60:63], v[20:35]
    ds_read_b128 v[44:47], v68 offset:576
    ds_read_b128 v[60:63], v69 offset:640
    s_waitcnt lgkmcnt(6)
    v_mfma_f32_32x32x16_bf16 v[20:35], v[48:51], v[64:67], v[20:35]
    ds_read_b128 v[48:51], v68 offset:608
    ds_read_b128 v[64:67], v69 offset:672
    s_waitcnt lgkmcnt(6)
    v_mfma_f32_32x32x16_bf16 v[20:35], v[36:39], v[52:55], v[20:35]
    ds_read_b128 v[36:39], v68 offset:0
    ds_read_b128 v[52:55], v69 offset:0
    s_waitcnt lgkmcnt(6)
    v_mfma_f32_32x32x16_bf16 v[20:35], v[40:43], v[56:59], v[20:35]
    ds_read_b128 v[40:43], v68 offset:32
    ds_read_b128 v[56:59], v69 offset:32
    s_waitcnt lgkmcnt(6)
    v_mfma_f32_32x32x16_bf16 v[20:35], v[44:47], v[60:63], v[20:35]
    ds_read_b128 v[44:47], v68 offset:64
    ds_read_b128 v[60:63], v69 offset:64
    s_waitcnt lgkmcnt(6)
    v_mfma_f32_32x32x16_bf16 v[20:35], v[48:51], v[64:67], v[20:35]
    ds_read_b128 v[48:51], v68 offset:96
    ds_read_b128 v[64:67], v69 offset:96
    s_waitcnt lgkmcnt(6)
    v_mfma_f32_32x32x16_bf16 v[20:35], v[36:39], v[52:55], v[20:35]
    s_waitcnt lgkmcnt(4)
    v_mfma_f32_32x32x16_bf16 v[20:35], v[40:43], v[56:59], v[20:35]
    s_waitcnt lgkmcnt(2)
    v_mfma_f32_32x32x16_bf16 v[20:35], v[44:47], v[60:63], v[20:35]
    s_waitcnt lgkmcnt(0)
    v_mfma_f32_32x32x16_bf16 v[20:35], v[48:51], v[64:67], v[20:35]
    s_nop 11
    ds_write_b128 v92, v[20:23] offset:0
    ds_write_b128 v92, v[24:27] offset:1056
    ds_write_b128 v92, v[28:31] offset:2112
    ds_write_b128 v92, v[32:35] offset:3168
    s_waitcnt lgkmcnt(0)
    s_barrier
    s_add_u32 m0, s36, 0
    s_add_u32 s20, s35, 0
    buffer_load_dwordx4 v18, s[12:15], s20 offen lds
    s_add_u32 m0, s36, 1024
    s_add_u32 s20, s35, 1024
    buffer_load_dwordx4 v18, s[12:15], s20 offen lds
    s_add_u32 m0, s36, 2048
    s_add_u32 s20, s35, 2048
    buffer_load_dwordx4 v18, s[12:15], s20 offen lds
    s_add_u32 m0, s36, 3072
    s_add_u32 s20, s35, 3072
    buffer_load_dwordx4 v18, s[12:15], s20 offen lds
    s_add_u32 s35, s35, 8224
    s_mov_b64 s[28:29], exec
    s_mov_b64 exec, s[30:31]
    buffer_load_dwordx4 v[12:15], v16, s[12:15], 0 offen
    v_add_u32 v16, 4096, v16
    s_mov_b64 exec, s[28:29]
    ds_read_b128 v[36:39], v93 offset:0
    ds_read_b128 v[40:43], v93 offset:8448
    ds_read_b128 v[44:47], v93 offset:16896
    ds_read_b128 v[48:51], v93 offset:25344
    s_waitcnt lgkmcnt(0)
    s_lshl_b32 s34, s32, 16
    v_lshlrev_b32 v76, 16, v80
    v_and_b32 v77, 0xffff0000, v80
    v_lshlrev_b32 v78, 16, v81
    v_and_b32 v79, 0xffff0000, v81
    v_mul_f32 v76, s34, v76
    v_mul_f32 v77, s34, v77
    v_mul_f32 v78, s34, v78
    v_mul_f32 v79, s34, v79
    v_cvt_pk_bf16_f32 v86, v76, v77
    v_cvt_pk_bf16_f32 v87, v78, v79
    v_add_f32 v72, v36, v40
    v_add_f32 v76, v44, v48
    v_add_f32 v72, v72, v76
    v_add_f32 v73, v37, v41
    v_add_f32 v77, v45, v49
    v_add_f32 v73, v73, v77
    v_add_f32 v74, v38, v42
    v_add_f32 v78, v46, v50
    v_add_f32 v74, v74, v78
    v_add_f32 v75, v39, v43
    v_add_f32 v79, v47, v51
    v_add_f32 v75, v75, v79
    v_cvt_pk_bf16_f32 v84, v72, v73
    v_cvt_pk_bf16_f32 v85, v74, v75
    v_lshlrev_b32 v6, 16, v84
    v_lshlrev_b32 v7, 16, v86
    v_add_f32 v6, v6, v7
    v_and_b32 v7, 0xffff0000, v84
    v_and_b32 v8, 0xffff0000, v86
    v_add_f32 v7, v7, v8
    v_cvt_pk_bf16_f32 v88, v6, v7
    v_lshlrev_b32 v6, 16, v85
    v_lshlrev_b32 v7, 16, v87
    v_add_f32 v6, v6, v7
    v_and_b32 v7, 0xffff0000, v85
    v_and_b32 v8, 0xffff0000, v87
    v_add_f32 v7, v7, v8
    v_cvt_pk_bf16_f32 v89, v6, v7
    buffer_store_dwordx2 v[88:89], v95, s[12:15], s22 offen
    s_add_u32 s22, s22, 4096
    s_waitcnt vmcnt(0)
    s_mov_b64 s[28:29], exec
    s_mov_b64 exec, s[30:31]
    ds_write_b128 v17, v[12:15]
    s_mov_b64 exec, s[28:29]
    s_waitcnt lgkmcnt(0)
    s_barrier
    ds_read_b64 v[80:81], v94
    v_mov_b32 v20, 0
    v_mov_b32 v21, 0
    v_mov_b32 v22, 0
    v_mov_b32 v23, 0
    v_mov_b32 v24, 0
    v_mov_b32 v25, 0
    v_mov_b32 v26, 0
    v_mov_b32 v27, 0
    v_mov_b32 v28, 0
    v_mov_b32 v29, 0
    v_mov_b32 v30, 0
    v_mov_b32 v31, 0
    v_mov_b32 v32, 0
    v_mov_b32 v33, 0
    v_mov_b32 v34, 0
    v_mov_b32 v35, 0
    ds_read_b128 v[36:39], v68 offset:3584
    ds_read_b128 v[52:55], v69 offset:4032
    ds_read_b128 v[40:43], v68 offset:3616
    ds_read_b128 v[56:59], v69 offset:4064
    ds_read_b128 v[44:47], v68 offset:3648
    ds_read_b128 v[60:63], v69 offset:4096
    ds_read_b128 v[48:51], v68 offset:3680
    ds_read_b128 v[64:67], v69 offset:4128
    s_waitcnt lgkmcnt(6)
    v_mfma_f32_32x32x16_bf16 v[20:35], v[36:39], v[52:55], v[20:35]
    ds_read_b128 v[36:39], v68 offset:3072
    ds_read_b128 v[52:55], v69 offset:3456
    s_waitcnt lgkmcnt(6)
    v_mfma_f32_32x32x16_bf16 v[20:35], v[40:43], v[56:59], v[20:35]
    ds_read_b128 v[40:43], v68 offset:3104
    ds_read_b128 v[56:59], v69 offset:3488
    s_waitcnt lgkmcnt(6)
    v_mfma_f32_32x32x16_bf16 v[20:35], v[44:47], v[60:63], v[20:35]
    ds_read_b128 v[44:47], v68 offset:3136
    ds_read_b128 v[60:63], v69 offset:3520
    s_waitcnt lgkmcnt(6)
    v_mfma_f32_32x32x16_bf16 v[20:35], v[48:51], v[64:67], v[20:35]
    ds_read_b128 v[48:51], v68 offset:3168
    ds_read_b128 v[64:67], v69 offset:3552
    s_waitcnt lgkmcnt(6)
    v_mfma_f32_32x32x16_bf16 v[20:35], v[36:39], v[52:55], v[20:35]
    ds_read_b128 v[36:39], v68 offset:2560
    ds_read_b128 v[52:55], v69 offset:2880
    s_waitcnt lgkmcnt(6)
    v_mfma_f32_32x32x16_bf16 v[20:35], v[40:43], v[56:59], v[20:35]
    ds_read_b128 v[40:43], v68 offset:2592
    ds_read_b128 v[56:59], v69 offset:2912
    s_waitcnt lgkmcnt(6)
    v_mfma_f32_32x32x16_bf16 v[20:35], v[44:47], v[60:63], v[20:35]
    ds_read_b128 v[44:47], v68 offset:2624
    ds_read_b128 v[60:63], v69 offset:2944
    s_waitcnt lgkmcnt(6)
    v_mfma_f32_32x32x16_bf16 v[20:35], v[48:51], v[64:67], v[20:35]
    ds_read_b128 v[48:51], v68 offset:2656
    ds_read_b128 v[64:67], v69 offset:2976
    s_waitcnt lgkmcnt(6)
    v_mfma_f32_32x32x16_bf16 v[20:35], v[36:39], v[52:55], v[20:35]
    ds_read_b128 v[36:39], v68 offset:2048
    ds_read_b128 v[52:55], v69 offset:2304
    s_waitcnt lgkmcnt(6)
    v_mfma_f32_32x32x16_bf16 v[20:35], v[40:43], v[56:59], v[20:35]
    ds_read_b128 v[40:43], v68 offset:2080
    ds_read_b128 v[56:59], v69 offset:2336
    s_waitcnt lgkmcnt(6)
    v_mfma_f32_32x32x16_bf16 v[20:35], v[44:47], v[60:63], v[20:35]
    ds_read_b128 v[44:47], v68 offset:2112
    ds_read_b128 v[60:63], v69 offset:2368
    s_waitcnt lgkmcnt(6)
    v_mfma_f32_32x32x16_bf16 v[20:35], v[48:51], v[64:67], v[20:35]
    ds_read_b128 v[48:51], v68 offset:2144
    ds_read_b128 v[64:67], v69 offset:2400
    s_waitcnt lgkmcnt(6)
    v_mfma_f32_32x32x16_bf16 v[20:35], v[36:39], v[52:55], v[20:35]
    ds_read_b128 v[36:39], v68 offset:1536
    ds_read_b128 v[52:55], v69 offset:1728
    s_waitcnt lgkmcnt(6)
    v_mfma_f32_32x32x16_bf16 v[20:35], v[40:43], v[56:59], v[20:35]
    ds_read_b128 v[40:43], v68 offset:1568
    ds_read_b128 v[56:59], v69 offset:1760
    s_waitcnt lgkmcnt(6)
    v_mfma_f32_32x32x16_bf16 v[20:35], v[44:47], v[60:63], v[20:35]
    ds_read_b128 v[44:47], v68 offset:1600
    ds_read_b128 v[60:63], v69 offset:1792
    s_waitcnt lgkmcnt(6)
    v_mfma_f32_32x32x16_bf16 v[20:35], v[48:51], v[64:67], v[20:35]
    ds_read_b128 v[48:51], v68 offset:1632
    ds_read_b128 v[64:67], v69 offset:1824
    s_waitcnt lgkmcnt(6)
    v_mfma_f32_32x32x16_bf16 v[20:35], v[36:39], v[52:55], v[20:35]
    ds_read_b128 v[36:39], v68 offset:1024
    ds_read_b128 v[52:55], v69 offset:1152
    s_waitcnt lgkmcnt(6)
    v_mfma_f32_32x32x16_bf16 v[20:35], v[40:43], v[56:59], v[20:35]
    ds_read_b128 v[40:43], v68 offset:1056
    ds_read_b128 v[56:59], v69 offset:1184
    s_waitcnt lgkmcnt(6)
    v_mfma_f32_32x32x16_bf16 v[20:35], v[44:47], v[60:63], v[20:35]
    ds_read_b128 v[44:47], v68 offset:1088
    ds_read_b128 v[60:63], v69 offset:1216
    s_waitcnt lgkmcnt(6)
    v_mfma_f32_32x32x16_bf16 v[20:35], v[48:51], v[64:67], v[20:35]
    ds_read_b128 v[48:51], v68 offset:1120
    ds_read_b128 v[64:67], v69 offset:1248
    s_waitcnt lgkmcnt(6)
    v_mfma_f32_32x32x16_bf16 v[20:35], v[36:39], v[52:55], v[20:35]
    ds_read_b128 v[36:39], v68 offset:512
    ds_read_b128 v[52:55], v69 offset:576
    s_waitcnt lgkmcnt(6)
    v_mfma_f32_32x32x16_bf16 v[20:35], v[40:43], v[56:59], v[20:35]
    ds_read_b128 v[40:43], v68 offset:544
    ds_read_b128 v[56:59], v69 offset:608
    s_waitcnt lgkmcnt(6)
    v_mfma_f32_32x32x16_bf16 v[20:35], v[44:47], v[60:63], v[20:35]
    ds_read_b128 v[44:47], v68 offset:576
    ds_read_b128 v[60:63], v69 offset:640
    s_waitcnt lgkmcnt(6)
    v_mfma_f32_32x32x16_bf16 v[20:35], v[48:51], v[64:67], v[20:35]
    ds_read_b128 v[48:51], v68 offset:608
    ds_read_b128 v[64:67], v69 offset:672
    s_waitcnt lgkmcnt(6)
    v_mfma_f32_32x32x16_bf16 v[20:35], v[36:39], v[52:55], v[20:35]
    ds_read_b128 v[36:39], v68 offset:0
    ds_read_b128 v[52:55], v69 offset:0
    s_waitcnt lgkmcnt(6)
    v_mfma_f32_32x32x16_bf16 v[20:35], v[40:43], v[56:59], v[20:35]
    ds_read_b128 v[40:43], v68 offset:32
    ds_read_b128 v[56:59], v69 offset:32
    s_waitcnt lgkmcnt(6)
    v_mfma_f32_32x32x16_bf16 v[20:35], v[44:47], v[60:63], v[20:35]
    ds_read_b128 v[44:47], v68 offset:64
    ds_read_b128 v[60:63], v69 offset:64
    s_waitcnt lgkmcnt(6)
    v_mfma_f32_32x32x16_bf16 v[20:35], v[48:51], v[64:67], v[20:35]
    ds_read_b128 v[48:51], v68 offset:96
    ds_read_b128 v[64:67], v69 offset:96
    s_waitcnt lgkmcnt(6)
    v_mfma_f32_32x32x16_bf16 v[20:35], v[36:39], v[52:55], v[20:35]
    s_waitcnt lgkmcnt(4)
    v_mfma_f32_32x32x16_bf16 v[20:35], v[40:43], v[56:59], v[20:35]
    s_waitcnt lgkmcnt(2)
    v_mfma_f32_32x32x16_bf16 v[20:35], v[44:47], v[60:63], v[20:35]
    s_waitcnt lgkmcnt(0)
    v_mfma_f32_32x32x16_bf16 v[20:35], v[48:51], v[64:67], v[20:35]
    s_nop 11
    ds_write_b128 v92, v[20:23] offset:0
    ds_write_b128 v92, v[24:27] offset:1056
    ds_write_b128 v92, v[28:31] offset:2112
    ds_write_b128 v92, v[32:35] offset:3168
    s_waitcnt lgkmcnt(0)
    s_barrier
    s_add_u32 m0, s36, 0
    s_add_u32 s20, s35, 0
    buffer_load_dwordx4 v18, s[12:15], s20 offen lds
    s_add_u32 m0, s36, 1024
    s_add_u32 s20, s35, 1024
    buffer_load_dwordx4 v18, s[12:15], s20 offen lds
    s_add_u32 m0, s36, 2048
    s_add_u32 s20, s35, 2048
    buffer_load_dwordx4 v18, s[12:15], s20 offen lds
    s_add_u32 m0, s36, 3072
    s_add_u32 s20, s35, 3072
    buffer_load_dwordx4 v18, s[12:15], s20 offen lds
    s_add_u32 s35, s35, 8224
    s_mov_b64 s[28:29], exec
    s_mov_b64 exec, s[30:31]
    buffer_load_dwordx4 v[12:15], v16, s[12:15], 0 offen
    v_add_u32 v16, 4096, v16
    s_mov_b64 exec, s[28:29]
    ds_read_b128 v[36:39], v93 offset:0
    ds_read_b128 v[40:43], v93 offset:8448
    ds_read_b128 v[44:47], v93 offset:16896
    ds_read_b128 v[48:51], v93 offset:25344
    s_and_b32 s34, s32, 0xffff0000
    v_lshlrev_b32 v76, 16, v80
    v_and_b32 v77, 0xffff0000, v80
    v_lshlrev_b32 v78, 16, v81
    v_and_b32 v79, 0xffff0000, v81
    v_mul_f32 v76, s34, v76
    v_mul_f32 v77, s34, v77
    v_mul_f32 v78, s34, v78
    v_mul_f32 v79, s34, v79
    v_cvt_pk_bf16_f32 v86, v76, v77
    v_cvt_pk_bf16_f32 v87, v78, v79
    s_waitcnt lgkmcnt(2)
    v_add_f32 v72, v36, v40
    s_waitcnt lgkmcnt(0)
    v_add_f32 v76, v44, v48
    v_add_f32 v72, v72, v76
    v_add_f32 v73, v37, v41
    v_add_f32 v77, v45, v49
    v_add_f32 v73, v73, v77
    v_add_f32 v74, v38, v42
    v_add_f32 v78, v46, v50
    v_add_f32 v74, v74, v78
    v_add_f32 v75, v39, v43
    v_add_f32 v79, v47, v51
    v_add_f32 v75, v75, v79
    v_cvt_pk_bf16_f32 v84, v72, v73
    v_cvt_pk_bf16_f32 v85, v74, v75
    v_lshlrev_b32 v6, 16, v84
    v_lshlrev_b32 v7, 16, v86
    v_add_f32 v6, v6, v7
    v_and_b32 v7, 0xffff0000, v84
    v_and_b32 v8, 0xffff0000, v86
    v_add_f32 v7, v7, v8
    v_cvt_pk_bf16_f32 v88, v6, v7
    v_lshlrev_b32 v6, 16, v85
    v_lshlrev_b32 v7, 16, v87
    v_add_f32 v6, v6, v7
    v_and_b32 v7, 0xffff0000, v85
    v_and_b32 v8, 0xffff0000, v87
    v_add_f32 v7, v7, v8
    v_cvt_pk_bf16_f32 v89, v6, v7
    buffer_store_dwordx2 v[88:89], v95, s[12:15], s22 offen
    s_add_u32 s22, s22, 4096
    s_waitcnt vmcnt(0)
    s_mov_b64 s[28:29], exec
    s_mov_b64 exec, s[30:31]
    ds_write_b128 v17, v[12:15]
    s_mov_b64 exec, s[28:29]
    s_waitcnt lgkmcnt(0)
    s_barrier
    ds_read_b64 v[80:81], v94
    v_mov_b32 v20, 0
    v_mov_b32 v21, 0
    v_mov_b32 v22, 0
    v_mov_b32 v23, 0
    v_mov_b32 v24, 0
    v_mov_b32 v25, 0
    v_mov_b32 v26, 0
    v_mov_b32 v27, 0
    v_mov_b32 v28, 0
    v_mov_b32 v29, 0
    v_mov_b32 v30, 0
    v_mov_b32 v31, 0
    v_mov_b32 v32, 0
    v_mov_b32 v33, 0
    v_mov_b32 v34, 0
    v_mov_b32 v35, 0
    ds_read_b128 v[36:39], v68 offset:3584
    ds_read_b128 v[52:55], v69 offset:4032
    ds_read_b128 v[40:43], v68 offset:3616
    ds_read_b128 v[56:59], v69 offset:4064
    ds_read_b128 v[44:47], v68 offset:3648
    ds_read_b128 v[60:63], v69 offset:4096
    ds_read_b128 v[48:51], v68 offset:3680
    ds_read_b128 v[64:67], v69 offset:4128
    s_waitcnt lgkmcnt(6)
    v_mfma_f32_32x32x16_bf16 v[20:35], v[36:39], v[52:55], v[20:35]
    ds_read_b128 v[36:39], v68 offset:3072
    ds_read_b128 v[52:55], v69 offset:3456
    s_waitcnt lgkmcnt(6)
    v_mfma_f32_32x32x16_bf16 v[20:35], v[40:43], v[56:59], v[20:35]
    ds_read_b128 v[40:43], v68 offset:3104
    ds_read_b128 v[56:59], v69 offset:3488
    s_waitcnt lgkmcnt(6)
    v_mfma_f32_32x32x16_bf16 v[20:35], v[44:47], v[60:63], v[20:35]
    ds_read_b128 v[44:47], v68 offset:3136
    ds_read_b128 v[60:63], v69 offset:3520
    s_waitcnt lgkmcnt(6)
    v_mfma_f32_32x32x16_bf16 v[20:35], v[48:51], v[64:67], v[20:35]
    ds_read_b128 v[48:51], v68 offset:3168
    ds_read_b128 v[64:67], v69 offset:3552
    s_waitcnt lgkmcnt(6)
    v_mfma_f32_32x32x16_bf16 v[20:35], v[36:39], v[52:55], v[20:35]
    ds_read_b128 v[36:39], v68 offset:2560
    ds_read_b128 v[52:55], v69 offset:2880
    s_waitcnt lgkmcnt(6)
    v_mfma_f32_32x32x16_bf16 v[20:35], v[40:43], v[56:59], v[20:35]
    ds_read_b128 v[40:43], v68 offset:2592
    ds_read_b128 v[56:59], v69 offset:2912
    s_waitcnt lgkmcnt(6)
    v_mfma_f32_32x32x16_bf16 v[20:35], v[44:47], v[60:63], v[20:35]
    ds_read_b128 v[44:47], v68 offset:2624
    ds_read_b128 v[60:63], v69 offset:2944
    s_waitcnt lgkmcnt(6)
    v_mfma_f32_32x32x16_bf16 v[20:35], v[48:51], v[64:67], v[20:35]
    ds_read_b128 v[48:51], v68 offset:2656
    ds_read_b128 v[64:67], v69 offset:2976
    s_waitcnt lgkmcnt(6)
    v_mfma_f32_32x32x16_bf16 v[20:35], v[36:39], v[52:55], v[20:35]
    ds_read_b128 v[36:39], v68 offset:2048
    ds_read_b128 v[52:55], v69 offset:2304
    s_waitcnt lgkmcnt(6)
    v_mfma_f32_32x32x16_bf16 v[20:35], v[40:43], v[56:59], v[20:35]
    ds_read_b128 v[40:43], v68 offset:2080
    ds_read_b128 v[56:59], v69 offset:2336
    s_waitcnt lgkmcnt(6)
    v_mfma_f32_32x32x16_bf16 v[20:35], v[44:47], v[60:63], v[20:35]
    ds_read_b128 v[44:47], v68 offset:2112
    ds_read_b128 v[60:63], v69 offset:2368
    s_waitcnt lgkmcnt(6)
    v_mfma_f32_32x32x16_bf16 v[20:35], v[48:51], v[64:67], v[20:35]
    ds_read_b128 v[48:51], v68 offset:2144
    ds_read_b128 v[64:67], v69 offset:2400
    s_waitcnt lgkmcnt(6)
    v_mfma_f32_32x32x16_bf16 v[20:35], v[36:39], v[52:55], v[20:35]
    ds_read_b128 v[36:39], v68 offset:1536
    ds_read_b128 v[52:55], v69 offset:1728
    s_waitcnt lgkmcnt(6)
    v_mfma_f32_32x32x16_bf16 v[20:35], v[40:43], v[56:59], v[20:35]
    ds_read_b128 v[40:43], v68 offset:1568
    ds_read_b128 v[56:59], v69 offset:1760
    s_waitcnt lgkmcnt(6)
    v_mfma_f32_32x32x16_bf16 v[20:35], v[44:47], v[60:63], v[20:35]
    ds_read_b128 v[44:47], v68 offset:1600
    ds_read_b128 v[60:63], v69 offset:1792
    s_waitcnt lgkmcnt(6)
    v_mfma_f32_32x32x16_bf16 v[20:35], v[48:51], v[64:67], v[20:35]
    ds_read_b128 v[48:51], v68 offset:1632
    ds_read_b128 v[64:67], v69 offset:1824
    s_waitcnt lgkmcnt(6)
    v_mfma_f32_32x32x16_bf16 v[20:35], v[36:39], v[52:55], v[20:35]
    ds_read_b128 v[36:39], v68 offset:1024
    ds_read_b128 v[52:55], v69 offset:1152
    s_waitcnt lgkmcnt(6)
    v_mfma_f32_32x32x16_bf16 v[20:35], v[40:43], v[56:59], v[20:35]
    ds_read_b128 v[40:43], v68 offset:1056
    ds_read_b128 v[56:59], v69 offset:1184
    s_waitcnt lgkmcnt(6)
    v_mfma_f32_32x32x16_bf16 v[20:35], v[44:47], v[60:63], v[20:35]
    ds_read_b128 v[44:47], v68 offset:1088
    ds_read_b128 v[60:63], v69 offset:1216
    s_waitcnt lgkmcnt(6)
    v_mfma_f32_32x32x16_bf16 v[20:35], v[48:51], v[64:67], v[20:35]
    ds_read_b128 v[48:51], v68 offset:1120
    ds_read_b128 v[64:67], v69 offset:1248
    s_waitcnt lgkmcnt(6)
    v_mfma_f32_32x32x16_bf16 v[20:35], v[36:39], v[52:55], v[20:35]
    ds_read_b128 v[36:39], v68 offset:512
    ds_read_b128 v[52:55], v69 offset:576
    s_waitcnt lgkmcnt(6)
    v_mfma_f32_32x32x16_bf16 v[20:35], v[40:43], v[56:59], v[20:35]
    ds_read_b128 v[40:43], v68 offset:544
    ds_read_b128 v[56:59], v69 offset:608
    s_waitcnt lgkmcnt(6)
    v_mfma_f32_32x32x16_bf16 v[20:35], v[44:47], v[60:63], v[20:35]
    ds_read_b128 v[44:47], v68 offset:576
    ds_read_b128 v[60:63], v69 offset:640
    s_waitcnt lgkmcnt(6)
    v_mfma_f32_32x32x16_bf16 v[20:35], v[48:51], v[64:67], v[20:35]
    ds_read_b128 v[48:51], v68 offset:608
    ds_read_b128 v[64:67], v69 offset:672
    s_waitcnt lgkmcnt(6)
    v_mfma_f32_32x32x16_bf16 v[20:35], v[36:39], v[52:55], v[20:35]
    ds_read_b128 v[36:39], v68 offset:0
    ds_read_b128 v[52:55], v69 offset:0
    s_waitcnt lgkmcnt(6)
    v_mfma_f32_32x32x16_bf16 v[20:35], v[40:43], v[56:59], v[20:35]
    ds_read_b128 v[40:43], v68 offset:32
    ds_read_b128 v[56:59], v69 offset:32
    s_waitcnt lgkmcnt(6)
    v_mfma_f32_32x32x16_bf16 v[20:35], v[44:47], v[60:63], v[20:35]
    ds_read_b128 v[44:47], v68 offset:64
    ds_read_b128 v[60:63], v69 offset:64
    s_waitcnt lgkmcnt(6)
    v_mfma_f32_32x32x16_bf16 v[20:35], v[48:51], v[64:67], v[20:35]
    ds_read_b128 v[48:51], v68 offset:96
    ds_read_b128 v[64:67], v69 offset:96
    s_waitcnt lgkmcnt(6)
    v_mfma_f32_32x32x16_bf16 v[20:35], v[36:39], v[52:55], v[20:35]
    s_waitcnt lgkmcnt(4)
    v_mfma_f32_32x32x16_bf16 v[20:35], v[40:43], v[56:59], v[20:35]
    s_waitcnt lgkmcnt(2)
    v_mfma_f32_32x32x16_bf16 v[20:35], v[44:47], v[60:63], v[20:35]
    s_waitcnt lgkmcnt(0)
    v_mfma_f32_32x32x16_bf16 v[20:35], v[48:51], v[64:67], v[20:35]
    s_nop 11
    ds_write_b128 v92, v[20:23] offset:0
    ds_write_b128 v92, v[24:27] offset:1056
    ds_write_b128 v92, v[28:31] offset:2112
    ds_write_b128 v92, v[32:35] offset:3168
    s_waitcnt lgkmcnt(0)
    s_barrier
    s_add_u32 m0, s36, 0
    s_add_u32 s20, s35, 0
    buffer_load_dwordx4 v18, s[12:15], s20 offen lds
    s_add_u32 m0, s36, 1024
    s_add_u32 s20, s35, 1024
    buffer_load_dwordx4 v18, s[12:15], s20 offen lds
    s_add_u32 m0, s36, 2048
    s_add_u32 s20, s35, 2048
    buffer_load_dwordx4 v18, s[12:15], s20 offen lds
    s_add_u32 m0, s36, 3072
    s_add_u32 s20, s35, 3072
    buffer_load_dwordx4 v18, s[12:15], s20 offen lds
    s_add_u32 s35, s35, 8224
    s_mov_b64 s[28:29], exec
    s_mov_b64 exec, s[30:31]
    buffer_load_dwordx4 v[12:15], v16, s[12:15], 0 offen
    v_add_u32 v16, 4096, v16
    s_mov_b64 exec, s[28:29]
    ds_read_b128 v[36:39], v93 offset:0
    ds_read_b128 v[40:43], v93 offset:8448
    ds_read_b128 v[44:47], v93 offset:16896
    ds_read_b128 v[48:51], v93 offset:25344
    s_lshl_b32 s34, s33, 16
    v_lshlrev_b32 v76, 16, v80
    v_and_b32 v77, 0xffff0000, v80
    v_lshlrev_b32 v78, 16, v81
    v_and_b32 v79, 0xffff0000, v81
    v_mul_f32 v76, s34, v76
    v_mul_f32 v77, s34, v77
    v_mul_f32 v78, s34, v78
    v_mul_f32 v79, s34, v79
    v_cvt_pk_bf16_f32 v86, v76, v77
    v_cvt_pk_bf16_f32 v87, v78, v79
    s_waitcnt lgkmcnt(2)
    v_add_f32 v72, v36, v40
    s_waitcnt lgkmcnt(0)
    v_add_f32 v76, v44, v48
    v_add_f32 v72, v72, v76
    v_add_f32 v73, v37, v41
    v_add_f32 v77, v45, v49
    v_add_f32 v73, v73, v77
    v_add_f32 v74, v38, v42
    v_add_f32 v78, v46, v50
    v_add_f32 v74, v74, v78
    v_add_f32 v75, v39, v43
    v_add_f32 v79, v47, v51
    v_add_f32 v75, v75, v79
    v_cvt_pk_bf16_f32 v84, v72, v73
    v_cvt_pk_bf16_f32 v85, v74, v75
    v_lshlrev_b32 v6, 16, v84
    v_lshlrev_b32 v7, 16, v86
    v_add_f32 v6, v6, v7
    v_and_b32 v7, 0xffff0000, v84
    v_and_b32 v8, 0xffff0000, v86
    v_add_f32 v7, v7, v8
    v_cvt_pk_bf16_f32 v88, v6, v7
    v_lshlrev_b32 v6, 16, v85
    v_lshlrev_b32 v7, 16, v87
    v_add_f32 v6, v6, v7
    v_and_b32 v7, 0xffff0000, v85
    v_and_b32 v8, 0xffff0000, v87
    v_add_f32 v7, v7, v8
    v_cvt_pk_bf16_f32 v89, v6, v7
    buffer_store_dwordx2 v[88:89], v95, s[12:15], s22 offen
    s_add_u32 s22, s22, 4096
    s_waitcnt vmcnt(0)
    s_mov_b64 s[28:29], exec
    s_mov_b64 exec, s[30:31]
    ds_write_b128 v17, v[12:15]
    s_mov_b64 exec, s[28:29]
    s_waitcnt lgkmcnt(0)
    s_barrier
    ds_read_b64 v[80:81], v94
    v_mov_b32 v20, 0
    v_mov_b32 v21, 0
    v_mov_b32 v22, 0
    v_mov_b32 v23, 0
    v_mov_b32 v24, 0
    v_mov_b32 v25, 0
    v_mov_b32 v26, 0
    v_mov_b32 v27, 0
    v_mov_b32 v28, 0
    v_mov_b32 v29, 0
    v_mov_b32 v30, 0
    v_mov_b32 v31, 0
    v_mov_b32 v32, 0
    v_mov_b32 v33, 0
    v_mov_b32 v34, 0
    v_mov_b32 v35, 0
    ds_read_b128 v[36:39], v68 offset:3584
    ds_read_b128 v[52:55], v69 offset:4032
    ds_read_b128 v[40:43], v68 offset:3616
    ds_read_b128 v[56:59], v69 offset:4064
    ds_read_b128 v[44:47], v68 offset:3648
    ds_read_b128 v[60:63], v69 offset:4096
    ds_read_b128 v[48:51], v68 offset:3680
    ds_read_b128 v[64:67], v69 offset:4128
    s_waitcnt lgkmcnt(6)
    v_mfma_f32_32x32x16_bf16 v[20:35], v[36:39], v[52:55], v[20:35]
    ds_read_b128 v[36:39], v68 offset:3072
    ds_read_b128 v[52:55], v69 offset:3456
    s_waitcnt lgkmcnt(6)
    v_mfma_f32_32x32x16_bf16 v[20:35], v[40:43], v[56:59], v[20:35]
    ds_read_b128 v[40:43], v68 offset:3104
    ds_read_b128 v[56:59], v69 offset:3488
    s_waitcnt lgkmcnt(6)
    v_mfma_f32_32x32x16_bf16 v[20:35], v[44:47], v[60:63], v[20:35]
    ds_read_b128 v[44:47], v68 offset:3136
    ds_read_b128 v[60:63], v69 offset:3520
    s_waitcnt lgkmcnt(6)
    v_mfma_f32_32x32x16_bf16 v[20:35], v[48:51], v[64:67], v[20:35]
    ds_read_b128 v[48:51], v68 offset:3168
    ds_read_b128 v[64:67], v69 offset:3552
    s_waitcnt lgkmcnt(6)
    v_mfma_f32_32x32x16_bf16 v[20:35], v[36:39], v[52:55], v[20:35]
    ds_read_b128 v[36:39], v68 offset:2560
    ds_read_b128 v[52:55], v69 offset:2880
    s_waitcnt lgkmcnt(6)
    v_mfma_f32_32x32x16_bf16 v[20:35], v[40:43], v[56:59], v[20:35]
    ds_read_b128 v[40:43], v68 offset:2592
    ds_read_b128 v[56:59], v69 offset:2912
    s_waitcnt lgkmcnt(6)
    v_mfma_f32_32x32x16_bf16 v[20:35], v[44:47], v[60:63], v[20:35]
    ds_read_b128 v[44:47], v68 offset:2624
    ds_read_b128 v[60:63], v69 offset:2944
    s_waitcnt lgkmcnt(6)
    v_mfma_f32_32x32x16_bf16 v[20:35], v[48:51], v[64:67], v[20:35]
    ds_read_b128 v[48:51], v68 offset:2656
    ds_read_b128 v[64:67], v69 offset:2976
    s_waitcnt lgkmcnt(6)
    v_mfma_f32_32x32x16_bf16 v[20:35], v[36:39], v[52:55], v[20:35]
    ds_read_b128 v[36:39], v68 offset:2048
    ds_read_b128 v[52:55], v69 offset:2304
    s_waitcnt lgkmcnt(6)
    v_mfma_f32_32x32x16_bf16 v[20:35], v[40:43], v[56:59], v[20:35]
    ds_read_b128 v[40:43], v68 offset:2080
    ds_read_b128 v[56:59], v69 offset:2336
    s_waitcnt lgkmcnt(6)
    v_mfma_f32_32x32x16_bf16 v[20:35], v[44:47], v[60:63], v[20:35]
    ds_read_b128 v[44:47], v68 offset:2112
    ds_read_b128 v[60:63], v69 offset:2368
    s_waitcnt lgkmcnt(6)
    v_mfma_f32_32x32x16_bf16 v[20:35], v[48:51], v[64:67], v[20:35]
    ds_read_b128 v[48:51], v68 offset:2144
    ds_read_b128 v[64:67], v69 offset:2400
    s_waitcnt lgkmcnt(6)
    v_mfma_f32_32x32x16_bf16 v[20:35], v[36:39], v[52:55], v[20:35]
    ds_read_b128 v[36:39], v68 offset:1536
    ds_read_b128 v[52:55], v69 offset:1728
    s_waitcnt lgkmcnt(6)
    v_mfma_f32_32x32x16_bf16 v[20:35], v[40:43], v[56:59], v[20:35]
    ds_read_b128 v[40:43], v68 offset:1568
    ds_read_b128 v[56:59], v69 offset:1760
    s_waitcnt lgkmcnt(6)
    v_mfma_f32_32x32x16_bf16 v[20:35], v[44:47], v[60:63], v[20:35]
    ds_read_b128 v[44:47], v68 offset:1600
    ds_read_b128 v[60:63], v69 offset:1792
    s_waitcnt lgkmcnt(6)
    v_mfma_f32_32x32x16_bf16 v[20:35], v[48:51], v[64:67], v[20:35]
    ds_read_b128 v[48:51], v68 offset:1632
    ds_read_b128 v[64:67], v69 offset:1824
    s_waitcnt lgkmcnt(6)
    v_mfma_f32_32x32x16_bf16 v[20:35], v[36:39], v[52:55], v[20:35]
    ds_read_b128 v[36:39], v68 offset:1024
    ds_read_b128 v[52:55], v69 offset:1152
    s_waitcnt lgkmcnt(6)
    v_mfma_f32_32x32x16_bf16 v[20:35], v[40:43], v[56:59], v[20:35]
    ds_read_b128 v[40:43], v68 offset:1056
    ds_read_b128 v[56:59], v69 offset:1184
    s_waitcnt lgkmcnt(6)
    v_mfma_f32_32x32x16_bf16 v[20:35], v[44:47], v[60:63], v[20:35]
    ds_read_b128 v[44:47], v68 offset:1088
    ds_read_b128 v[60:63], v69 offset:1216
    s_waitcnt lgkmcnt(6)
    v_mfma_f32_32x32x16_bf16 v[20:35], v[48:51], v[64:67], v[20:35]
    ds_read_b128 v[48:51], v68 offset:1120
    ds_read_b128 v[64:67], v69 offset:1248
    s_waitcnt lgkmcnt(6)
    v_mfma_f32_32x32x16_bf16 v[20:35], v[36:39], v[52:55], v[20:35]
    ds_read_b128 v[36:39], v68 offset:512
    ds_read_b128 v[52:55], v69 offset:576
    s_waitcnt lgkmcnt(6)
    v_mfma_f32_32x32x16_bf16 v[20:35], v[40:43], v[56:59], v[20:35]
    ds_read_b128 v[40:43], v68 offset:544
    ds_read_b128 v[56:59], v69 offset:608
    s_waitcnt lgkmcnt(6)
    v_mfma_f32_32x32x16_bf16 v[20:35], v[44:47], v[60:63], v[20:35]
    ds_read_b128 v[44:47], v68 offset:576
    ds_read_b128 v[60:63], v69 offset:640
    s_waitcnt lgkmcnt(6)
    v_mfma_f32_32x32x16_bf16 v[20:35], v[48:51], v[64:67], v[20:35]
    ds_read_b128 v[48:51], v68 offset:608
    ds_read_b128 v[64:67], v69 offset:672
    s_waitcnt lgkmcnt(6)
    v_mfma_f32_32x32x16_bf16 v[20:35], v[36:39], v[52:55], v[20:35]
    ds_read_b128 v[36:39], v68 offset:0
    ds_read_b128 v[52:55], v69 offset:0
    s_waitcnt lgkmcnt(6)
    v_mfma_f32_32x32x16_bf16 v[20:35], v[40:43], v[56:59], v[20:35]
    ds_read_b128 v[40:43], v68 offset:32
    ds_read_b128 v[56:59], v69 offset:32
    s_waitcnt lgkmcnt(6)
    v_mfma_f32_32x32x16_bf16 v[20:35], v[44:47], v[60:63], v[20:35]
    ds_read_b128 v[44:47], v68 offset:64
    ds_read_b128 v[60:63], v69 offset:64
    s_waitcnt lgkmcnt(6)
    v_mfma_f32_32x32x16_bf16 v[20:35], v[48:51], v[64:67], v[20:35]
    ds_read_b128 v[48:51], v68 offset:96
    ds_read_b128 v[64:67], v69 offset:96
    s_waitcnt lgkmcnt(6)
    v_mfma_f32_32x32x16_bf16 v[20:35], v[36:39], v[52:55], v[20:35]
    s_waitcnt lgkmcnt(4)
    v_mfma_f32_32x32x16_bf16 v[20:35], v[40:43], v[56:59], v[20:35]
    s_waitcnt lgkmcnt(2)
    v_mfma_f32_32x32x16_bf16 v[20:35], v[44:47], v[60:63], v[20:35]
    s_waitcnt lgkmcnt(0)
    v_mfma_f32_32x32x16_bf16 v[20:35], v[48:51], v[64:67], v[20:35]
    s_nop 11
    ds_write_b128 v92, v[20:23] offset:0
    ds_write_b128 v92, v[24:27] offset:1056
    ds_write_b128 v92, v[28:31] offset:2112
    ds_write_b128 v92, v[32:35] offset:3168
    s_waitcnt lgkmcnt(0)
    s_barrier
    ds_read_b128 v[36:39], v93 offset:0
    ds_read_b128 v[40:43], v93 offset:8448
    ds_read_b128 v[44:47], v93 offset:16896
    ds_read_b128 v[48:51], v93 offset:25344
    s_and_b32 s34, s33, 0xffff0000
    v_lshlrev_b32 v76, 16, v80
    v_and_b32 v77, 0xffff0000, v80
    v_lshlrev_b32 v78, 16, v81
    v_and_b32 v79, 0xffff0000, v81
    v_mul_f32 v76, s34, v76
    v_mul_f32 v77, s34, v77
    v_mul_f32 v78, s34, v78
    v_mul_f32 v79, s34, v79
    v_cvt_pk_bf16_f32 v86, v76, v77
    v_cvt_pk_bf16_f32 v87, v78, v79
    s_waitcnt lgkmcnt(2)
    v_add_f32 v72, v36, v40
    s_waitcnt lgkmcnt(0)
    v_add_f32 v76, v44, v48
    v_add_f32 v72, v72, v76
    v_add_f32 v73, v37, v41
    v_add_f32 v77, v45, v49
    v_add_f32 v73, v73, v77
    v_add_f32 v74, v38, v42
    v_add_f32 v78, v46, v50
    v_add_f32 v74, v74, v78
    v_add_f32 v75, v39, v43
    v_add_f32 v79, v47, v51
    v_add_f32 v75, v75, v79
    v_cvt_pk_bf16_f32 v84, v72, v73
    v_cvt_pk_bf16_f32 v85, v74, v75
    v_lshlrev_b32 v6, 16, v84
    v_lshlrev_b32 v7, 16, v86
    v_add_f32 v6, v6, v7
    v_and_b32 v7, 0xffff0000, v84
    v_and_b32 v8, 0xffff0000, v86
    v_add_f32 v7, v7, v8
    v_cvt_pk_bf16_f32 v88, v6, v7
    v_lshlrev_b32 v6, 16, v85
    v_lshlrev_b32 v7, 16, v87
    v_add_f32 v6, v6, v7
    v_and_b32 v7, 0xffff0000, v85
    v_and_b32 v8, 0xffff0000, v87
    v_add_f32 v7, v7, v8
    v_cvt_pk_bf16_f32 v89, v6, v7
    buffer_store_dwordx2 v[88:89], v95, s[12:15], s22 offen
    s_add_u32 s22, s22, 4096
    s_endpgm
k2_kernel_exit_1:
    s_endpgm
.globl k3_kernel
.p2align 8
.type k3_kernel,@function
k3_kernel:
    s_load_dwordx2 s[6:7], s[0:1], 16
    s_load_dwordx2 s[8:9], s[0:1], 104
    s_load_dwordx2 s[10:11], s[0:1], 88
    s_cmp_ge_u32 s2, 192
    s_cbranch_scc1 k3_kernel_exit_1
    s_waitcnt lgkmcnt(0)
    s_mov_b32 s16, s6
    s_mov_b32 s17, s7
    s_mov_b32 s18, 663552
    s_mov_b32 s19, 0x00020000
    s_mov_b32 s20, s8
    s_mov_b32 s21, s9
    s_mov_b32 s22, 21784576
    s_mov_b32 s23, 0x00020000
    s_mov_b32 s24, s10
    s_mov_b32 s25, s11
    s_mov_b32 s26, 2359296
    s_mov_b32 s27, 0x00020000
    s_and_b32 s33, s2, 31
    s_lshr_b32 s34, s2, 5
    v_and_b32 v1, 63, v0
    v_and_b32 v2, 15, v0
    v_lshrrev_b32 v3, 4, v1
    v_lshrrev_b32 v4, 6, v0
    s_nop 0
    v_readfirstlane_b32 s28, v4
    s_mul_i32 s39, s33, 64
    s_nop 0
    s_lshl_b32 s36, s28, 5
    s_add_u32 s35, s39, s36
    s_mul_i32 s29, s35, 1152
    s_add_u32 s29, s29, 17065984
    s_mul_i32 s30, s34, 192
    s_lshl_b32 s31, s28, 12
    s_lshl_b32 s32, s28, 10
    s_add_u32 s32, s32, 24576
    v_lshrrev_b32 v4, 3, v1
    s_mov_b32 s37, 1152
    v_mul_lo_u32 v4, v4, s37
    v_and_b32 v5, 7, v1
    v_xor_b32 v5, v5, v3
    v_lshl_add_u32 v8, v5, 4, v4
    v_xor_b32 v6, 64, v8
    v_add_u32 v9, 9216, v6
    v_add_u32 v10, 18432, v8
    v_add_u32 v11, 27648, v6
    s_mov_b32 s38, 1152
    s_mov_b32 s37, 5462
    v_add_u32 v4, 0, v0
    v_mul_lo_u32 v5, v4, s37
    v_lshrrev_b32 v5, 16, v5
    v_mul_u32_u24 v6, 12, v5
    v_sub_u32 v6, v4, v6
    v_mul_lo_u32 v5, v5, s38
    v_lshl_add_u32 v12, v6, 4, v5
    v_add_u32 v4, 128, v0
    v_mul_lo_u32 v5, v4, s37
    v_lshrrev_b32 v5, 16, v5
    v_mul_u32_u24 v6, 12, v5
    v_sub_u32 v6, v4, v6
    v_mul_lo_u32 v5, v5, s38
    v_lshl_add_u32 v13, v6, 4, v5
    v_add_u32 v4, 256, v0
    v_mul_lo_u32 v5, v4, s37
    v_lshrrev_b32 v5, 16, v5
    v_mul_u32_u24 v6, 12, v5
    v_sub_u32 v6, v4, v6
    v_mul_lo_u32 v5, v5, s38
    v_lshl_add_u32 v14, v6, 4, v5
    v_add_u32 v4, 384, v0
    v_mul_lo_u32 v5, v4, s37
    v_lshrrev_b32 v5, 16, v5
    v_mul_u32_u24 v6, 12, v5
    v_sub_u32 v6, v4, v6
    v_mul_lo_u32 v5, v5, s38
    v_lshl_add_u32 v15, v6, 4, v5
    v_add_u32 v4, 512, v0
    v_mul_lo_u32 v5, v4, s37
    v_lshrrev_b32 v5, 16, v5
    v_mul_u32_u24 v6, 12, v5
    v_sub_u32 v6, v4, v6
    v_mul_lo_u32 v5, v5, s38
    v_lshl_add_u32 v16, v6, 4, v5
    v_add_u32 v4, 640, v0
    v_mul_lo_u32 v5, v4, s37
    v_lshrrev_b32 v5, 16, v5
    v_mul_u32_u24 v6, 12, v5
    v_sub_u32 v6, v4, v6
    v_mul_lo_u32 v5, v5, s38
    v_lshl_add_u32 v17, v6, 4, v5
    v_lshlrev_b32 v4, 5, s28
    v_add_u32 v4, v4, v2
    v_lshlrev_b32 v4, 7, v4
    v_and_b32 v5, 1, v3
    v_lshl_add_u32 v4, v5, 3, v4
    v_lshrrev_b32 v5, 1, v3
    v_lshrrev_b32 v6, 1, v2
    v_add_u32 v20, 0, v5
    v_xor_b32 v20, v20, v6
    v_lshl_add_u32 v20, v20, 4, v4
    v_add_u32 v21, 2, v5
    v_xor_b32 v21, v21, v6
    v_lshl_add_u32 v21, v21, 4, v4
    v_add_u32 v22, 4, v5
    v_xor_b32 v22, v22, v6
    v_lshl_add_u32 v22, v22, 4, v4
    v_add_u32 v23, 6, v5
    v_xor_b32 v23, v23, v6
    v_lshl_add_u32 v23, v23, 4, v4
    v_lshrrev_b32 v4, 2, v2
    v_lshl_add_u32 v4, v3, 2, v4
    v_mul_u32_u24 v4, 192, v4
    v_and_b32 v5, 3, v2
    v_lshl_add_u32 v4, v5, 3, v4
    v_add_u32 v24, 24576, v4
    v_mov_b32 v28, 0
    v_mov_b32 v29, 0
    v_mov_b32 v30, 0
    v_mov_b32 v31, 0
    v_mov_b32 v32, 0
    v_mov_b32 v33, 0
    v_mov_b32 v34, 0
    v_mov_b32 v35, 0
    v_mov_b32 v36, 0
    v_mov_b32 v37, 0
    v_mov_b32 v38, 0
    v_mov_b32 v39, 0
    v_mov_b32 v40, 0
    v_mov_b32 v41, 0
    v_mov_b32 v42, 0
    v_mov_b32 v43, 0
    v_mov_b32 v44, 0
    v_mov_b32 v45, 0
    v_mov_b32 v46, 0
    v_mov_b32 v47, 0
    v_mov_b32 v48, 0
    v_mov_b32 v49, 0
    v_mov_b32 v50, 0
    v_mov_b32 v51, 0
    v_mov_b32 v52, 0
    v_mov_b32 v53, 0
    v_mov_b32 v54, 0
    v_mov_b32 v55, 0
    v_mov_b32 v56, 0
    v_mov_b32 v57, 0
    v_mov_b32 v58, 0
    v_mov_b32 v59, 0
    v_mov_b32 v60, 0
    v_mov_b32 v61, 0
    v_mov_b32 v62, 0
    v_mov_b32 v63, 0
    v_mov_b32 v64, 0
    v_mov_b32 v65, 0
    v_mov_b32 v66, 0
    v_mov_b32 v67, 0
    v_mov_b32 v68, 0
    v_mov_b32 v69, 0
    v_mov_b32 v70, 0
    v_mov_b32 v71, 0
    v_mov_b32 v72, 0
    v_mov_b32 v73, 0
    v_mov_b32 v74, 0
    v_mov_b32 v75, 0
    v_lshrrev_b32 v4, 3, v1
    v_lshlrev_b32 v4, 12, v4
    v_and_b32 v5, 7, v1
    v_lshl_add_u32 v140, v5, 4, v4
    s_mul_i32 s35, s34, 393216
    s_lshl_b32 s36, s39, 1
    s_add_u32 s35, s35, s36
    s_add_u32 s35, s35, 19425280
    s_lshl_b32 s36, s28, 15
    s_add_u32 s35, s35, s36
    s_lshl_b32 s36, s28, 10
    s_add_u32 m0, s36, 61440
    s_add_u32 s37, s35, 0
    buffer_load_dwordx4 v140, s[20:23], s37 offen lds
    s_add_u32 m0, s36, 63488
    s_add_u32 s37, s35, 65536
    buffer_load_dwordx4 v140, s[20:23], s37 offen lds
    s_add_u32 m0, s36, 65536
    s_add_u32 s37, s35, 131072
    buffer_load_dwordx4 v140, s[20:23], s37 offen lds
    s_add_u32 m0, s36, 67584
    s_add_u32 s37, s35, 196608
    buffer_load_dwordx4 v140, s[20:23], s37 offen lds
    s_add_u32 m0, s36, 69632
    s_add_u32 s37, s35, 262144
    buffer_load_dwordx4 v140, s[20:23], s37 offen lds
    s_add_u32 m0, s36, 71680
    s_add_u32 s37, s35, 327680
    buffer_load_dwordx4 v140, s[20:23], s37 offen lds
    s_add_u32 m0, s31, 0
    s_nop 0
    buffer_load_dwordx4 v8, s[20:23], s29 offen lds
    s_add_u32 m0, s31, 1024
    s_nop 0
    buffer_load_dwordx4 v9, s[20:23], s29 offen lds
    s_add_u32 m0, s31, 2048
    s_nop 0
    buffer_load_dwordx4 v10, s[20:23], s29 offen lds
    s_add_u32 m0, s31, 3072
    s_nop 0
    buffer_load_dwordx4 v11, s[20:23], s29 offen lds
    s_add_u32 m0, s32, 0
    s_nop 0
    buffer_load_dwordx4 v12, s[16:19], s30 offen lds
    s_add_u32 m0, s32, 2048
    s_nop 0
    buffer_load_dwordx4 v13, s[16:19], s30 offen lds
    s_add_u32 m0, s32, 4096
    s_nop 0
    buffer_load_dwordx4 v14, s[16:19], s30 offen lds
    s_add_u32 m0, s32, 6144
    s_nop 0
    buffer_load_dwordx4 v15, s[16:19], s30 offen lds
    s_add_u32 m0, s32, 8192
    s_nop 0
    buffer_load_dwordx4 v16, s[16:19], s30 offen lds
    s_add_u32 m0, s32, 10240
    s_nop 0
    buffer_load_dwordx4 v17, s[16:19], s30 offen lds
    s_add_u32 s29, s29, 128
    s_add_u32 s30, s30, 73728
    s_add_u32 m0, s31, 8192
    s_nop 0
    buffer_load_dwordx4 v8, s[20:23], s29 offen lds
    s_add_u32 m0, s31, 9216
    s_nop 0
    buffer_load_dwordx4 v9, s[20:23], s29 offen lds
    s_add_u32 m0, s31, 10240
    s_nop 0
    buffer_load_dwordx4 v10, s[20:23], s29 offen lds
    s_add_u32 m0, s31, 11264
    s_nop 0
    buffer_load_dwordx4 v11, s[20:23], s29 offen lds
    s_add_u32 m0, s32, 12288
    s_nop 0
    buffer_load_dwordx4 v12, s[16:19], s30 offen lds
    s_add_u32 m0, s32, 14336
    s_nop 0
    buffer_load_dwordx4 v13, s[16:19], s30 offen lds
    s_add_u32 m0, s32, 16384
    s_nop 0
    buffer_load_dwordx4 v14, s[16:19], s30 offen lds
    s_add_u32 m0, s32, 18432
    s_nop 0
    buffer_load_dwordx4 v15, s[16:19], s30 offen lds
    s_add_u32 m0, s32, 20480
    s_nop 0
    buffer_load_dwordx4 v16, s[16:19], s30 offen lds
    s_add_u32 m0, s32, 22528
    s_nop 0
    buffer_load_dwordx4 v17, s[16:19], s30 offen lds
    s_add_u32 s29, s29, 128
    s_add_u32 s30, s30, 73728
    s_waitcnt vmcnt(10)
    s_barrier
    s_add_u32 m0, s31, 16384
    s_nop 0
    buffer_load_dwordx4 v8, s[20:23], s29 offen lds
    s_add_u32 m0, s31, 17408
    s_nop 0
    buffer_load_dwordx4 v9, s[20:23], s29 offen lds
    s_add_u32 m0, s31, 18432
    s_nop 0
    buffer_load_dwordx4 v10, s[20:23], s29 offen lds
    s_add_u32 m0, s31, 19456
    s_nop 0
    buffer_load_dwordx4 v11, s[20:23], s29 offen lds
    s_add_u32 m0, s32, 24576
    s_nop 0
    buffer_load_dwordx4 v12, s[16:19], s30 offen lds
    s_add_u32 m0, s32, 26624
    s_nop 0
    buffer_load_dwordx4 v13, s[16:19], s30 offen lds
    s_add_u32 m0, s32, 28672
    s_nop 0
    buffer_load_dwordx4 v14, s[16:19], s30 offen lds
    s_add_u32 m0, s32, 30720
    s_nop 0
    buffer_load_dwordx4 v15, s[16:19], s30 offen lds
    s_add_u32 m0, s32, 32768
    s_nop 0
    buffer_load_dwordx4 v16, s[16:19], s30 offen lds
    s_add_u32 m0, s32, 34816
    s_nop 0
    buffer_load_dwordx4 v17, s[16:19], s30 offen lds
    s_add_u32 s29, s29, 128
    s_add_u32 s30, s30, 73728
    ds_read_b64 v[76:77], v20 offset:0
    ds_read_b64 v[78:79], v21 offset:0
    ds_read_b64 v[80:81], v20 offset:2048
    ds_read_b64 v[82:83], v21 offset:2048
    ds_read_b64_tr_b16 v[92:93], v24 offset:0
    ds_read_b64_tr_b16 v[94:95], v24 offset:3072
    ds_read_b64_tr_b16 v[96:97], v24 offset:32
    ds_read_b64_tr_b16 v[98:99], v24 offset:3104
    ds_read_b64_tr_b16 v[100:101], v24 offset:64
    ds_read_b64_tr_b16 v[102:103], v24 offset:3136
    ds_read_b64_tr_b16 v[104:105], v24 offset:96
    ds_read_b64_tr_b16 v[106:107], v24 offset:3168
    ds_read_b64_tr_b16 v[108:109], v24 offset:128
    ds_read_b64_tr_b16 v[110:111], v24 offset:3200
    ds_read_b64_tr_b16 v[112:113], v24 offset:160
    ds_read_b64_tr_b16 v[114:115], v24 offset:3232
    ds_read_b64 v[84:85], v22 offset:0
    ds_read_b64 v[86:87], v23 offset:0
    ds_read_b64 v[88:89], v22 offset:2048
    ds_read_b64 v[90:91], v23 offset:2048
    ds_read_b64_tr_b16 v[116:117], v24 offset:6144
    ds_read_b64_tr_b16 v[118:119], v24 offset:9216
    s_waitcnt lgkmcnt(15)
    v_mfma_f32_16x16x32_bf16 v[28:31], v[92:95], v[76:79], v[28:31]
    v_mfma_f32_16x16x32_bf16 v[52:55], v[92:95], v[80:83], v[52:55]
    ds_read_b64_tr_b16 v[120:121], v24 offset:6176
    ds_read_b64_tr_b16 v[122:123], v24 offset:9248
    s_waitcnt lgkmcnt(15)
    v_mfma_f32_16x16x32_bf16 v[32:35], v[96:99], v[76:79], v[32:35]
    v_mfma_f32_16x16x32_bf16 v[56:59], v[96:99], v[80:83], v[56:59]
    ds_read_b64_tr_b16 v[124:125], v24 offset:6208
    ds_read_b64_tr_b16 v[126:127], v24 offset:9280
    s_waitcnt lgkmcnt(15)
    v_mfma_f32_16x16x32_bf16 v[36:39], v[100:103], v[76:79], v[36:39]
    v_mfma_f32_16x16x32_bf16 v[60:63], v[100:103], v[80:83], v[60:63]
    ds_read_b64_tr_b16 v[128:129], v24 offset:6240
    ds_read_b64_tr_b16 v[130:131], v24 offset:9312
    s_waitcnt lgkmcnt(15)
    v_mfma_f32_16x16x32_bf16 v[40:43], v[104:107], v[76:79], v[40:43]
    v_mfma_f32_16x16x32_bf16 v[64:67], v[104:107], v[80:83], v[64:67]
    ds_read_b64_tr_b16 v[132:133], v24 offset:6272
    ds_read_b64_tr_b16 v[134:135], v24 offset:9344
    s_waitcnt lgkmcnt(15)
    v_mfma_f32_16x16x32_bf16 v[44:47], v[108:111], v[76:79], v[44:47]
    v_mfma_f32_16x16x32_bf16 v[68:71], v[108:111], v[80:83], v[68:71]
    ds_read_b64_tr_b16 v[136:137], v24 offset:6304
    ds_read_b64_tr_b16 v[138:139], v24 offset:9376
    s_waitcnt lgkmcnt(15)
    v_mfma_f32_16x16x32_bf16 v[48:51], v[112:115], v[76:79], v[48:51]
    v_mfma_f32_16x16x32_bf16 v[72:75], v[112:115], v[80:83], v[72:75]
    s_waitcnt lgkmcnt(10)
    v_mfma_f32_16x16x32_bf16 v[28:31], v[116:119], v[84:87], v[28:31]
    v_mfma_f32_16x16x32_bf16 v[52:55], v[116:119], v[88:91], v[52:55]
    s_waitcnt lgkmcnt(8)
    v_mfma_f32_16x16x32_bf16 v[32:35], v[120:123], v[84:87], v[32:35]
    v_mfma_f32_16x16x32_bf16 v[56:59], v[120:123], v[88:91], v[56:59]
    s_waitcnt lgkmcnt(6)
    v_mfma_f32_16x16x32_bf16 v[36:39], v[124:127], v[84:87], v[36:39]
    v_mfma_f32_16x16x32_bf16 v[60:63], v[124:127], v[88:91], v[60:63]
    s_waitcnt lgkmcnt(4)
    v_mfma_f32_16x16x32_bf16 v[40:43], v[128:131], v[84:87], v[40:43]
    v_mfma_f32_16x16x32_bf16 v[64:67], v[128:131], v[88:91], v[64:67]
    s_waitcnt lgkmcnt(2)
    v_mfma_f32_16x16x32_bf16 v[44:47], v[132:135], v[84:87], v[44:47]
    v_mfma_f32_16x16x32_bf16 v[68:71], v[132:135], v[88:91], v[68:71]
    s_waitcnt lgkmcnt(0)
    v_mfma_f32_16x16x32_bf16 v[48:51], v[136:139], v[84:87], v[48:51]
    v_mfma_f32_16x16x32_bf16 v[72:75], v[136:139], v[88:91], v[72:75]
    s_waitcnt vmcnt(10)
    s_barrier
    s_add_u32 m0, s31, 0
    s_nop 0
    buffer_load_dwordx4 v8, s[20:23], s29 offen lds
    s_add_u32 m0, s31, 1024
    s_nop 0
    buffer_load_dwordx4 v9, s[20:23], s29 offen lds
    s_add_u32 m0, s31, 2048
    s_nop 0
    buffer_load_dwordx4 v10, s[20:23], s29 offen lds
    s_add_u32 m0, s31, 3072
    s_nop 0
    buffer_load_dwordx4 v11, s[20:23], s29 offen lds
    s_add_u32 m0, s32, 0
    s_nop 0
    buffer_load_dwordx4 v12, s[16:19], s30 offen lds
    s_add_u32 m0, s32, 2048
    s_nop 0
    buffer_load_dwordx4 v13, s[16:19], s30 offen lds
    s_add_u32 m0, s32, 4096
    s_nop 0
    buffer_load_dwordx4 v14, s[16:19], s30 offen lds
    s_add_u32 m0, s32, 6144
    s_nop 0
    buffer_load_dwordx4 v15, s[16:19], s30 offen lds
    s_add_u32 m0, s32, 8192
    s_nop 0
    buffer_load_dwordx4 v16, s[16:19], s30 offen lds
    s_add_u32 m0, s32, 10240
    s_nop 0
    buffer_load_dwordx4 v17, s[16:19], s30 offen lds
    s_add_u32 s29, s29, 128
    s_add_u32 s30, s30, 73728
    ds_read_b64 v[76:77], v20 offset:8192
    ds_read_b64 v[78:79], v21 offset:8192
    ds_read_b64 v[80:81], v20 offset:10240
    ds_read_b64 v[82:83], v21 offset:10240
    ds_read_b64_tr_b16 v[92:93], v24 offset:12288
    ds_read_b64_tr_b16 v[94:95], v24 offset:15360
    ds_read_b64_tr_b16 v[96:97], v24 offset:12320
    ds_read_b64_tr_b16 v[98:99], v24 offset:15392
    ds_read_b64_tr_b16 v[100:101], v24 offset:12352
    ds_read_b64_tr_b16 v[102:103], v24 offset:15424
    ds_read_b64_tr_b16 v[104:105], v24 offset:12384
    ds_read_b64_tr_b16 v[106:107], v24 offset:15456
    ds_read_b64_tr_b16 v[108:109], v24 offset:12416
    ds_read_b64_tr_b16 v[110:111], v24 offset:15488
    ds_read_b64_tr_b16 v[112:113], v24 offset:12448
    ds_read_b64_tr_b16 v[114:115], v24 offset:15520
    ds_read_b64 v[84:85], v22 offset:8192
    ds_read_b64 v[86:87], v23 offset:8192
    ds_read_b64 v[88:89], v22 offset:10240
    ds_read_b64 v[90:91], v23 offset:10240
    ds_read_b64_tr_b16 v[116:117], v24 offset:18432
    ds_read_b64_tr_b16 v[118:119], v24 offset:21504
    s_waitcnt lgkmcnt(15)
    v_mfma_f32_16x16x32_bf16 v[28:31], v[92:95], v[76:79], v[28:31]
    v_mfma_f32_16x16x32_bf16 v[52:55], v[92:95], v[80:83], v[52:55]
    ds_read_b64_tr_b16 v[120:121], v24 offset:18464
    ds_read_b64_tr_b16 v[122:123], v24 offset:21536
    s_waitcnt lgkmcnt(15)
    v_mfma_f32_16x16x32_bf16 v[32:35], v[96:99], v[76:79], v[32:35]
    v_mfma_f32_16x16x32_bf16 v[56:59], v[96:99], v[80:83], v[56:59]
    ds_read_b64_tr_b16 v[124:125], v24 offset:18496
    ds_read_b64_tr_b16 v[126:127], v24 offset:21568
    s_waitcnt lgkmcnt(15)
    v_mfma_f32_16x16x32_bf16 v[36:39], v[100:103], v[76:79], v[36:39]
    v_mfma_f32_16x16x32_bf16 v[60:63], v[100:103], v[80:83], v[60:63]
    ds_read_b64_tr_b16 v[128:129], v24 offset:18528
    ds_read_b64_tr_b16 v[130:131], v24 offset:21600
    s_waitcnt lgkmcnt(15)
    v_mfma_f32_16x16x32_bf16 v[40:43], v[104:107], v[76:79], v[40:43]
    v_mfma_f32_16x16x32_bf16 v[64:67], v[104:107], v[80:83], v[64:67]
    ds_read_b64_tr_b16 v[132:133], v24 offset:18560
    ds_read_b64_tr_b16 v[134:135], v24 offset:21632
    s_waitcnt lgkmcnt(15)
    v_mfma_f32_16x16x32_bf16 v[44:47], v[108:111], v[76:79], v[44:47]
    v_mfma_f32_16x16x32_bf16 v[68:71], v[108:111], v[80:83], v[68:71]
    ds_read_b64_tr_b16 v[136:137], v24 offset:18592
    ds_read_b64_tr_b16 v[138:139], v24 offset:21664
    s_waitcnt lgkmcnt(15)
    v_mfma_f32_16x16x32_bf16 v[48:51], v[112:115], v[76:79], v[48:51]
    v_mfma_f32_16x16x32_bf16 v[72:75], v[112:115], v[80:83], v[72:75]
    s_waitcnt lgkmcnt(10)
    v_mfma_f32_16x16x32_bf16 v[28:31], v[116:119], v[84:87], v[28:31]
    v_mfma_f32_16x16x32_bf16 v[52:55], v[116:119], v[88:91], v[52:55]
    s_waitcnt lgkmcnt(8)
    v_mfma_f32_16x16x32_bf16 v[32:35], v[120:123], v[84:87], v[32:35]
    v_mfma_f32_16x16x32_bf16 v[56:59], v[120:123], v[88:91], v[56:59]
    s_waitcnt lgkmcnt(6)
    v_mfma_f32_16x16x32_bf16 v[36:39], v[124:127], v[84:87], v[36:39]
    v_mfma_f32_16x16x32_bf16 v[60:63], v[124:127], v[88:91], v[60:63]
    s_waitcnt lgkmcnt(4)
    v_mfma_f32_16x16x32_bf16 v[40:43], v[128:131], v[84:87], v[40:43]
    v_mfma_f32_16x16x32_bf16 v[64:67], v[128:131], v[88:91], v[64:67]
    s_waitcnt lgkmcnt(2)
    v_mfma_f32_16x16x32_bf16 v[44:47], v[132:135], v[84:87], v[44:47]
    v_mfma_f32_16x16x32_bf16 v[68:71], v[132:135], v[88:91], v[68:71]
    s_waitcnt lgkmcnt(0)
    v_mfma_f32_16x16x32_bf16 v[48:51], v[136:139], v[84:87], v[48:51]
    v_mfma_f32_16x16x32_bf16 v[72:75], v[136:139], v[88:91], v[72:75]
    s_waitcnt vmcnt(10)
    s_barrier
    s_add_u32 m0, s31, 8192
    s_nop 0
    buffer_load_dwordx4 v8, s[20:23], s29 offen lds
    s_add_u32 m0, s31, 9216
    s_nop 0
    buffer_load_dwordx4 v9, s[20:23], s29 offen lds
    s_add_u32 m0, s31, 10240
    s_nop 0
    buffer_load_dwordx4 v10, s[20:23], s29 offen lds
    s_add_u32 m0, s31, 11264
    s_nop 0
    buffer_load_dwordx4 v11, s[20:23], s29 offen lds
    s_add_u32 m0, s32, 12288
    s_nop 0
    buffer_load_dwordx4 v12, s[16:19], s30 offen lds
    s_add_u32 m0, s32, 14336
    s_nop 0
    buffer_load_dwordx4 v13, s[16:19], s30 offen lds
    s_add_u32 m0, s32, 16384
    s_nop 0
    buffer_load_dwordx4 v14, s[16:19], s30 offen lds
    s_add_u32 m0, s32, 18432
    s_nop 0
    buffer_load_dwordx4 v15, s[16:19], s30 offen lds
    s_add_u32 m0, s32, 20480
    s_nop 0
    buffer_load_dwordx4 v16, s[16:19], s30 offen lds
    s_add_u32 m0, s32, 22528
    s_nop 0
    buffer_load_dwordx4 v17, s[16:19], s30 offen lds
    s_add_u32 s29, s29, 128
    s_add_u32 s30, s30, 73728
    ds_read_b64 v[76:77], v20 offset:16384
    ds_read_b64 v[78:79], v21 offset:16384
    ds_read_b64 v[80:81], v20 offset:18432
    ds_read_b64 v[82:83], v21 offset:18432
    ds_read_b64_tr_b16 v[92:93], v24 offset:24576
    ds_read_b64_tr_b16 v[94:95], v24 offset:27648
    ds_read_b64_tr_b16 v[96:97], v24 offset:24608
    ds_read_b64_tr_b16 v[98:99], v24 offset:27680
    ds_read_b64_tr_b16 v[100:101], v24 offset:24640
    ds_read_b64_tr_b16 v[102:103], v24 offset:27712
    ds_read_b64_tr_b16 v[104:105], v24 offset:24672
    ds_read_b64_tr_b16 v[106:107], v24 offset:27744
    ds_read_b64_tr_b16 v[108:109], v24 offset:24704
    ds_read_b64_tr_b16 v[110:111], v24 offset:27776
    ds_read_b64_tr_b16 v[112:113], v24 offset:24736
    ds_read_b64_tr_b16 v[114:115], v24 offset:27808
    ds_read_b64 v[84:85], v22 offset:16384
    ds_read_b64 v[86:87], v23 offset:16384
    ds_read_b64 v[88:89], v22 offset:18432
    ds_read_b64 v[90:91], v23 offset:18432
    ds_read_b64_tr_b16 v[116:117], v24 offset:30720
    ds_read_b64_tr_b16 v[118:119], v24 offset:33792
    s_waitcnt lgkmcnt(15)
    v_mfma_f32_16x16x32_bf16 v[28:31], v[92:95], v[76:79], v[28:31]
    v_mfma_f32_16x16x32_bf16 v[52:55], v[92:95], v[80:83], v[52:55]
    ds_read_b64_tr_b16 v[120:121], v24 offset:30752
    ds_read_b64_tr_b16 v[122:123], v24 offset:33824
    s_waitcnt lgkmcnt(15)
    v_mfma_f32_16x16x32_bf16 v[32:35], v[96:99], v[76:79], v[32:35]
    v_mfma_f32_16x16x32_bf16 v[56:59], v[96:99], v[80:83], v[56:59]
    ds_read_b64_tr_b16 v[124:125], v24 offset:30784
    ds_read_b64_tr_b16 v[126:127], v24 offset:33856
    s_waitcnt lgkmcnt(15)
    v_mfma_f32_16x16x32_bf16 v[36:39], v[100:103], v[76:79], v[36:39]
    v_mfma_f32_16x16x32_bf16 v[60:63], v[100:103], v[80:83], v[60:63]
    ds_read_b64_tr_b16 v[128:129], v24 offset:30816
    ds_read_b64_tr_b16 v[130:131], v24 offset:33888
    s_waitcnt lgkmcnt(15)
    v_mfma_f32_16x16x32_bf16 v[40:43], v[104:107], v[76:79], v[40:43]
    v_mfma_f32_16x16x32_bf16 v[64:67], v[104:107], v[80:83], v[64:67]
    ds_read_b64_tr_b16 v[132:133], v24 offset:30848
    ds_read_b64_tr_b16 v[134:135], v24 offset:33920
    s_waitcnt lgkmcnt(15)
    v_mfma_f32_16x16x32_bf16 v[44:47], v[108:111], v[76:79], v[44:47]
    v_mfma_f32_16x16x32_bf16 v[68:71], v[108:111], v[80:83], v[68:71]
    ds_read_b64_tr_b16 v[136:137], v24 offset:30880
    ds_read_b64_tr_b16 v[138:139], v24 offset:33952
    s_waitcnt lgkmcnt(15)
    v_mfma_f32_16x16x32_bf16 v[48:51], v[112:115], v[76:79], v[48:51]
    v_mfma_f32_16x16x32_bf16 v[72:75], v[112:115], v[80:83], v[72:75]
    s_waitcnt lgkmcnt(10)
    v_mfma_f32_16x16x32_bf16 v[28:31], v[116:119], v[84:87], v[28:31]
    v_mfma_f32_16x16x32_bf16 v[52:55], v[116:119], v[88:91], v[52:55]
    s_waitcnt lgkmcnt(8)
    v_mfma_f32_16x16x32_bf16 v[32:35], v[120:123], v[84:87], v[32:35]
    v_mfma_f32_16x16x32_bf16 v[56:59], v[120:123], v[88:91], v[56:59]
    s_waitcnt lgkmcnt(6)
    v_mfma_f32_16x16x32_bf16 v[36:39], v[124:127], v[84:87], v[36:39]
    v_mfma_f32_16x16x32_bf16 v[60:63], v[124:127], v[88:91], v[60:63]
    s_waitcnt lgkmcnt(4)
    v_mfma_f32_16x16x32_bf16 v[40:43], v[128:131], v[84:87], v[40:43]
    v_mfma_f32_16x16x32_bf16 v[64:67], v[128:131], v[88:91], v[64:67]
    s_waitcnt lgkmcnt(2)
    v_mfma_f32_16x16x32_bf16 v[44:47], v[132:135], v[84:87], v[44:47]
    v_mfma_f32_16x16x32_bf16 v[68:71], v[132:135], v[88:91], v[68:71]
    s_waitcnt lgkmcnt(0)
    v_mfma_f32_16x16x32_bf16 v[48:51], v[136:139], v[84:87], v[48:51]
    v_mfma_f32_16x16x32_bf16 v[72:75], v[136:139], v[88:91], v[72:75]
    s_waitcnt vmcnt(10)
    s_barrier
    s_add_u32 m0, s31, 16384
    s_nop 0
    buffer_load_dwordx4 v8, s[20:23], s29 offen lds
    s_add_u32 m0, s31, 17408
    s_nop 0
    buffer_load_dwordx4 v9, s[20:23], s29 offen lds
    s_add_u32 m0, s31, 18432
    s_nop 0
    buffer_load_dwordx4 v10, s[20:23], s29 offen lds
    s_add_u32 m0, s31, 19456
    s_nop 0
    buffer_load_dwordx4 v11, s[20:23], s29 offen lds
    s_add_u32 m0, s32, 24576
    s_nop 0
    buffer_load_dwordx4 v12, s[16:19], s30 offen lds
    s_add_u32 m0, s32, 26624
    s_nop 0
    buffer_load_dwordx4 v13, s[16:19], s30 offen lds
    s_add_u32 m0, s32, 28672
    s_nop 0
    buffer_load_dwordx4 v14, s[16:19], s30 offen lds
    s_add_u32 m0, s32, 30720
    s_nop 0
    buffer_load_dwordx4 v15, s[16:19], s30 offen lds
    s_add_u32 m0, s32, 32768
    s_nop 0
    buffer_load_dwordx4 v16, s[16:19], s30 offen lds
    s_add_u32 m0, s32, 34816
    s_nop 0
    buffer_load_dwordx4 v17, s[16:19], s30 offen lds
    s_add_u32 s29, s29, 128
    s_add_u32 s30, s30, 73728
    ds_read_b64 v[76:77], v20 offset:0
    ds_read_b64 v[78:79], v21 offset:0
    ds_read_b64 v[80:81], v20 offset:2048
    ds_read_b64 v[82:83], v21 offset:2048
    ds_read_b64_tr_b16 v[92:93], v24 offset:0
    ds_read_b64_tr_b16 v[94:95], v24 offset:3072
    ds_read_b64_tr_b16 v[96:97], v24 offset:32
    ds_read_b64_tr_b16 v[98:99], v24 offset:3104
    ds_read_b64_tr_b16 v[100:101], v24 offset:64
    ds_read_b64_tr_b16 v[102:103], v24 offset:3136
    ds_read_b64_tr_b16 v[104:105], v24 offset:96
    ds_read_b64_tr_b16 v[106:107], v24 offset:3168
    ds_read_b64_tr_b16 v[108:109], v24 offset:128
    ds_read_b64_tr_b16 v[110:111], v24 offset:3200
    ds_read_b64_tr_b16 v[112:113], v24 offset:160
    ds_read_b64_tr_b16 v[114:115], v24 offset:3232
    ds_read_b64 v[84:85], v22 offset:0
    ds_read_b64 v[86:87], v23 offset:0
    ds_read_b64 v[88:89], v22 offset:2048
    ds_read_b64 v[90:91], v23 offset:2048
    ds_read_b64_tr_b16 v[116:117], v24 offset:6144
    ds_read_b64_tr_b16 v[118:119], v24 offset:9216
    s_waitcnt lgkmcnt(15)
    v_mfma_f32_16x16x32_bf16 v[28:31], v[92:95], v[76:79], v[28:31]
    v_mfma_f32_16x16x32_bf16 v[52:55], v[92:95], v[80:83], v[52:55]
    ds_read_b64_tr_b16 v[120:121], v24 offset:6176
    ds_read_b64_tr_b16 v[122:123], v24 offset:9248
    s_waitcnt lgkmcnt(15)
    v_mfma_f32_16x16x32_bf16 v[32:35], v[96:99], v[76:79], v[32:35]
    v_mfma_f32_16x16x32_bf16 v[56:59], v[96:99], v[80:83], v[56:59]
    ds_read_b64_tr_b16 v[124:125], v24 offset:6208
    ds_read_b64_tr_b16 v[126:127], v24 offset:9280
    s_waitcnt lgkmcnt(15)
    v_mfma_f32_16x16x32_bf16 v[36:39], v[100:103], v[76:79], v[36:39]
    v_mfma_f32_16x16x32_bf16 v[60:63], v[100:103], v[80:83], v[60:63]
    ds_read_b64_tr_b16 v[128:129], v24 offset:6240
    ds_read_b64_tr_b16 v[130:131], v24 offset:9312
    s_waitcnt lgkmcnt(15)
    v_mfma_f32_16x16x32_bf16 v[40:43], v[104:107], v[76:79], v[40:43]
    v_mfma_f32_16x16x32_bf16 v[64:67], v[104:107], v[80:83], v[64:67]
    ds_read_b64_tr_b16 v[132:133], v24 offset:6272
    ds_read_b64_tr_b16 v[134:135], v24 offset:9344
    s_waitcnt lgkmcnt(15)
    v_mfma_f32_16x16x32_bf16 v[44:47], v[108:111], v[76:79], v[44:47]
    v_mfma_f32_16x16x32_bf16 v[68:71], v[108:111], v[80:83], v[68:71]
    ds_read_b64_tr_b16 v[136:137], v24 offset:6304
    ds_read_b64_tr_b16 v[138:139], v24 offset:9376
    s_waitcnt lgkmcnt(15)
    v_mfma_f32_16x16x32_bf16 v[48:51], v[112:115], v[76:79], v[48:51]
    v_mfma_f32_16x16x32_bf16 v[72:75], v[112:115], v[80:83], v[72:75]
    s_waitcnt lgkmcnt(10)
    v_mfma_f32_16x16x32_bf16 v[28:31], v[116:119], v[84:87], v[28:31]
    v_mfma_f32_16x16x32_bf16 v[52:55], v[116:119], v[88:91], v[52:55]
    s_waitcnt lgkmcnt(8)
    v_mfma_f32_16x16x32_bf16 v[32:35], v[120:123], v[84:87], v[32:35]
    v_mfma_f32_16x16x32_bf16 v[56:59], v[120:123], v[88:91], v[56:59]
    s_waitcnt lgkmcnt(6)
    v_mfma_f32_16x16x32_bf16 v[36:39], v[124:127], v[84:87], v[36:39]
    v_mfma_f32_16x16x32_bf16 v[60:63], v[124:127], v[88:91], v[60:63]
    s_waitcnt lgkmcnt(4)
    v_mfma_f32_16x16x32_bf16 v[40:43], v[128:131], v[84:87], v[40:43]
    v_mfma_f32_16x16x32_bf16 v[64:67], v[128:131], v[88:91], v[64:67]
    s_waitcnt lgkmcnt(2)
    v_mfma_f32_16x16x32_bf16 v[44:47], v[132:135], v[84:87], v[44:47]
    v_mfma_f32_16x16x32_bf16 v[68:71], v[132:135], v[88:91], v[68:71]
    s_waitcnt lgkmcnt(0)
    v_mfma_f32_16x16x32_bf16 v[48:51], v[136:139], v[84:87], v[48:51]
    v_mfma_f32_16x16x32_bf16 v[72:75], v[136:139], v[88:91], v[72:75]
    s_waitcnt vmcnt(10)
    s_barrier
    s_add_u32 m0, s31, 0
    s_nop 0
    buffer_load_dwordx4 v8, s[20:23], s29 offen lds
    s_add_u32 m0, s31, 1024
    s_nop 0
    buffer_load_dwordx4 v9, s[20:23], s29 offen lds
    s_add_u32 m0, s31, 2048
    s_nop 0
    buffer_load_dwordx4 v10, s[20:23], s29 offen lds
    s_add_u32 m0, s31, 3072
    s_nop 0
    buffer_load_dwordx4 v11, s[20:23], s29 offen lds
    s_add_u32 m0, s32, 0
    s_nop 0
    buffer_load_dwordx4 v12, s[16:19], s30 offen lds
    s_add_u32 m0, s32, 2048
    s_nop 0
    buffer_load_dwordx4 v13, s[16:19], s30 offen lds
    s_add_u32 m0, s32, 4096
    s_nop 0
    buffer_load_dwordx4 v14, s[16:19], s30 offen lds
    s_add_u32 m0, s32, 6144
    s_nop 0
    buffer_load_dwordx4 v15, s[16:19], s30 offen lds
    s_add_u32 m0, s32, 8192
    s_nop 0
    buffer_load_dwordx4 v16, s[16:19], s30 offen lds
    s_add_u32 m0, s32, 10240
    s_nop 0
    buffer_load_dwordx4 v17, s[16:19], s30 offen lds
    s_add_u32 s29, s29, 128
    s_add_u32 s30, s30, 73728
    ds_read_b64 v[76:77], v20 offset:8192
    ds_read_b64 v[78:79], v21 offset:8192
    ds_read_b64 v[80:81], v20 offset:10240
    ds_read_b64 v[82:83], v21 offset:10240
    ds_read_b64_tr_b16 v[92:93], v24 offset:12288
    ds_read_b64_tr_b16 v[94:95], v24 offset:15360
    ds_read_b64_tr_b16 v[96:97], v24 offset:12320
    ds_read_b64_tr_b16 v[98:99], v24 offset:15392
    ds_read_b64_tr_b16 v[100:101], v24 offset:12352
    ds_read_b64_tr_b16 v[102:103], v24 offset:15424
    ds_read_b64_tr_b16 v[104:105], v24 offset:12384
    ds_read_b64_tr_b16 v[106:107], v24 offset:15456
    ds_read_b64_tr_b16 v[108:109], v24 offset:12416
    ds_read_b64_tr_b16 v[110:111], v24 offset:15488
    ds_read_b64_tr_b16 v[112:113], v24 offset:12448
    ds_read_b64_tr_b16 v[114:115], v24 offset:15520
    ds_read_b64 v[84:85], v22 offset:8192
    ds_read_b64 v[86:87], v23 offset:8192
    ds_read_b64 v[88:89], v22 offset:10240
    ds_read_b64 v[90:91], v23 offset:10240
    ds_read_b64_tr_b16 v[116:117], v24 offset:18432
    ds_read_b64_tr_b16 v[118:119], v24 offset:21504
    s_waitcnt lgkmcnt(15)
    v_mfma_f32_16x16x32_bf16 v[28:31], v[92:95], v[76:79], v[28:31]
    v_mfma_f32_16x16x32_bf16 v[52:55], v[92:95], v[80:83], v[52:55]
    ds_read_b64_tr_b16 v[120:121], v24 offset:18464
    ds_read_b64_tr_b16 v[122:123], v24 offset:21536
    s_waitcnt lgkmcnt(15)
    v_mfma_f32_16x16x32_bf16 v[32:35], v[96:99], v[76:79], v[32:35]
    v_mfma_f32_16x16x32_bf16 v[56:59], v[96:99], v[80:83], v[56:59]
    ds_read_b64_tr_b16 v[124:125], v24 offset:18496
    ds_read_b64_tr_b16 v[126:127], v24 offset:21568
    s_waitcnt lgkmcnt(15)
    v_mfma_f32_16x16x32_bf16 v[36:39], v[100:103], v[76:79], v[36:39]
    v_mfma_f32_16x16x32_bf16 v[60:63], v[100:103], v[80:83], v[60:63]
    ds_read_b64_tr_b16 v[128:129], v24 offset:18528
    ds_read_b64_tr_b16 v[130:131], v24 offset:21600
    s_waitcnt lgkmcnt(15)
    v_mfma_f32_16x16x32_bf16 v[40:43], v[104:107], v[76:79], v[40:43]
    v_mfma_f32_16x16x32_bf16 v[64:67], v[104:107], v[80:83], v[64:67]
    ds_read_b64_tr_b16 v[132:133], v24 offset:18560
    ds_read_b64_tr_b16 v[134:135], v24 offset:21632
    s_waitcnt lgkmcnt(15)
    v_mfma_f32_16x16x32_bf16 v[44:47], v[108:111], v[76:79], v[44:47]
    v_mfma_f32_16x16x32_bf16 v[68:71], v[108:111], v[80:83], v[68:71]
    ds_read_b64_tr_b16 v[136:137], v24 offset:18592
    ds_read_b64_tr_b16 v[138:139], v24 offset:21664
    s_waitcnt lgkmcnt(15)
    v_mfma_f32_16x16x32_bf16 v[48:51], v[112:115], v[76:79], v[48:51]
    v_mfma_f32_16x16x32_bf16 v[72:75], v[112:115], v[80:83], v[72:75]
    s_waitcnt lgkmcnt(10)
    v_mfma_f32_16x16x32_bf16 v[28:31], v[116:119], v[84:87], v[28:31]
    v_mfma_f32_16x16x32_bf16 v[52:55], v[116:119], v[88:91], v[52:55]
    s_waitcnt lgkmcnt(8)
    v_mfma_f32_16x16x32_bf16 v[32:35], v[120:123], v[84:87], v[32:35]
    v_mfma_f32_16x16x32_bf16 v[56:59], v[120:123], v[88:91], v[56:59]
    s_waitcnt lgkmcnt(6)
    v_mfma_f32_16x16x32_bf16 v[36:39], v[124:127], v[84:87], v[36:39]
    v_mfma_f32_16x16x32_bf16 v[60:63], v[124:127], v[88:91], v[60:63]
    s_waitcnt lgkmcnt(4)
    v_mfma_f32_16x16x32_bf16 v[40:43], v[128:131], v[84:87], v[40:43]
    v_mfma_f32_16x16x32_bf16 v[64:67], v[128:131], v[88:91], v[64:67]
    s_waitcnt lgkmcnt(2)
    v_mfma_f32_16x16x32_bf16 v[44:47], v[132:135], v[84:87], v[44:47]
    v_mfma_f32_16x16x32_bf16 v[68:71], v[132:135], v[88:91], v[68:71]
    s_waitcnt lgkmcnt(0)
    v_mfma_f32_16x16x32_bf16 v[48:51], v[136:139], v[84:87], v[48:51]
    v_mfma_f32_16x16x32_bf16 v[72:75], v[136:139], v[88:91], v[72:75]
    s_waitcnt vmcnt(10)
    s_barrier
    s_add_u32 m0, s31, 8192
    s_nop 0
    buffer_load_dwordx4 v8, s[20:23], s29 offen lds
    s_add_u32 m0, s31, 9216
    s_nop 0
    buffer_load_dwordx4 v9, s[20:23], s29 offen lds
    s_add_u32 m0, s31, 10240
    s_nop 0
    buffer_load_dwordx4 v10, s[20:23], s29 offen lds
    s_add_u32 m0, s31, 11264
    s_nop 0
    buffer_load_dwordx4 v11, s[20:23], s29 offen lds
    s_add_u32 m0, s32, 12288
    s_nop 0
    buffer_load_dwordx4 v12, s[16:19], s30 offen lds
    s_add_u32 m0, s32, 14336
    s_nop 0
    buffer_load_dwordx4 v13, s[16:19], s30 offen lds
    s_add_u32 m0, s32, 16384
    s_nop 0
    buffer_load_dwordx4 v14, s[16:19], s30 offen lds
    s_add_u32 m0, s32, 18432
    s_nop 0
    buffer_load_dwordx4 v15, s[16:19], s30 offen lds
    s_add_u32 m0, s32, 20480
    s_nop 0
    buffer_load_dwordx4 v16, s[16:19], s30 offen lds
    s_add_u32 m0, s32, 22528
    s_nop 0
    buffer_load_dwordx4 v17, s[16:19], s30 offen lds
    s_add_u32 s29, s29, 128
    s_add_u32 s30, s30, 73728
    ds_read_b64 v[76:77], v20 offset:16384
    ds_read_b64 v[78:79], v21 offset:16384
    ds_read_b64 v[80:81], v20 offset:18432
    ds_read_b64 v[82:83], v21 offset:18432
    ds_read_b64_tr_b16 v[92:93], v24 offset:24576
    ds_read_b64_tr_b16 v[94:95], v24 offset:27648
    ds_read_b64_tr_b16 v[96:97], v24 offset:24608
    ds_read_b64_tr_b16 v[98:99], v24 offset:27680
    ds_read_b64_tr_b16 v[100:101], v24 offset:24640
    ds_read_b64_tr_b16 v[102:103], v24 offset:27712
    ds_read_b64_tr_b16 v[104:105], v24 offset:24672
    ds_read_b64_tr_b16 v[106:107], v24 offset:27744
    ds_read_b64_tr_b16 v[108:109], v24 offset:24704
    ds_read_b64_tr_b16 v[110:111], v24 offset:27776
    ds_read_b64_tr_b16 v[112:113], v24 offset:24736
    ds_read_b64_tr_b16 v[114:115], v24 offset:27808
    ds_read_b64 v[84:85], v22 offset:16384
    ds_read_b64 v[86:87], v23 offset:16384
    ds_read_b64 v[88:89], v22 offset:18432
    ds_read_b64 v[90:91], v23 offset:18432
    ds_read_b64_tr_b16 v[116:117], v24 offset:30720
    ds_read_b64_tr_b16 v[118:119], v24 offset:33792
    s_waitcnt lgkmcnt(15)
    v_mfma_f32_16x16x32_bf16 v[28:31], v[92:95], v[76:79], v[28:31]
    v_mfma_f32_16x16x32_bf16 v[52:55], v[92:95], v[80:83], v[52:55]
    ds_read_b64_tr_b16 v[120:121], v24 offset:30752
    ds_read_b64_tr_b16 v[122:123], v24 offset:33824
    s_waitcnt lgkmcnt(15)
    v_mfma_f32_16x16x32_bf16 v[32:35], v[96:99], v[76:79], v[32:35]
    v_mfma_f32_16x16x32_bf16 v[56:59], v[96:99], v[80:83], v[56:59]
    ds_read_b64_tr_b16 v[124:125], v24 offset:30784
    ds_read_b64_tr_b16 v[126:127], v24 offset:33856
    s_waitcnt lgkmcnt(15)
    v_mfma_f32_16x16x32_bf16 v[36:39], v[100:103], v[76:79], v[36:39]
    v_mfma_f32_16x16x32_bf16 v[60:63], v[100:103], v[80:83], v[60:63]
    ds_read_b64_tr_b16 v[128:129], v24 offset:30816
    ds_read_b64_tr_b16 v[130:131], v24 offset:33888
    s_waitcnt lgkmcnt(15)
    v_mfma_f32_16x16x32_bf16 v[40:43], v[104:107], v[76:79], v[40:43]
    v_mfma_f32_16x16x32_bf16 v[64:67], v[104:107], v[80:83], v[64:67]
    ds_read_b64_tr_b16 v[132:133], v24 offset:30848
    ds_read_b64_tr_b16 v[134:135], v24 offset:33920
    s_waitcnt lgkmcnt(15)
    v_mfma_f32_16x16x32_bf16 v[44:47], v[108:111], v[76:79], v[44:47]
    v_mfma_f32_16x16x32_bf16 v[68:71], v[108:111], v[80:83], v[68:71]
    ds_read_b64_tr_b16 v[136:137], v24 offset:30880
    ds_read_b64_tr_b16 v[138:139], v24 offset:33952
    s_waitcnt lgkmcnt(15)
    v_mfma_f32_16x16x32_bf16 v[48:51], v[112:115], v[76:79], v[48:51]
    v_mfma_f32_16x16x32_bf16 v[72:75], v[112:115], v[80:83], v[72:75]
    s_waitcnt lgkmcnt(10)
    v_mfma_f32_16x16x32_bf16 v[28:31], v[116:119], v[84:87], v[28:31]
    v_mfma_f32_16x16x32_bf16 v[52:55], v[116:119], v[88:91], v[52:55]
    s_waitcnt lgkmcnt(8)
    v_mfma_f32_16x16x32_bf16 v[32:35], v[120:123], v[84:87], v[32:35]
    v_mfma_f32_16x16x32_bf16 v[56:59], v[120:123], v[88:91], v[56:59]
    s_waitcnt lgkmcnt(6)
    v_mfma_f32_16x16x32_bf16 v[36:39], v[124:127], v[84:87], v[36:39]
    v_mfma_f32_16x16x32_bf16 v[60:63], v[124:127], v[88:91], v[60:63]
    s_waitcnt lgkmcnt(4)
    v_mfma_f32_16x16x32_bf16 v[40:43], v[128:131], v[84:87], v[40:43]
    v_mfma_f32_16x16x32_bf16 v[64:67], v[128:131], v[88:91], v[64:67]
    s_waitcnt lgkmcnt(2)
    v_mfma_f32_16x16x32_bf16 v[44:47], v[132:135], v[84:87], v[44:47]
    v_mfma_f32_16x16x32_bf16 v[68:71], v[132:135], v[88:91], v[68:71]
    s_waitcnt lgkmcnt(0)
    v_mfma_f32_16x16x32_bf16 v[48:51], v[136:139], v[84:87], v[48:51]
    v_mfma_f32_16x16x32_bf16 v[72:75], v[136:139], v[88:91], v[72:75]
    s_waitcnt vmcnt(10)
    s_barrier
    s_add_u32 m0, s31, 16384
    s_nop 0
    buffer_load_dwordx4 v8, s[20:23], s29 offen lds
    s_add_u32 m0, s31, 17408
    s_nop 0
    buffer_load_dwordx4 v9, s[20:23], s29 offen lds
    s_add_u32 m0, s31, 18432
    s_nop 0
    buffer_load_dwordx4 v10, s[20:23], s29 offen lds
    s_add_u32 m0, s31, 19456
    s_nop 0
    buffer_load_dwordx4 v11, s[20:23], s29 offen lds
    s_add_u32 m0, s32, 24576
    s_nop 0
    buffer_load_dwordx4 v12, s[16:19], s30 offen lds
    s_add_u32 m0, s32, 26624
    s_nop 0
    buffer_load_dwordx4 v13, s[16:19], s30 offen lds
    s_add_u32 m0, s32, 28672
    s_nop 0
    buffer_load_dwordx4 v14, s[16:19], s30 offen lds
    s_add_u32 m0, s32, 30720
    s_nop 0
    buffer_load_dwordx4 v15, s[16:19], s30 offen lds
    s_add_u32 m0, s32, 32768
    s_nop 0
    buffer_load_dwordx4 v16, s[16:19], s30 offen lds
    s_add_u32 m0, s32, 34816
    s_nop 0
    buffer_load_dwordx4 v17, s[16:19], s30 offen lds
    s_add_u32 s29, s29, 128
    s_add_u32 s30, s30, 73728
    ds_read_b64 v[76:77], v20 offset:0
    ds_read_b64 v[78:79], v21 offset:0
    ds_read_b64 v[80:81], v20 offset:2048
    ds_read_b64 v[82:83], v21 offset:2048
    ds_read_b64_tr_b16 v[92:93], v24 offset:0
    ds_read_b64_tr_b16 v[94:95], v24 offset:3072
    ds_read_b64_tr_b16 v[96:97], v24 offset:32
    ds_read_b64_tr_b16 v[98:99], v24 offset:3104
    ds_read_b64_tr_b16 v[100:101], v24 offset:64
    ds_read_b64_tr_b16 v[102:103], v24 offset:3136
    ds_read_b64_tr_b16 v[104:105], v24 offset:96
    ds_read_b64_tr_b16 v[106:107], v24 offset:3168
    ds_read_b64_tr_b16 v[108:109], v24 offset:128
    ds_read_b64_tr_b16 v[110:111], v24 offset:3200
    ds_read_b64_tr_b16 v[112:113], v24 offset:160
    ds_read_b64_tr_b16 v[114:115], v24 offset:3232
    ds_read_b64 v[84:85], v22 offset:0
    ds_read_b64 v[86:87], v23 offset:0
    ds_read_b64 v[88:89], v22 offset:2048
    ds_read_b64 v[90:91], v23 offset:2048
    ds_read_b64_tr_b16 v[116:117], v24 offset:6144
    ds_read_b64_tr_b16 v[118:119], v24 offset:9216
    s_waitcnt lgkmcnt(15)
    v_mfma_f32_16x16x32_bf16 v[28:31], v[92:95], v[76:79], v[28:31]
    v_mfma_f32_16x16x32_bf16 v[52:55], v[92:95], v[80:83], v[52:55]
    ds_read_b64_tr_b16 v[120:121], v24 offset:6176
    ds_read_b64_tr_b16 v[122:123], v24 offset:9248
    s_waitcnt lgkmcnt(15)
    v_mfma_f32_16x16x32_bf16 v[32:35], v[96:99], v[76:79], v[32:35]
    v_mfma_f32_16x16x32_bf16 v[56:59], v[96:99], v[80:83], v[56:59]
    ds_read_b64_tr_b16 v[124:125], v24 offset:6208
    ds_read_b64_tr_b16 v[126:127], v24 offset:9280
    s_waitcnt lgkmcnt(15)
    v_mfma_f32_16x16x32_bf16 v[36:39], v[100:103], v[76:79], v[36:39]
    v_mfma_f32_16x16x32_bf16 v[60:63], v[100:103], v[80:83], v[60:63]
    ds_read_b64_tr_b16 v[128:129], v24 offset:6240
    ds_read_b64_tr_b16 v[130:131], v24 offset:9312
    s_waitcnt lgkmcnt(15)
    v_mfma_f32_16x16x32_bf16 v[40:43], v[104:107], v[76:79], v[40:43]
    v_mfma_f32_16x16x32_bf16 v[64:67], v[104:107], v[80:83], v[64:67]
    ds_read_b64_tr_b16 v[132:133], v24 offset:6272
    ds_read_b64_tr_b16 v[134:135], v24 offset:9344
    s_waitcnt lgkmcnt(15)
    v_mfma_f32_16x16x32_bf16 v[44:47], v[108:111], v[76:79], v[44:47]
    v_mfma_f32_16x16x32_bf16 v[68:71], v[108:111], v[80:83], v[68:71]
    ds_read_b64_tr_b16 v[136:137], v24 offset:6304
    ds_read_b64_tr_b16 v[138:139], v24 offset:9376
    s_waitcnt lgkmcnt(15)
    v_mfma_f32_16x16x32_bf16 v[48:51], v[112:115], v[76:79], v[48:51]
    v_mfma_f32_16x16x32_bf16 v[72:75], v[112:115], v[80:83], v[72:75]
    s_waitcnt lgkmcnt(10)
    v_mfma_f32_16x16x32_bf16 v[28:31], v[116:119], v[84:87], v[28:31]
    v_mfma_f32_16x16x32_bf16 v[52:55], v[116:119], v[88:91], v[52:55]
    s_waitcnt lgkmcnt(8)
    v_mfma_f32_16x16x32_bf16 v[32:35], v[120:123], v[84:87], v[32:35]
    v_mfma_f32_16x16x32_bf16 v[56:59], v[120:123], v[88:91], v[56:59]
    s_waitcnt lgkmcnt(6)
    v_mfma_f32_16x16x32_bf16 v[36:39], v[124:127], v[84:87], v[36:39]
    v_mfma_f32_16x16x32_bf16 v[60:63], v[124:127], v[88:91], v[60:63]
    s_waitcnt lgkmcnt(4)
    v_mfma_f32_16x16x32_bf16 v[40:43], v[128:131], v[84:87], v[40:43]
    v_mfma_f32_16x16x32_bf16 v[64:67], v[128:131], v[88:91], v[64:67]
    s_waitcnt lgkmcnt(2)
    v_mfma_f32_16x16x32_bf16 v[44:47], v[132:135], v[84:87], v[44:47]
    v_mfma_f32_16x16x32_bf16 v[68:71], v[132:135], v[88:91], v[68:71]
    s_waitcnt lgkmcnt(0)
    v_mfma_f32_16x16x32_bf16 v[48:51], v[136:139], v[84:87], v[48:51]
    v_mfma_f32_16x16x32_bf16 v[72:75], v[136:139], v[88:91], v[72:75]
    s_waitcnt vmcnt(10)
    s_barrier
    ds_read_b64 v[76:77], v20 offset:8192
    ds_read_b64 v[78:79], v21 offset:8192
    ds_read_b64 v[80:81], v20 offset:10240
    ds_read_b64 v[82:83], v21 offset:10240
    ds_read_b64_tr_b16 v[92:93], v24 offset:12288
    ds_read_b64_tr_b16 v[94:95], v24 offset:15360
    ds_read_b64_tr_b16 v[96:97], v24 offset:12320
    ds_read_b64_tr_b16 v[98:99], v24 offset:15392
    ds_read_b64_tr_b16 v[100:101], v24 offset:12352
    ds_read_b64_tr_b16 v[102:103], v24 offset:15424
    ds_read_b64_tr_b16 v[104:105], v24 offset:12384
    ds_read_b64_tr_b16 v[106:107], v24 offset:15456
    ds_read_b64_tr_b16 v[108:109], v24 offset:12416
    ds_read_b64_tr_b16 v[110:111], v24 offset:15488
    ds_read_b64_tr_b16 v[112:113], v24 offset:12448
    ds_read_b64_tr_b16 v[114:115], v24 offset:15520
    ds_read_b64 v[84:85], v22 offset:8192
    ds_read_b64 v[86:87], v23 offset:8192
    ds_read_b64 v[88:89], v22 offset:10240
    ds_read_b64 v[90:91], v23 offset:10240
    ds_read_b64_tr_b16 v[116:117], v24 offset:18432
    ds_read_b64_tr_b16 v[118:119], v24 offset:21504
    s_waitcnt lgkmcnt(15)
    v_mfma_f32_16x16x32_bf16 v[28:31], v[92:95], v[76:79], v[28:31]
    v_mfma_f32_16x16x32_bf16 v[52:55], v[92:95], v[80:83], v[52:55]
    ds_read_b64_tr_b16 v[120:121], v24 offset:18464
    ds_read_b64_tr_b16 v[122:123], v24 offset:21536
    s_waitcnt lgkmcnt(15)
    v_mfma_f32_16x16x32_bf16 v[32:35], v[96:99], v[76:79], v[32:35]
    v_mfma_f32_16x16x32_bf16 v[56:59], v[96:99], v[80:83], v[56:59]
    ds_read_b64_tr_b16 v[124:125], v24 offset:18496
    ds_read_b64_tr_b16 v[126:127], v24 offset:21568
    s_waitcnt lgkmcnt(15)
    v_mfma_f32_16x16x32_bf16 v[36:39], v[100:103], v[76:79], v[36:39]
    v_mfma_f32_16x16x32_bf16 v[60:63], v[100:103], v[80:83], v[60:63]
    ds_read_b64_tr_b16 v[128:129], v24 offset:18528
    ds_read_b64_tr_b16 v[130:131], v24 offset:21600
    s_waitcnt lgkmcnt(15)
    v_mfma_f32_16x16x32_bf16 v[40:43], v[104:107], v[76:79], v[40:43]
    v_mfma_f32_16x16x32_bf16 v[64:67], v[104:107], v[80:83], v[64:67]
    ds_read_b64_tr_b16 v[132:133], v24 offset:18560
    ds_read_b64_tr_b16 v[134:135], v24 offset:21632
    s_waitcnt lgkmcnt(15)
    v_mfma_f32_16x16x32_bf16 v[44:47], v[108:111], v[76:79], v[44:47]
    v_mfma_f32_16x16x32_bf16 v[68:71], v[108:111], v[80:83], v[68:71]
    ds_read_b64_tr_b16 v[136:137], v24 offset:18592
    ds_read_b64_tr_b16 v[138:139], v24 offset:21664
    s_waitcnt lgkmcnt(15)
    v_mfma_f32_16x16x32_bf16 v[48:51], v[112:115], v[76:79], v[48:51]
    v_mfma_f32_16x16x32_bf16 v[72:75], v[112:115], v[80:83], v[72:75]
    s_waitcnt lgkmcnt(10)
    v_mfma_f32_16x16x32_bf16 v[28:31], v[116:119], v[84:87], v[28:31]
    v_mfma_f32_16x16x32_bf16 v[52:55], v[116:119], v[88:91], v[52:55]
    s_waitcnt lgkmcnt(8)
    v_mfma_f32_16x16x32_bf16 v[32:35], v[120:123], v[84:87], v[32:35]
    v_mfma_f32_16x16x32_bf16 v[56:59], v[120:123], v[88:91], v[56:59]
    s_waitcnt lgkmcnt(6)
    v_mfma_f32_16x16x32_bf16 v[36:39], v[124:127], v[84:87], v[36:39]
    v_mfma_f32_16x16x32_bf16 v[60:63], v[124:127], v[88:91], v[60:63]
    s_waitcnt lgkmcnt(4)
    v_mfma_f32_16x16x32_bf16 v[40:43], v[128:131], v[84:87], v[40:43]
    v_mfma_f32_16x16x32_bf16 v[64:67], v[128:131], v[88:91], v[64:67]
    s_waitcnt lgkmcnt(2)
    v_mfma_f32_16x16x32_bf16 v[44:47], v[132:135], v[84:87], v[44:47]
    v_mfma_f32_16x16x32_bf16 v[68:71], v[132:135], v[88:91], v[68:71]
    s_waitcnt lgkmcnt(0)
    v_mfma_f32_16x16x32_bf16 v[48:51], v[136:139], v[84:87], v[48:51]
    v_mfma_f32_16x16x32_bf16 v[72:75], v[136:139], v[88:91], v[72:75]
    s_waitcnt vmcnt(0)
    s_barrier
    ds_read_b64 v[76:77], v20 offset:16384
    ds_read_b64 v[78:79], v21 offset:16384
    ds_read_b64 v[80:81], v20 offset:18432
    ds_read_b64 v[82:83], v21 offset:18432
    ds_read_b64_tr_b16 v[92:93], v24 offset:24576
    ds_read_b64_tr_b16 v[94:95], v24 offset:27648
    ds_read_b64_tr_b16 v[96:97], v24 offset:24608
    ds_read_b64_tr_b16 v[98:99], v24 offset:27680
    ds_read_b64_tr_b16 v[100:101], v24 offset:24640
    ds_read_b64_tr_b16 v[102:103], v24 offset:27712
    ds_read_b64_tr_b16 v[104:105], v24 offset:24672
    ds_read_b64_tr_b16 v[106:107], v24 offset:27744
    ds_read_b64_tr_b16 v[108:109], v24 offset:24704
    ds_read_b64_tr_b16 v[110:111], v24 offset:27776
    ds_read_b64_tr_b16 v[112:113], v24 offset:24736
    ds_read_b64_tr_b16 v[114:115], v24 offset:27808
    ds_read_b64 v[84:85], v22 offset:16384
    ds_read_b64 v[86:87], v23 offset:16384
    ds_read_b64 v[88:89], v22 offset:18432
    ds_read_b64 v[90:91], v23 offset:18432
    ds_read_b64_tr_b16 v[116:117], v24 offset:30720
    ds_read_b64_tr_b16 v[118:119], v24 offset:33792
    s_waitcnt lgkmcnt(15)
    v_mfma_f32_16x16x32_bf16 v[28:31], v[92:95], v[76:79], v[28:31]
    v_mfma_f32_16x16x32_bf16 v[52:55], v[92:95], v[80:83], v[52:55]
    ds_read_b64_tr_b16 v[120:121], v24 offset:30752
    ds_read_b64_tr_b16 v[122:123], v24 offset:33824
    s_waitcnt lgkmcnt(15)
    v_mfma_f32_16x16x32_bf16 v[32:35], v[96:99], v[76:79], v[32:35]
    v_mfma_f32_16x16x32_bf16 v[56:59], v[96:99], v[80:83], v[56:59]
    ds_read_b64_tr_b16 v[124:125], v24 offset:30784
    ds_read_b64_tr_b16 v[126:127], v24 offset:33856
    s_waitcnt lgkmcnt(15)
    v_mfma_f32_16x16x32_bf16 v[36:39], v[100:103], v[76:79], v[36:39]
    v_mfma_f32_16x16x32_bf16 v[60:63], v[100:103], v[80:83], v[60:63]
    ds_read_b64_tr_b16 v[128:129], v24 offset:30816
    ds_read_b64_tr_b16 v[130:131], v24 offset:33888
    s_waitcnt lgkmcnt(15)
    v_mfma_f32_16x16x32_bf16 v[40:43], v[104:107], v[76:79], v[40:43]
    v_mfma_f32_16x16x32_bf16 v[64:67], v[104:107], v[80:83], v[64:67]
    ds_read_b64_tr_b16 v[132:133], v24 offset:30848
    ds_read_b64_tr_b16 v[134:135], v24 offset:33920
    s_waitcnt lgkmcnt(15)
    v_mfma_f32_16x16x32_bf16 v[44:47], v[108:111], v[76:79], v[44:47]
    v_mfma_f32_16x16x32_bf16 v[68:71], v[108:111], v[80:83], v[68:71]
    ds_read_b64_tr_b16 v[136:137], v24 offset:30880
    ds_read_b64_tr_b16 v[138:139], v24 offset:33952
    s_waitcnt lgkmcnt(15)
    v_mfma_f32_16x16x32_bf16 v[48:51], v[112:115], v[76:79], v[48:51]
    v_mfma_f32_16x16x32_bf16 v[72:75], v[112:115], v[80:83], v[72:75]
    s_waitcnt lgkmcnt(10)
    v_mfma_f32_16x16x32_bf16 v[28:31], v[116:119], v[84:87], v[28:31]
    v_mfma_f32_16x16x32_bf16 v[52:55], v[116:119], v[88:91], v[52:55]
    s_waitcnt lgkmcnt(8)
    v_mfma_f32_16x16x32_bf16 v[32:35], v[120:123], v[84:87], v[32:35]
    v_mfma_f32_16x16x32_bf16 v[56:59], v[120:123], v[88:91], v[56:59]
    s_waitcnt lgkmcnt(6)
    v_mfma_f32_16x16x32_bf16 v[36:39], v[124:127], v[84:87], v[36:39]
    v_mfma_f32_16x16x32_bf16 v[60:63], v[124:127], v[88:91], v[60:63]
    s_waitcnt lgkmcnt(4)
    v_mfma_f32_16x16x32_bf16 v[40:43], v[128:131], v[84:87], v[40:43]
    v_mfma_f32_16x16x32_bf16 v[64:67], v[128:131], v[88:91], v[64:67]
    s_waitcnt lgkmcnt(2)
    v_mfma_f32_16x16x32_bf16 v[44:47], v[132:135], v[84:87], v[44:47]
    v_mfma_f32_16x16x32_bf16 v[68:71], v[132:135], v[88:91], v[68:71]
    s_waitcnt lgkmcnt(0)
    v_mfma_f32_16x16x32_bf16 v[48:51], v[136:139], v[84:87], v[48:51]
    v_mfma_f32_16x16x32_bf16 v[72:75], v[136:139], v[88:91], v[72:75]
    s_lshl_b32 s36, s28, 5
    s_add_u32 s35, s39, s36
    s_lshl_b32 s36, s35, 2
    s_add_u32 s36, s36, 17057792
    v_lshlrev_b32 v4, 2, v2
    buffer_load_dword v142, v4, s[20:23], s36 offen
    buffer_load_dword v143, v4, s[20:23], s36 offen offset:64
    v_mul_u32_u24 v5, 1152, v2
    v_lshl_add_u32 v5, v3, 3, v5
    s_mul_i32 s37, s35, 1152
    s_mul_i32 s38, s34, 192
    s_add_u32 s37, s37, s38
    s_add_u32 s38, s37, 19425280
    v_lshrrev_b32 v4, 2, v2
    v_lshl_add_u32 v4, v3, 2, v4
    v_lshlrev_b32 v4, 7, v4
    v_and_b32 v6, 3, v2
    v_lshl_add_u32 v4, v6, 3, v4
    s_lshl_b32 s36, s28, 6
    s_add_u32 s36, s36, 61440
    v_add_u32 v4, s36, v4
    ds_read_b64_tr_b16 v[92:93], v4 offset:0
    ds_read_b64_tr_b16 v[94:95], v4 offset:2048
    ds_read_b64_tr_b16 v[96:97], v4 offset:4096
    ds_read_b64_tr_b16 v[98:99], v4 offset:6144
    ds_read_b64_tr_b16 v[100:101], v4 offset:8192
    ds_read_b64_tr_b16 v[102:103], v4 offset:10240
    ds_read_b64_tr_b16 v[104:105], v4 offset:32
    ds_read_b64_tr_b16 v[106:107], v4 offset:2080
    ds_read_b64_tr_b16 v[108:109], v4 offset:4128
    ds_read_b64_tr_b16 v[110:111], v4 offset:6176
    ds_read_b64_tr_b16 v[112:113], v4 offset:8224
    ds_read_b64_tr_b16 v[114:115], v4 offset:10272
    s_waitcnt vmcnt(1)
    v_sub_f32 v144, 1.0, v142
    v_cvt_pk_bf16_f32 v144, v144, v144
    v_lshlrev_b32 v144, 16, v144
    s_waitcnt vmcnt(0)
    v_sub_f32 v145, 1.0, v143
    v_cvt_pk_bf16_f32 v145, v145, v145
    v_lshlrev_b32 v145, 16, v145
    s_add_u32 s36, s37, 0
    v_cvt_pk_bf16_f32 v146, v28, v29
    v_cvt_pk_bf16_f32 v147, v30, v31
    v_lshlrev_b32 v28, 16, v146
    v_and_b32 v29, 0xffff0000, v146
    v_lshlrev_b32 v30, 16, v147
    v_and_b32 v31, 0xffff0000, v147
    v_mul_f32 v28, v142, v28
    v_mul_f32 v29, v142, v29
    v_mul_f32 v30, v142, v30
    v_mul_f32 v31, v142, v31
    v_cvt_pk_bf16_f32 v146, v28, v29
    v_cvt_pk_bf16_f32 v147, v30, v31
    s_waitcnt lgkmcnt(11)
    v_lshlrev_b32 v148, 16, v92
    v_and_b32 v149, 0xffff0000, v92
    v_lshlrev_b32 v150, 16, v93
    v_and_b32 v151, 0xffff0000, v93
    v_mul_f32 v148, v144, v148
    v_mul_f32 v149, v144, v149
    v_mul_f32 v150, v144, v150
    v_mul_f32 v151, v144, v151
    v_cvt_pk_bf16_f32 v148, v148, v149
    v_cvt_pk_bf16_f32 v149, v150, v151
    v_lshlrev_b32 v150, 16, v146
    v_lshlrev_b32 v151, 16, v148
    v_add_f32 v150, v150, v151
    v_and_b32 v151, 0xffff0000, v146
    v_and_b32 v152, 0xffff0000, v148
    v_add_f32 v151, v151, v152
    v_cvt_pk_bf16_f32 v92, v150, v151
    v_lshlrev_b32 v150, 16, v147
    v_lshlrev_b32 v151, 16, v149
    v_add_f32 v150, v150, v151
    v_and_b32 v151, 0xffff0000, v147
    v_and_b32 v152, 0xffff0000, v149
    v_add_f32 v151, v151, v152
    v_cvt_pk_bf16_f32 v93, v150, v151
    buffer_store_dwordx2 v[92:93], v5, s[24:27], s36 offen offset:0
    v_cvt_pk_bf16_f32 v146, v32, v33
    v_cvt_pk_bf16_f32 v147, v34, v35
    v_lshlrev_b32 v32, 16, v146
    v_and_b32 v33, 0xffff0000, v146
    v_lshlrev_b32 v34, 16, v147
    v_and_b32 v35, 0xffff0000, v147
    v_mul_f32 v32, v142, v32
    v_mul_f32 v33, v142, v33
    v_mul_f32 v34, v142, v34
    v_mul_f32 v35, v142, v35
    v_cvt_pk_bf16_f32 v146, v32, v33
    v_cvt_pk_bf16_f32 v147, v34, v35
    s_waitcnt lgkmcnt(10)
    v_lshlrev_b32 v148, 16, v94
    v_and_b32 v149, 0xffff0000, v94
    v_lshlrev_b32 v150, 16, v95
    v_and_b32 v151, 0xffff0000, v95
    v_mul_f32 v148, v144, v148
    v_mul_f32 v149, v144, v149
    v_mul_f32 v150, v144, v150
    v_mul_f32 v151, v144, v151
    v_cvt_pk_bf16_f32 v148, v148, v149
    v_cvt_pk_bf16_f32 v149, v150, v151
    v_lshlrev_b32 v150, 16, v146
    v_lshlrev_b32 v151, 16, v148
    v_add_f32 v150, v150, v151
    v_and_b32 v151, 0xffff0000, v146
    v_and_b32 v152, 0xffff0000, v148
    v_add_f32 v151, v151, v152
    v_cvt_pk_bf16_f32 v94, v150, v151
    v_lshlrev_b32 v150, 16, v147
    v_lshlrev_b32 v151, 16, v149
    v_add_f32 v150, v150, v151
    v_and_b32 v151, 0xffff0000, v147
    v_and_b32 v152, 0xffff0000, v149
    v_add_f32 v151, v151, v152
    v_cvt_pk_bf16_f32 v95, v150, v151
    buffer_store_dwordx2 v[94:95], v5, s[24:27], s36 offen offset:32
    v_cvt_pk_bf16_f32 v146, v36, v37
    v_cvt_pk_bf16_f32 v147, v38, v39
    v_lshlrev_b32 v36, 16, v146
    v_and_b32 v37, 0xffff0000, v146
    v_lshlrev_b32 v38, 16, v147
    v_and_b32 v39, 0xffff0000, v147
    v_mul_f32 v36, v142, v36
    v_mul_f32 v37, v142, v37
    v_mul_f32 v38, v142, v38
    v_mul_f32 v39, v142, v39
    v_cvt_pk_bf16_f32 v146, v36, v37
    v_cvt_pk_bf16_f32 v147, v38, v39
    s_waitcnt lgkmcnt(9)
    v_lshlrev_b32 v148, 16, v96
    v_and_b32 v149, 0xffff0000, v96
    v_lshlrev_b32 v150, 16, v97
    v_and_b32 v151, 0xffff0000, v97
    v_mul_f32 v148, v144, v148
    v_mul_f32 v149, v144, v149
    v_mul_f32 v150, v144, v150
    v_mul_f32 v151, v144, v151
    v_cvt_pk_bf16_f32 v148, v148, v149
    v_cvt_pk_bf16_f32 v149, v150, v151
    v_lshlrev_b32 v150, 16, v146
    v_lshlrev_b32 v151, 16, v148
    v_add_f32 v150, v150, v151
    v_and_b32 v151, 0xffff0000, v146
    v_and_b32 v152, 0xffff0000, v148
    v_add_f32 v151, v151, v152
    v_cvt_pk_bf16_f32 v96, v150, v151
    v_lshlrev_b32 v150, 16, v147
    v_lshlrev_b32 v151, 16, v149
    v_add_f32 v150, v150, v151
    v_and_b32 v151, 0xffff0000, v147
    v_and_b32 v152, 0xffff0000, v149
    v_add_f32 v151, v151, v152
    v_cvt_pk_bf16_f32 v97, v150, v151
    buffer_store_dwordx2 v[96:97], v5, s[24:27], s36 offen offset:64
    v_cvt_pk_bf16_f32 v146, v40, v41
    v_cvt_pk_bf16_f32 v147, v42, v43
    v_lshlrev_b32 v40, 16, v146
    v_and_b32 v41, 0xffff0000, v146
    v_lshlrev_b32 v42, 16, v147
    v_and_b32 v43, 0xffff0000, v147
    v_mul_f32 v40, v142, v40
    v_mul_f32 v41, v142, v41
    v_mul_f32 v42, v142, v42
    v_mul_f32 v43, v142, v43
    v_cvt_pk_bf16_f32 v146, v40, v41
    v_cvt_pk_bf16_f32 v147, v42, v43
    s_waitcnt lgkmcnt(8)
    v_lshlrev_b32 v148, 16, v98
    v_and_b32 v149, 0xffff0000, v98
    v_lshlrev_b32 v150, 16, v99
    v_and_b32 v151, 0xffff0000, v99
    v_mul_f32 v148, v144, v148
    v_mul_f32 v149, v144, v149
    v_mul_f32 v150, v144, v150
    v_mul_f32 v151, v144, v151
    v_cvt_pk_bf16_f32 v148, v148, v149
    v_cvt_pk_bf16_f32 v149, v150, v151
    v_lshlrev_b32 v150, 16, v146
    v_lshlrev_b32 v151, 16, v148
    v_add_f32 v150, v150, v151
    v_and_b32 v151, 0xffff0000, v146
    v_and_b32 v152, 0xffff0000, v148
    v_add_f32 v151, v151, v152
    v_cvt_pk_bf16_f32 v98, v150, v151
    v_lshlrev_b32 v150, 16, v147
    v_lshlrev_b32 v151, 16, v149
    v_add_f32 v150, v150, v151
    v_and_b32 v151, 0xffff0000, v147
    v_and_b32 v152, 0xffff0000, v149
    v_add_f32 v151, v151, v152
    v_cvt_pk_bf16_f32 v99, v150, v151
    buffer_store_dwordx2 v[98:99], v5, s[24:27], s36 offen offset:96
    v_cvt_pk_bf16_f32 v146, v44, v45
    v_cvt_pk_bf16_f32 v147, v46, v47
    v_lshlrev_b32 v44, 16, v146
    v_and_b32 v45, 0xffff0000, v146
    v_lshlrev_b32 v46, 16, v147
    v_and_b32 v47, 0xffff0000, v147
    v_mul_f32 v44, v142, v44
    v_mul_f32 v45, v142, v45
    v_mul_f32 v46, v142, v46
    v_mul_f32 v47, v142, v47
    v_cvt_pk_bf16_f32 v146, v44, v45
    v_cvt_pk_bf16_f32 v147, v46, v47
    s_waitcnt lgkmcnt(7)
    v_lshlrev_b32 v148, 16, v100
    v_and_b32 v149, 0xffff0000, v100
    v_lshlrev_b32 v150, 16, v101
    v_and_b32 v151, 0xffff0000, v101
    v_mul_f32 v148, v144, v148
    v_mul_f32 v149, v144, v149
    v_mul_f32 v150, v144, v150
    v_mul_f32 v151, v144, v151
    v_cvt_pk_bf16_f32 v148, v148, v149
    v_cvt_pk_bf16_f32 v149, v150, v151
    v_lshlrev_b32 v150, 16, v146
    v_lshlrev_b32 v151, 16, v148
    v_add_f32 v150, v150, v151
    v_and_b32 v151, 0xffff0000, v146
    v_and_b32 v152, 0xffff0000, v148
    v_add_f32 v151, v151, v152
    v_cvt_pk_bf16_f32 v100, v150, v151
    v_lshlrev_b32 v150, 16, v147
    v_lshlrev_b32 v151, 16, v149
    v_add_f32 v150, v150, v151
    v_and_b32 v151, 0xffff0000, v147
    v_and_b32 v152, 0xffff0000, v149
    v_add_f32 v151, v151, v152
    v_cvt_pk_bf16_f32 v101, v150, v151
    buffer_store_dwordx2 v[100:101], v5, s[24:27], s36 offen offset:128
    v_cvt_pk_bf16_f32 v146, v48, v49
    v_cvt_pk_bf16_f32 v147, v50, v51
    v_lshlrev_b32 v48, 16, v146
    v_and_b32 v49, 0xffff0000, v146
    v_lshlrev_b32 v50, 16, v147
    v_and_b32 v51, 0xffff0000, v147
    v_mul_f32 v48, v142, v48
    v_mul_f32 v49, v142, v49
    v_mul_f32 v50, v142, v50
    v_mul_f32 v51, v142, v51
    v_cvt_pk_bf16_f32 v146, v48, v49
    v_cvt_pk_bf16_f32 v147, v50, v51
    s_waitcnt lgkmcnt(6)
    v_lshlrev_b32 v148, 16, v102
    v_and_b32 v149, 0xffff0000, v102
    v_lshlrev_b32 v150, 16, v103
    v_and_b32 v151, 0xffff0000, v103
    v_mul_f32 v148, v144, v148
    v_mul_f32 v149, v144, v149
    v_mul_f32 v150, v144, v150
    v_mul_f32 v151, v144, v151
    v_cvt_pk_bf16_f32 v148, v148, v149
    v_cvt_pk_bf16_f32 v149, v150, v151
    v_lshlrev_b32 v150, 16, v146
    v_lshlrev_b32 v151, 16, v148
    v_add_f32 v150, v150, v151
    v_and_b32 v151, 0xffff0000, v146
    v_and_b32 v152, 0xffff0000, v148
    v_add_f32 v151, v151, v152
    v_cvt_pk_bf16_f32 v102, v150, v151
    v_lshlrev_b32 v150, 16, v147
    v_lshlrev_b32 v151, 16, v149
    v_add_f32 v150, v150, v151
    v_and_b32 v151, 0xffff0000, v147
    v_and_b32 v152, 0xffff0000, v149
    v_add_f32 v151, v151, v152
    v_cvt_pk_bf16_f32 v103, v150, v151
    buffer_store_dwordx2 v[102:103], v5, s[24:27], s36 offen offset:160
    s_add_u32 s36, s37, 18432
    v_cvt_pk_bf16_f32 v146, v52, v53
    v_cvt_pk_bf16_f32 v147, v54, v55
    v_lshlrev_b32 v52, 16, v146
    v_and_b32 v53, 0xffff0000, v146
    v_lshlrev_b32 v54, 16, v147
    v_and_b32 v55, 0xffff0000, v147
    v_mul_f32 v52, v143, v52
    v_mul_f32 v53, v143, v53
    v_mul_f32 v54, v143, v54
    v_mul_f32 v55, v143, v55
    v_cvt_pk_bf16_f32 v146, v52, v53
    v_cvt_pk_bf16_f32 v147, v54, v55
    s_waitcnt lgkmcnt(5)
    v_lshlrev_b32 v148, 16, v104
    v_and_b32 v149, 0xffff0000, v104
    v_lshlrev_b32 v150, 16, v105
    v_and_b32 v151, 0xffff0000, v105
    v_mul_f32 v148, v145, v148
    v_mul_f32 v149, v145, v149
    v_mul_f32 v150, v145, v150
    v_mul_f32 v151, v145, v151
    v_cvt_pk_bf16_f32 v148, v148, v149
    v_cvt_pk_bf16_f32 v149, v150, v151
    v_lshlrev_b32 v150, 16, v146
    v_lshlrev_b32 v151, 16, v148
    v_add_f32 v150, v150, v151
    v_and_b32 v151, 0xffff0000, v146
    v_and_b32 v152, 0xffff0000, v148
    v_add_f32 v151, v151, v152
    v_cvt_pk_bf16_f32 v104, v150, v151
    v_lshlrev_b32 v150, 16, v147
    v_lshlrev_b32 v151, 16, v149
    v_add_f32 v150, v150, v151
    v_and_b32 v151, 0xffff0000, v147
    v_and_b32 v152, 0xffff0000, v149
    v_add_f32 v151, v151, v152
    v_cvt_pk_bf16_f32 v105, v150, v151
    buffer_store_dwordx2 v[104:105], v5, s[24:27], s36 offen offset:0
    v_cvt_pk_bf16_f32 v146, v56, v57
    v_cvt_pk_bf16_f32 v147, v58, v59
    v_lshlrev_b32 v56, 16, v146
    v_and_b32 v57, 0xffff0000, v146
    v_lshlrev_b32 v58, 16, v147
    v_and_b32 v59, 0xffff0000, v147
    v_mul_f32 v56, v143, v56
    v_mul_f32 v57, v143, v57
    v_mul_f32 v58, v143, v58
    v_mul_f32 v59, v143, v59
    v_cvt_pk_bf16_f32 v146, v56, v57
    v_cvt_pk_bf16_f32 v147, v58, v59
    s_waitcnt lgkmcnt(4)
    v_lshlrev_b32 v148, 16, v106
    v_and_b32 v149, 0xffff0000, v106
    v_lshlrev_b32 v150, 16, v107
    v_and_b32 v151, 0xffff0000, v107
    v_mul_f32 v148, v145, v148
    v_mul_f32 v149, v145, v149
    v_mul_f32 v150, v145, v150
    v_mul_f32 v151, v145, v151
    v_cvt_pk_bf16_f32 v148, v148, v149
    v_cvt_pk_bf16_f32 v149, v150, v151
    v_lshlrev_b32 v150, 16, v146
    v_lshlrev_b32 v151, 16, v148
    v_add_f32 v150, v150, v151
    v_and_b32 v151, 0xffff0000, v146
    v_and_b32 v152, 0xffff0000, v148
    v_add_f32 v151, v151, v152
    v_cvt_pk_bf16_f32 v106, v150, v151
    v_lshlrev_b32 v150, 16, v147
    v_lshlrev_b32 v151, 16, v149
    v_add_f32 v150, v150, v151
    v_and_b32 v151, 0xffff0000, v147
    v_and_b32 v152, 0xffff0000, v149
    v_add_f32 v151, v151, v152
    v_cvt_pk_bf16_f32 v107, v150, v151
    buffer_store_dwordx2 v[106:107], v5, s[24:27], s36 offen offset:32
    v_cvt_pk_bf16_f32 v146, v60, v61
    v_cvt_pk_bf16_f32 v147, v62, v63
    v_lshlrev_b32 v60, 16, v146
    v_and_b32 v61, 0xffff0000, v146
    v_lshlrev_b32 v62, 16, v147
    v_and_b32 v63, 0xffff0000, v147
    v_mul_f32 v60, v143, v60
    v_mul_f32 v61, v143, v61
    v_mul_f32 v62, v143, v62
    v_mul_f32 v63, v143, v63
    v_cvt_pk_bf16_f32 v146, v60, v61
    v_cvt_pk_bf16_f32 v147, v62, v63
    s_waitcnt lgkmcnt(3)
    v_lshlrev_b32 v148, 16, v108
    v_and_b32 v149, 0xffff0000, v108
    v_lshlrev_b32 v150, 16, v109
    v_and_b32 v151, 0xffff0000, v109
    v_mul_f32 v148, v145, v148
    v_mul_f32 v149, v145, v149
    v_mul_f32 v150, v145, v150
    v_mul_f32 v151, v145, v151
    v_cvt_pk_bf16_f32 v148, v148, v149
    v_cvt_pk_bf16_f32 v149, v150, v151
    v_lshlrev_b32 v150, 16, v146
    v_lshlrev_b32 v151, 16, v148
    v_add_f32 v150, v150, v151
    v_and_b32 v151, 0xffff0000, v146
    v_and_b32 v152, 0xffff0000, v148
    v_add_f32 v151, v151, v152
    v_cvt_pk_bf16_f32 v108, v150, v151
    v_lshlrev_b32 v150, 16, v147
    v_lshlrev_b32 v151, 16, v149
    v_add_f32 v150, v150, v151
    v_and_b32 v151, 0xffff0000, v147
    v_and_b32 v152, 0xffff0000, v149
    v_add_f32 v151, v151, v152
    v_cvt_pk_bf16_f32 v109, v150, v151
    buffer_store_dwordx2 v[108:109], v5, s[24:27], s36 offen offset:64
    v_cvt_pk_bf16_f32 v146, v64, v65
    v_cvt_pk_bf16_f32 v147, v66, v67
    v_lshlrev_b32 v64, 16, v146
    v_and_b32 v65, 0xffff0000, v146
    v_lshlrev_b32 v66, 16, v147
    v_and_b32 v67, 0xffff0000, v147
    v_mul_f32 v64, v143, v64
    v_mul_f32 v65, v143, v65
    v_mul_f32 v66, v143, v66
    v_mul_f32 v67, v143, v67
    v_cvt_pk_bf16_f32 v146, v64, v65
    v_cvt_pk_bf16_f32 v147, v66, v67
    s_waitcnt lgkmcnt(2)
    v_lshlrev_b32 v148, 16, v110
    v_and_b32 v149, 0xffff0000, v110
    v_lshlrev_b32 v150, 16, v111
    v_and_b32 v151, 0xffff0000, v111
    v_mul_f32 v148, v145, v148
    v_mul_f32 v149, v145, v149
    v_mul_f32 v150, v145, v150
    v_mul_f32 v151, v145, v151
    v_cvt_pk_bf16_f32 v148, v148, v149
    v_cvt_pk_bf16_f32 v149, v150, v151
    v_lshlrev_b32 v150, 16, v146
    v_lshlrev_b32 v151, 16, v148
    v_add_f32 v150, v150, v151
    v_and_b32 v151, 0xffff0000, v146
    v_and_b32 v152, 0xffff0000, v148
    v_add_f32 v151, v151, v152
    v_cvt_pk_bf16_f32 v110, v150, v151
    v_lshlrev_b32 v150, 16, v147
    v_lshlrev_b32 v151, 16, v149
    v_add_f32 v150, v150, v151
    v_and_b32 v151, 0xffff0000, v147
    v_and_b32 v152, 0xffff0000, v149
    v_add_f32 v151, v151, v152
    v_cvt_pk_bf16_f32 v111, v150, v151
    buffer_store_dwordx2 v[110:111], v5, s[24:27], s36 offen offset:96
    v_cvt_pk_bf16_f32 v146, v68, v69
    v_cvt_pk_bf16_f32 v147, v70, v71
    v_lshlrev_b32 v68, 16, v146
    v_and_b32 v69, 0xffff0000, v146
    v_lshlrev_b32 v70, 16, v147
    v_and_b32 v71, 0xffff0000, v147
    v_mul_f32 v68, v143, v68
    v_mul_f32 v69, v143, v69
    v_mul_f32 v70, v143, v70
    v_mul_f32 v71, v143, v71
    v_cvt_pk_bf16_f32 v146, v68, v69
    v_cvt_pk_bf16_f32 v147, v70, v71
    s_waitcnt lgkmcnt(1)
    v_lshlrev_b32 v148, 16, v112
    v_and_b32 v149, 0xffff0000, v112
    v_lshlrev_b32 v150, 16, v113
    v_and_b32 v151, 0xffff0000, v113
    v_mul_f32 v148, v145, v148
    v_mul_f32 v149, v145, v149
    v_mul_f32 v150, v145, v150
    v_mul_f32 v151, v145, v151
    v_cvt_pk_bf16_f32 v148, v148, v149
    v_cvt_pk_bf16_f32 v149, v150, v151
    v_lshlrev_b32 v150, 16, v146
    v_lshlrev_b32 v151, 16, v148
    v_add_f32 v150, v150, v151
    v_and_b32 v151, 0xffff0000, v146
    v_and_b32 v152, 0xffff0000, v148
    v_add_f32 v151, v151, v152
    v_cvt_pk_bf16_f32 v112, v150, v151
    v_lshlrev_b32 v150, 16, v147
    v_lshlrev_b32 v151, 16, v149
    v_add_f32 v150, v150, v151
    v_and_b32 v151, 0xffff0000, v147
    v_and_b32 v152, 0xffff0000, v149
    v_add_f32 v151, v151, v152
    v_cvt_pk_bf16_f32 v113, v150, v151
    buffer_store_dwordx2 v[112:113], v5, s[24:27], s36 offen offset:128
    v_cvt_pk_bf16_f32 v146, v72, v73
    v_cvt_pk_bf16_f32 v147, v74, v75
    v_lshlrev_b32 v72, 16, v146
    v_and_b32 v73, 0xffff0000, v146
    v_lshlrev_b32 v74, 16, v147
    v_and_b32 v75, 0xffff0000, v147
    v_mul_f32 v72, v143, v72
    v_mul_f32 v73, v143, v73
    v_mul_f32 v74, v143, v74
    v_mul_f32 v75, v143, v75
    v_cvt_pk_bf16_f32 v146, v72, v73
    v_cvt_pk_bf16_f32 v147, v74, v75
    s_waitcnt lgkmcnt(0)
    v_lshlrev_b32 v148, 16, v114
    v_and_b32 v149, 0xffff0000, v114
    v_lshlrev_b32 v150, 16, v115
    v_and_b32 v151, 0xffff0000, v115
    v_mul_f32 v148, v145, v148
    v_mul_f32 v149, v145, v149
    v_mul_f32 v150, v145, v150
    v_mul_f32 v151, v145, v151
    v_cvt_pk_bf16_f32 v148, v148, v149
    v_cvt_pk_bf16_f32 v149, v150, v151
    v_lshlrev_b32 v150, 16, v146
    v_lshlrev_b32 v151, 16, v148
    v_add_f32 v150, v150, v151
    v_and_b32 v151, 0xffff0000, v146
    v_and_b32 v152, 0xffff0000, v148
    v_add_f32 v151, v151, v152
    v_cvt_pk_bf16_f32 v114, v150, v151
    v_lshlrev_b32 v150, 16, v147
    v_lshlrev_b32 v151, 16, v149
    v_add_f32 v150, v150, v151
    v_and_b32 v151, 0xffff0000, v147
    v_and_b32 v152, 0xffff0000, v149
    v_add_f32 v151, v151, v152
    v_cvt_pk_bf16_f32 v115, v150, v151
    buffer_store_dwordx2 v[114:115], v5, s[24:27], s36 offen offset:160
k3_kernel_exit_1:
    s_endpgm
.section .rodata,"a"
.p2align 6
.amdhsa_kernel k1_kernel
  .amdhsa_next_free_vgpr 144
  .amdhsa_next_free_sgpr 64
  .amdhsa_accum_offset 144
  .amdhsa_group_segment_fixed_size 0
  .amdhsa_kernarg_size 112
  .amdhsa_user_sgpr_count 2
  .amdhsa_user_sgpr_kernarg_segment_ptr 1
  .amdhsa_system_sgpr_workgroup_id_x 1
.end_amdhsa_kernel
.p2align 6
.amdhsa_kernel k2_kernel
  .amdhsa_next_free_vgpr 120
  .amdhsa_next_free_sgpr 37
  .amdhsa_accum_offset 120
  .amdhsa_group_segment_fixed_size 0
  .amdhsa_kernarg_size 112
  .amdhsa_user_sgpr_count 2
  .amdhsa_user_sgpr_kernarg_segment_ptr 1
  .amdhsa_system_sgpr_workgroup_id_x 1
.end_amdhsa_kernel
.p2align 6
.amdhsa_kernel k3_kernel
  .amdhsa_next_free_vgpr 160
  .amdhsa_next_free_sgpr 40
  .amdhsa_accum_offset 160
  .amdhsa_group_segment_fixed_size 0
  .amdhsa_kernarg_size 112
  .amdhsa_user_sgpr_count 2
  .amdhsa_user_sgpr_kernarg_segment_ptr 1
  .amdhsa_system_sgpr_workgroup_id_x 1
.end_amdhsa_kernel
```
